```python
import torch

def _softmax(x, axis=-1):
    return torch.softmax(x, dim=axis)
def _gelu(x):
    return torch.nn.functional.gelu(x, approximate="tanh")
def _silu(x):
    return torch.nn.functional.silu(x)
def _sigmoid(x):
    return torch.sigmoid(x)
def _layernorm(x, axis=-1, eps=1e-5):
    m = x.mean(dim=axis, keepdim=True)
    v = x.var(dim=axis, keepdim=True, unbiased=False)
    return (x - m) / torch.sqrt(v + eps)
def _scatter_add(tgt, idx, src, axis=0):
    return tgt.clone().index_add_(axis, idx, src)
def _segment_sum(src, seg, n):
    out = torch.zeros((n,) + src.shape[1:], dtype=src.dtype)
    return out.index_add_(0, seg, src)
def _pad(x, pw):
    flat = tuple(v for pair in reversed(pw) for v in pair)
    return torch.nn.functional.pad(x, flat)

kernel_name = 'interleave_layers__gqa_block_cached__glu_gated_reglu__decode'

def setup_inputs():

    _w = (lambda a: (lambda t: t.to(torch.bfloat16) if t.is_floating_point() else t)(torch.as_tensor(a)))
    def _A_setup():
        B, Sq, D = 1, 1, 512
        Hq, Hkv, Sk, Dh = 32, 8, 65536, 128
        assert Hq % Hkv == 0, (Hq, Hkv)
        return {
            "x": _w((lambda *s: torch.randn(*s, dtype=torch.bfloat16) * 0.05)(B, Sq, D)),
            "k_cache": _w((lambda *s: torch.randn(*s, dtype=torch.bfloat16) * 0.8)(B, Hkv, Sk, Dh)),
            "v_cache": _w((lambda *s: torch.randn(*s, dtype=torch.bfloat16) * 1.6)(B, Hkv, Sk, Dh)),
            "wq": _w((lambda *s: torch.randn(*s, dtype=torch.bfloat16) * 0.8)(D, Hq * Dh) * (D ** -0.5)),
            "wo": _w((lambda *s: torch.randn(*s, dtype=torch.bfloat16) * 1.6)(Hq * Dh, D) * ((Hq * Dh) ** -0.5)),
        }
    _A_in = _A_setup()

    def _B_setup():
        B, S, D, F = 1, 1, 512, 1792
        return {
            "x": _w((lambda *s: torch.randn(*s, dtype=torch.bfloat16) * 0.05)(B, S, D)),
            "W_gate": _w((lambda *s: torch.randn(*s, dtype=torch.bfloat16) * 0.2)(D, F) * (2.0 / D) ** 0.5),
            "W_up": _w((lambda *s: torch.randn(*s, dtype=torch.bfloat16) * 0.2)(D, F) * (2.0 / D) ** 0.5),
            "W_down": _w((lambda *s: torch.randn(*s, dtype=torch.bfloat16) * 0.2)(F, D) * (1.0 / F) ** 0.5),
        }
    _B_in = _B_setup()

    return {
        "A_x": _A_in["x"],
        "A_k_cache": _A_in["k_cache"],
        "A_v_cache": _A_in["v_cache"],
        "A_wq": _A_in["wq"],
        "A_wo": _A_in["wo"],
        "B_x": _B_in["x"],
        "B_W_gate": _B_in["W_gate"],
        "B_W_up": _B_in["W_up"],
        "B_W_down": _B_in["W_down"],
    }

def reference(A_x, A_k_cache, A_v_cache, A_wq, A_wo, B_x, B_W_gate, B_W_up, B_W_down):
    def _A_ref(x, k_cache, v_cache, wq, wo):
        B, Sq, D = x.shape
        Hq, Dh = 32, 128
        Hkv = k_cache.shape[1]
        rep = Hq // Hkv
        q = (lambda x, *d: x.permute(*d))((x @ wq).reshape(B, Sq, Hq, Dh), 0, 2, 1, 3)
        k = (lambda x, n, axis: torch.repeat_interleave(x, n, dim=axis))(k_cache, rep, axis=1)
        v = (lambda x, n, axis: torch.repeat_interleave(x, n, dim=axis))(v_cache, rep, axis=1)
        scores = torch.einsum("bhqd,bhkd->bhqk", q, k) * (Dh ** -0.5)
        p = _softmax(scores, axis=-1)
        o = torch.einsum("bhqk,bhkd->bhqd", p, v)
        return (lambda x, *d: x.permute(*d))(o, 0, 2, 1, 3).reshape(B, Sq, Hq * Dh) @ wo

    def _B_ref(x, W_gate, W_up, W_down):
        gate = torch.einsum("bsd,df->bsf", x, W_gate)
        up = torch.einsum("bsd,df->bsf", x, W_up)
        gate = gate * (lambda x, dt: x.to(dt))(gate > 0, gate.dtype)
        h = gate * up
        return torch.einsum("bsf,fd->bsd", h, W_down)

    x = A_x
    x = x + _A_ref(_layernorm(x, axis=-1), A_k_cache, A_v_cache, A_wq, A_wo)
    x = x + _B_ref(_layernorm(x, axis=-1), B_W_gate, B_W_up, B_W_down)
    x = x + _A_ref(_layernorm(x, axis=-1), A_k_cache, A_v_cache, A_wq, A_wo)
    x = x + _B_ref(_layernorm(x, axis=-1), B_W_gate, B_W_up, B_W_down)
    return x
```

```asm
; @launch grid=(256,1,1) block=(256,1,1) lds=163840
.amdgcn_target "amdgcn-amd-amdhsa--gfx950"
.macro M_CALL hdr, sub
s_movk_i32 s96, \hdr
s_call_b64 s[94:95], \sub
.endm
.macro M_XCV r0, r1, r2, r3, r4, r5, r6, r7, w
v_mov_b32 v40, 0
v_pk_sub_u16 v41, v\r0, s74 clamp
v_and_b32 v41, 0x78007800, v41
v_pk_sub_u16 v42, v\r0, s85
v_pk_sub_u16 v42, s74, v42 clamp
v_or3_b32 v40, v40, v41, v42
v_pk_sub_u16 v41, v\r1, s74 clamp
v_and_b32 v41, 0x78007800, v41
v_pk_sub_u16 v42, v\r1, s85
v_pk_sub_u16 v42, s74, v42 clamp
v_or3_b32 v40, v40, v41, v42
v_pk_sub_u16 v41, v\r2, s74 clamp
v_and_b32 v41, 0x78007800, v41
v_pk_sub_u16 v42, v\r2, s85
v_pk_sub_u16 v42, s74, v42 clamp
v_or3_b32 v40, v40, v41, v42
v_pk_sub_u16 v41, v\r3, s74 clamp
v_and_b32 v41, 0x78007800, v41
v_pk_sub_u16 v42, v\r3, s85
v_pk_sub_u16 v42, s74, v42 clamp
v_or3_b32 v40, v40, v41, v42
v_pk_sub_u16 v41, v\r4, s74 clamp
v_and_b32 v41, 0x78007800, v41
v_pk_sub_u16 v42, v\r4, s85
v_pk_sub_u16 v42, s74, v42 clamp
v_or3_b32 v40, v40, v41, v42
v_pk_sub_u16 v41, v\r5, s74 clamp
v_and_b32 v41, 0x78007800, v41
v_pk_sub_u16 v42, v\r5, s85
v_pk_sub_u16 v42, s74, v42 clamp
v_or3_b32 v40, v40, v41, v42
v_pk_sub_u16 v41, v\r6, s74 clamp
v_and_b32 v41, 0x78007800, v41
v_pk_sub_u16 v42, v\r6, s85
v_pk_sub_u16 v42, s74, v42 clamp
v_or3_b32 v40, v40, v41, v42
v_pk_sub_u16 v41, v\r7, s74 clamp
v_and_b32 v41, 0x78007800, v41
v_pk_sub_u16 v42, v\r7, s85
v_pk_sub_u16 v42, s74, v42 clamp
v_or3_b32 v40, v40, v41, v42
v_cmp_ne_u32 vcc, 0, v40
s_cbranch_vccz L_m\@
s_nop 4
v_perm_b32 v32, v\r1, v\r0, s57
v_perm_b32 v33, v\r3, v\r2, s57
v_perm_b32 v34, v\r5, v\r4, s57
v_perm_b32 v35, v\r7, v\r6, s57
v_perm_b32 v36, v\r1, v\r0, s58
v_perm_b32 v37, v\r3, v\r2, s58
v_perm_b32 v38, v\r5, v\r4, s58
v_perm_b32 v39, v\r7, v\r6, s58
s_bcnt1_i32_b64 s82, vcc
s_add_u32 s82, s82, s78
s_cmp_gt_u32 s82, 26
s_cbranch_scc1 L_sub_ret
v_mbcnt_lo_u32_b32 v41, vcc_lo, 0
v_mbcnt_hi_u32_b32 v41, vcc_hi, v41
v_add_u32 v41, s78, v41
v_lshlrev_b32 v42, 5, v41
v_add_u32 v42, s80, v42
v_lshlrev_b32 v41, 2, v41
v_add_u32 v41, s80, v41
v_or_b32 v43, s96, v1
s_mov_b32 s78, s82
s_mov_b64 exec, vcc
s_lshr_b32 s83, s96, 9
s_lshl_b32 s83, s83, 2
s_add_u32 s83, s83, \w
s_bitset1_b64 s[90:91], s83
ds_write_b128 v42, v[32:35] offset:128
ds_write_b128 v42, v[36:39] offset:144
ds_write_b32 v41, v43
s_waitcnt lgkmcnt(0)
s_mov_b64 exec, -1
L_m\@:
s_add_u32 s96, s96, 64
.endm
.macro M_XCK r
v_mov_b32 v40, 0
v_pk_sub_u16 v41, v[\r+0], s75 clamp
v_and_b32 v41, 0x78007800, v41
v_pk_sub_u16 v42, v[\r+0], s85
v_pk_sub_u16 v42, s75, v42 clamp
v_or3_b32 v40, v40, v41, v42
v_pk_sub_u16 v41, v[\r+1], s75 clamp
v_and_b32 v41, 0x78007800, v41
v_pk_sub_u16 v42, v[\r+1], s85
v_pk_sub_u16 v42, s75, v42 clamp
v_or3_b32 v40, v40, v41, v42
v_pk_sub_u16 v41, v[\r+2], s75 clamp
v_and_b32 v41, 0x78007800, v41
v_pk_sub_u16 v42, v[\r+2], s85
v_pk_sub_u16 v42, s75, v42 clamp
v_or3_b32 v40, v40, v41, v42
v_pk_sub_u16 v41, v[\r+3], s75 clamp
v_and_b32 v41, 0x78007800, v41
v_pk_sub_u16 v42, v[\r+3], s85
v_pk_sub_u16 v42, s75, v42 clamp
v_or3_b32 v40, v40, v41, v42
v_cmp_ne_u32 vcc, 0, v40
s_cbranch_vccz L_m\@
s_nop 4
s_bcnt1_i32_b64 s82, vcc
s_add_u32 s82, s82, s78
s_cmp_gt_u32 s82, 26
s_cbranch_scc1 L_sub_ret
v_mbcnt_lo_u32_b32 v41, vcc_lo, 0
v_mbcnt_hi_u32_b32 v41, vcc_hi, v41
v_add_u32 v41, s78, v41
v_lshlrev_b32 v42, 5, v41
v_add_u32 v42, s80, v42
v_lshlrev_b32 v41, 2, v41
v_add_u32 v41, s80, v41
v_or_b32 v43, s96, v1
s_mov_b32 s78, s82
s_mov_b64 exec, vcc
s_lshr_b32 s83, s96, 6
s_bitset1_b64 s[92:93], s83
ds_write_b128 v42, v[\r:\r+3] offset:128
ds_write_b32 v41, v43
s_waitcnt lgkmcnt(0)
s_mov_b64 exec, -1
L_m\@:
s_add_u32 s96, s96, 64
.endm
.macro M_SPV r0, r1, r2, r3, r4, r5, r6, r7, off
v_perm_b32 v32, v\r1, v\r0, s57
v_perm_b32 v33, v\r3, v\r2, s57
v_perm_b32 v34, v\r5, v\r4, s57
v_perm_b32 v35, v\r7, v\r6, s57
v_perm_b32 v36, v\r1, v\r0, s58
v_perm_b32 v37, v\r3, v\r2, s58
v_perm_b32 v38, v\r5, v\r4, s58
v_perm_b32 v39, v\r7, v\r6, s58
v_lshlrev_b32 v40, 4, v1
s_add_u32 s82, s79, \off
buffer_store_dwordx4 v[32:35], v40, s[16:19], s82 offen sc0 sc1
buffer_store_dwordx4 v[36:39], v40, s[16:19], s82 offen offset:1024 sc0 sc1
s_waitcnt vmcnt(0)
.endm
.macro M_SPK r, off
v_lshlrev_b32 v40, 4, v1
s_add_u32 s82, s79, \off
buffer_store_dwordx4 v[\r:\r+3], v40, s[16:19], s82 offen sc0 sc1
s_waitcnt vmcnt(0)
.endm
.macro M_CSUBS_
L_sub_pv:
s_lshr_b32 s82, s96, 9
s_bitcmp1_b32 s77, s82
s_cbranch_scc1 L_sub_pvo
v_and_b32 v8, 31, v1
v_lshlrev_b32 v8, 2, v8
v_add_u32 v8, s80, v8
ds_read_b32 v8, v8
s_bfm_b32 s82, s78, 0
s_waitcnt lgkmcnt(0)
v_xor_b32 v8, s96, v8
v_cmp_gt_u32 vcc, 64, v8
s_nop 4
s_and_b32 s82, s82, vcc_lo
s_cbranch_scc0 L_sub_pvd
L_sub_pvl:
s_ff1_i32_b32 s83, s82
s_bitset0_b32 s82, s83
v_readlane_b32 s84, v8, s83
s_lshl_b32 s83, s83, 5
s_add_u32 s83, s83, s80
s_nop 4
s_lshl_b64 exec, 1, s84
v_mov_b32 v39, s83
ds_read_b128 v[32:35], v39 offset:128
ds_read_b128 v[36:39], v39 offset:144
s_cmp_lg_u32 s82, 0
s_cbranch_scc1 L_sub_pvl
s_mov_b64 exec, -1
s_waitcnt lgkmcnt(0)
L_sub_pvd:
s_nop 1
s_setpc_b64 s[94:95]
L_sub_pvo:
v_lshlrev_b32 v8, 4, v1
s_lshl_b32 s82, s82, 13
s_bfe_u32 s83, s96, 0x30006
s_lshl_b32 s83, s83, 11
s_add_u32 s82, s82, s83
s_add_u32 s82, s82, s79
buffer_load_dwordx4 v[32:35], v8, s[16:19], s82 offen sc0 sc1
buffer_load_dwordx4 v[36:39], v8, s[16:19], s82 offen offset:1024 sc0 sc1
s_waitcnt vmcnt(0)
s_branch L_sub_pvd
L_sub_pk:
s_lshr_b32 s82, s96, 9
s_bitcmp1_b32 s77, s82
s_cbranch_scc1 L_sub_pko
v_and_b32 v8, 31, v1
v_lshlrev_b32 v8, 2, v8
v_add_u32 v8, s80, v8
ds_read_b32 v8, v8
s_bfm_b32 s82, s78, 0
s_waitcnt lgkmcnt(0)
v_xor_b32 v8, s96, v8
v_cmp_gt_u32 vcc, 64, v8
s_nop 4
s_and_b32 s82, s82, vcc_lo
s_cbranch_scc0 L_sub_pkd
L_sub_pkl:
s_ff1_i32_b32 s83, s82
s_bitset0_b32 s82, s83
v_readlane_b32 s84, v8, s83
s_lshl_b32 s83, s83, 5
s_add_u32 s83, s83, s80
s_nop 4
s_lshl_b64 exec, 1, s84
v_mov_b32 v31, s83
ds_read_b128 v[28:31], v31 offset:128
s_cmp_lg_u32 s82, 0
s_cbranch_scc1 L_sub_pkl
s_mov_b64 exec, -1
s_waitcnt lgkmcnt(0)
L_sub_pkd:
s_nop 1
s_setpc_b64 s[94:95]
L_sub_pko:
v_lshlrev_b32 v8, 4, v1
s_lshl_b32 s82, s96, 4
s_add_u32 s82, s82, s79
buffer_load_dwordx4 v[28:31], v8, s[16:19], s82 offen sc0 sc1
s_waitcnt vmcnt(0)
s_branch L_sub_pkd
.endm
.macro M_CSUBE_
L_sub_ev80:
s_waitcnt lgkmcnt(0)
s_nop 7
M_XCV 80, 84, 88, 92, 96, 100, 104, 108, 0
M_XCV 81, 85, 89, 93, 97, 101, 105, 109, 1
M_XCV 82, 86, 90, 94, 98, 102, 106, 110, 2
M_XCV 83, 87, 91, 95, 99, 103, 107, 111, 3
s_branch L_sub_ok
L_sub_ek80:
s_waitcnt lgkmcnt(0)
s_nop 7
M_XCK 80
M_XCK 84
M_XCK 88
M_XCK 92
M_XCK 96
M_XCK 100
M_XCK 104
M_XCK 108
s_branch L_sub_ok
L_sub_ev112:
s_waitcnt lgkmcnt(0)
s_nop 7
M_XCV 112, 116, 120, 124, 128, 132, 136, 140, 0
M_XCV 113, 117, 121, 125, 129, 133, 137, 141, 1
M_XCV 114, 118, 122, 126, 130, 134, 138, 142, 2
M_XCV 115, 119, 123, 127, 131, 135, 139, 143, 3
s_branch L_sub_ok
L_sub_ek112:
s_waitcnt lgkmcnt(0)
s_nop 7
M_XCK 112
M_XCK 116
M_XCK 120
M_XCK 124
M_XCK 128
M_XCK 132
M_XCK 136
M_XCK 140
s_branch L_sub_ok
L_sub_ok:
s_cmp_lg_u32 0, 0
L_sub_ret:
s_nop 1
s_setpc_b64 s[94:95]
.endm
.text
.globl interleave_layers__gqa_block_cached__glu_gated_reglu__decode_kernel
.p2align 8
.type interleave_layers__gqa_block_cached__glu_gated_reglu__decode_kernel,@function
interleave_layers__gqa_block_cached__glu_gated_reglu__decode_kernel:
    s_load_dwordx16 s[64:79], s[0:1], 0
    s_load_dwordx8 s[80:87], s[0:1], 64
    v_and_b32 v1, 63, v0
    v_lshrrev_b32 v4, 6, v0
    s_nop 0
    v_readfirstlane_b32 s52, v4
    s_cmp_ge_u32 s2, 256
    s_cbranch_scc1 L_exit
    s_waitcnt lgkmcnt(0)
    s_mov_b32 s8, s66
    s_and_b32 s9, s67, 0xffff
    s_mov_b32 s10, 0x8000000
    s_mov_b32 s11, 0x00020000
    s_mov_b32 s12, s68
    s_and_b32 s13, s69, 0xffff
    s_mov_b32 s14, 0x8000000
    s_mov_b32 s15, 0x00020000
    s_and_b32 s66, s2, 7
    s_lshr_b32 s67, s2, 3
    s_lshl_b32 s3, s66, 5
    s_add_u32 s3, s3, s67
    s_lshl_b32 s66, s3, 2
    s_add_u32 s66, s66, s52
    s_lshr_b32 s67, s66, 4
    s_mul_i32 s99, s67, 3
    s_and_b32 s99, s99, 15
    s_lshl_b32 s99, s99, 17
    s_lshl_b32 s67, s67, 21
    s_and_b32 s66, s66, 15
    s_lshl_b32 s66, s66, 13
    s_add_u32 s66, s66, s67
    v_bfe_u32 v4, v1, 2, 2
    v_lshlrev_b32 v4, 8, v4
    v_lshrrev_b32 v5, 4, v1
    v_lshlrev_b32 v5, 6, v5
    v_and_b32 v6, 3, v1
    v_lshlrev_b32 v6, 4, v6
    v_add3_u32 v2, v4, v5, v6
    v_add_u32 v2, s66, v2
    v_lshlrev_b32 v3, 4, v1
    v_add_u32 v3, s66, v3
    s_add_u32 s53, s99, 0x0
    s_and_b32 s53, s53, 0x1fffff
    buffer_load_dwordx4 v[80:83], v3, s[12:15], s53 offen offset:0 nt
    buffer_load_dwordx4 v[84:87], v3, s[12:15], s53 offen offset:1024 nt
    buffer_load_dwordx4 v[88:91], v3, s[12:15], s53 offen offset:2048 nt
    buffer_load_dwordx4 v[92:95], v3, s[12:15], s53 offen offset:3072 nt
    s_add_u32 s53, s53, 0x1000
    buffer_load_dwordx4 v[96:99], v3, s[12:15], s53 offen offset:0 nt
    buffer_load_dwordx4 v[100:103], v3, s[12:15], s53 offen offset:1024 nt
    buffer_load_dwordx4 v[104:107], v3, s[12:15], s53 offen offset:2048 nt
    buffer_load_dwordx4 v[108:111], v3, s[12:15], s53 offen offset:3072 nt
    s_add_u32 s53, s99, 0x20000
    s_and_b32 s53, s53, 0x1fffff
    buffer_load_dwordx4 v[112:115], v3, s[12:15], s53 offen offset:0 nt
    buffer_load_dwordx4 v[116:119], v3, s[12:15], s53 offen offset:1024 nt
    buffer_load_dwordx4 v[120:123], v3, s[12:15], s53 offen offset:2048 nt
    buffer_load_dwordx4 v[124:127], v3, s[12:15], s53 offen offset:3072 nt
    s_add_u32 s53, s53, 0x1000
    buffer_load_dwordx4 v[128:131], v3, s[12:15], s53 offen offset:0 nt
    buffer_load_dwordx4 v[132:135], v3, s[12:15], s53 offen offset:1024 nt
    buffer_load_dwordx4 v[136:139], v3, s[12:15], s53 offen offset:2048 nt
    buffer_load_dwordx4 v[140:143], v3, s[12:15], s53 offen offset:3072 nt
    s_mov_b32 s40, s64
    s_and_b32 s41, s65, 0xffff
    s_mov_b32 s42, 0x400
    s_mov_b32 s43, 0x00020000
    s_mov_b32 s20, s70
    s_and_b32 s21, s71, 0xffff
    s_mov_b32 s22, 0x400000
    s_mov_b32 s23, 0x00020000
    s_mov_b32 s24, s72
    s_and_b32 s25, s73, 0xffff
    s_mov_b32 s26, 0x400000
    s_mov_b32 s27, 0x00020000
    s_mov_b32 s28, s76
    s_and_b32 s29, s77, 0xffff
    s_mov_b32 s30, 0x1c0000
    s_mov_b32 s31, 0x00020000
    s_mov_b32 s32, s78
    s_and_b32 s33, s79, 0xffff
    s_mov_b32 s34, 0x1c0000
    s_mov_b32 s35, 0x00020000
    s_mov_b32 s36, s80
    s_and_b32 s37, s81, 0xffff
    s_mov_b32 s38, 0x1c0000
    s_mov_b32 s39, 0x00020000
    s_mov_b32 s44, s82
    s_and_b32 s45, s83, 0xffff
    s_mov_b32 s46, 0x400
    s_mov_b32 s47, 0x00020000
    s_mov_b32 s48, s84
    s_and_b32 s49, s85, 0xffff
    s_mov_b32 s50, 0x100
    s_mov_b32 s51, 0x00020000
    s_mov_b32 s16, s86
    s_and_b32 s17, s87, 0xffff
    s_mov_b32 s18, 0xb800000
    s_mov_b32 s19, 0x00020000
    s_mov_b32 s54, 0
    s_mov_b32 s55, 0
    s_and_b32 s4, s3, 31
    s_lshr_b32 s66, s3, 5
    s_lshl_b32 s6, s66, 4
    s_add_u32 s6, s6, s4
    s_sub_u32 s6, s6, 16
    s_cmp_lt_u32 s4, 16
    s_cselect_b32 s6, 0x100, s6
    s_mov_b32 s61, 0x100000
    s_mov_b32 s56, 400000
    s_mov_b32 s57, 0x05040100
    s_mov_b32 s58, 0x07060302
    s_mov_b32 s59, 0xffff0000
    s_mov_b32 s70, 0x6020400
    s_mov_b32 s71, 0x7030501
    s_mov_b32 s72, 0x5010400
    s_mov_b32 s73, 0x7030602
    s_mov_b32 s74, 0x39003900
    s_mov_b32 s75, 0x38803880
    s_mov_b32 s85, 0x10001
    s_mov_b32 s90, 0x0
    s_mov_b32 s91, 0x0
    s_mov_b32 s92, 0x0
    s_mov_b32 s93, 0x0
    s_mov_b32 s76, 0x0
    s_mov_b32 s77, 0x0
    s_mov_b32 s78, 0x0
    s_mov_b32 s81, 0x87878787
    s_lshl_b32 s79, s2, 2
    s_add_u32 s79, s79, s52
    s_mul_i32 s79, s79, 172032
    s_add_u32 s79, s79, 0x1000000
    s_mul_i32 s80, s52, 960
    s_add_u32 s80, s80, 12544
    s_mov_b32 s60, 0x3e0293ee
    v_mov_b32 v8, -1
    v_mov_b32 v9, -1
    v_lshlrev_b32 v4, 3, v0
    s_mul_i32 s5, s3, 2560
    v_add_u32 v4, s5, v4
    buffer_store_dwordx2 v[8:9], v4, s[16:19], 0 offen sc1
    buffer_store_dwordx2 v[8:9], v4, s[16:19], s61 offen sc1
    v_lshlrev_b32 v5, 3, v1
    s_lshl_b32 s66, s52, 7
    s_add_u32 s5, s5, s66
    s_add_u32 s5, s5, 2048
    s_mov_b32 s66, s5
    v_add_u32 v4, s66, v5
    s_mov_b64 exec, 0x1
    buffer_store_dwordx2 v[8:9], v4, s[16:19], 0 offen sc1
    buffer_store_dwordx2 v[8:9], v4, s[16:19], s61 offen sc1
    s_mov_b64 exec, -1
    s_lshl_b32 s68, s3, 8
    s_lshl_b32 s69, s52, 7
    s_add_u32 s68, s68, s69
    s_mov_b32 s69, 0xc0000
    s_cmp_lt_u32 s52, 2
    s_cselect_b32 s69, s69, 0xaff00
    s_add_u32 s68, s68, s69
    s_mov_b32 s66, s68
    v_add_u32 v4, s66, v5
    s_mov_b64 exec, 0xffff
    buffer_store_dwordx2 v[8:9], v4, s[16:19], 0 offen sc1
    buffer_store_dwordx2 v[8:9], v4, s[16:19], s61 offen sc1
    s_mov_b64 exec, -1
    s_cmp_lt_u32 s52, 2
    s_cbranch_scc1 L_clear1
    s_and_b32 s66, s3, 3
    s_lshl_b32 s66, s66, 8
    v_lshrrev_b32 v7, 2, v1
    v_lshlrev_b32 v7, 1, v7
    buffer_load_ushort v240, v7, s[40:43], s66 offen offset:0
    buffer_load_ushort v241, v7, s[40:43], s66 offen offset:32
    buffer_load_ushort v242, v7, s[40:43], s66 offen offset:64
    buffer_load_ushort v243, v7, s[40:43], s66 offen offset:96
    buffer_load_ushort v244, v7, s[40:43], s66 offen offset:128
    buffer_load_ushort v245, v7, s[40:43], s66 offen offset:160
    buffer_load_ushort v246, v7, s[40:43], s66 offen offset:192
    buffer_load_ushort v247, v7, s[40:43], s66 offen offset:224
    v_lshrrev_b32 v4, 2, v1
    v_lshlrev_b32 v4, 13, v4
    v_and_b32 v5, 3, v1
    v_lshl_add_u32 v4, v5, 4, v4
    s_and_b32 s66, s3, 3
    s_lshl_b32 s66, s66, 20
    s_lshr_b32 s67, s3, 2
    s_lshl_b32 s67, s67, 7
    s_add_u32 s66, s66, s67
    s_lshl_b32 s67, s52, 6
    s_add_u32 s66, s66, s67
    s_sub_u32 s66, s66, 128
    s_add_u32 s53, s66, 0x0
    buffer_load_dwordx4 v[48:51], v4, s[20:23], s53 offen
    s_add_u32 s53, s66, 0x20000
    buffer_load_dwordx4 v[52:55], v4, s[20:23], s53 offen
    s_add_u32 s53, s66, 0x40000
    buffer_load_dwordx4 v[56:59], v4, s[20:23], s53 offen
    s_add_u32 s53, s66, 0x60000
    buffer_load_dwordx4 v[60:63], v4, s[20:23], s53 offen
    s_add_u32 s53, s66, 0x80000
    buffer_load_dwordx4 v[64:67], v4, s[20:23], s53 offen
    s_add_u32 s53, s66, 0xa0000
    buffer_load_dwordx4 v[68:71], v4, s[20:23], s53 offen
    s_add_u32 s53, s66, 0xc0000
    buffer_load_dwordx4 v[72:75], v4, s[20:23], s53 offen
    s_add_u32 s53, s66, 0xe0000
    buffer_load_dwordx4 v[76:79], v4, s[20:23], s53 offen
    s_branch L_noclear
L_clear1:
    s_cmp_lg_u32 s52, 0
    s_cbranch_scc1 L_noclear
    s_lshl_b32 s66, s3, 7
    s_add_u32 s66, s66, 0x400000
    v_lshrrev_b32 v4, 4, v1
    v_mul_u32_u24 v4, 0x8100, v4
    v_and_b32 v6, 15, v1
    v_lshl_add_u32 v4, v6, 3, v4
    s_add_u32 s67, s66, 0x0
    buffer_store_dwordx2 v[8:9], v4, s[16:19], s67 offen sc1
    s_add_u32 s67, s66, 0x100000
    buffer_store_dwordx2 v[8:9], v4, s[16:19], s67 offen sc1
    s_add_u32 s67, s66, 0x20400
    buffer_store_dwordx2 v[8:9], v4, s[16:19], s67 offen sc1
    s_add_u32 s67, s66, 0x120400
    buffer_store_dwordx2 v[8:9], v4, s[16:19], s67 offen sc1
    s_getreg_b32 s67, hwreg(HW_REG_XCC_ID, 0, 4)
    s_lshl_b32 s66, s3, 2
    s_add_u32 s66, s66, 0xd1000
    v_mov_b32 v6, s67
    s_mov_b64 exec, 1
    buffer_store_dword v6, off, s[16:19], s66 sc1
    s_mov_b64 exec, -1
    s_cmp_ge_u32 s6, 128
    s_cbranch_scc1 L_noclear
    s_lshl_b32 s66, s6, 7
    s_add_u32 s66, s66, 0x600000
    v_lshrrev_b32 v4, 4, v1
    v_mul_u32_u24 v4, 0x4100, v4
    v_and_b32 v6, 15, v1
    v_lshl_add_u32 v4, v6, 3, v4
    s_add_u32 s67, s66, 0x0
    buffer_store_dwordx2 v[8:9], v4, s[16:19], s67 offen sc1
    s_add_u32 s67, s66, 0x100000
    buffer_store_dwordx2 v[8:9], v4, s[16:19], s67 offen sc1
    s_add_u32 s67, s66, 0x10400
    buffer_store_dwordx2 v[8:9], v4, s[16:19], s67 offen sc1
    s_add_u32 s67, s66, 0x110400
    buffer_store_dwordx2 v[8:9], v4, s[16:19], s67 offen sc1
L_noclear:
    v_lshlrev_b32 v7, 1, v1
    buffer_load_ushort v24, v7, s[40:43], 0 offen offset:0
    buffer_load_ushort v25, v7, s[40:43], 0 offen offset:128
    buffer_load_ushort v26, v7, s[40:43], 0 offen offset:256
    buffer_load_ushort v27, v7, s[40:43], 0 offen offset:384
    buffer_load_ushort v28, v7, s[40:43], 0 offen offset:512
    buffer_load_ushort v29, v7, s[40:43], 0 offen offset:640
    buffer_load_ushort v30, v7, s[40:43], 0 offen offset:768
    buffer_load_ushort v31, v7, s[40:43], 0 offen offset:896
    s_cmp_eq_u32 s52, 0
    s_cselect_b32 s40, s28, s32
    s_cselect_b32 s41, s29, s33
    s_cmp_lt_u32 s4, 28
    s_cselect_b32 s42, s30, 0
    s_and_b32 s68, s3, 3
    s_mul_i32 s66, s68, 458752
    s_lshr_b32 s67, s3, 5
    s_mul_i32 s67, s67, 448
    s_add_u32 s66, s66, s67
    s_lshr_b32 s67, s4, 2
    s_lshl_b32 s67, s67, 6
    s_add_u32 s66, s66, s67
    s_mov_b32 s69, 57344
    s_cmp_lt_u32 s52, 2
    s_cbranch_scc1 L_pgu
    s_mov_b32 s40, s20
    s_mov_b32 s41, s21
    s_mov_b32 s42, s22
    s_lshl_b32 s66, s68, 20
    s_lshr_b32 s67, s3, 2
    s_lshl_b32 s67, s67, 7
    s_add_u32 s66, s66, s67
    s_lshl_b32 s67, s52, 6
    s_add_u32 s66, s66, s67
    s_sub_u32 s66, s66, 128
    s_mov_b32 s69, 131072
L_pgu:
    s_mov_b32 s28, s66
    s_add_u32 s29, s28, s69
    s_add_u32 s30, s29, s69
    s_add_u32 s31, s30, s69
    s_add_u32 s32, s31, s69
    s_add_u32 s33, s32, s69
    s_add_u32 s34, s33, s69
    s_add_u32 s35, s34, s69
    v_lshlrev_b32 v9, 4, v1
    s_mul_i32 s66, s52, 36864
    s_add_u32 s66, s66, 16384
    v_add_u32 v9, s66, v9
    s_waitcnt vmcnt(8)
    v_pk_max_i16 v32, v80, v81
    v_pk_max_i16 v33, v88, v89
    v_pk_max_u16 v34, v96, v97
    v_pk_max_u16 v35, v104, v105
    v_pk_max_i16 v32, v32, v82
    v_pk_max_i16 v33, v33, v90
    v_pk_max_u16 v34, v34, v98
    v_pk_max_u16 v35, v35, v106
    v_pk_max_i16 v32, v32, v83
    v_pk_max_i16 v33, v33, v91
    v_pk_max_u16 v34, v34, v99
    v_pk_max_u16 v35, v35, v107
    v_pk_max_i16 v32, v32, v84
    v_pk_max_i16 v33, v33, v92
    v_pk_max_u16 v34, v34, v100
    v_pk_max_u16 v35, v35, v108
    v_pk_max_i16 v32, v32, v85
    v_pk_max_i16 v33, v33, v93
    v_pk_max_u16 v34, v34, v101
    v_pk_max_u16 v35, v35, v109
    v_pk_max_i16 v32, v32, v86
    v_pk_max_i16 v33, v33, v94
    v_pk_max_u16 v34, v34, v102
    v_pk_max_u16 v35, v35, v110
    v_pk_max_i16 v32, v32, v87
    v_pk_max_i16 v33, v33, v95
    v_pk_max_u16 v34, v34, v103
    v_pk_max_u16 v35, v35, v111
    v_pk_max_i16 v32, v32, v33
    v_pk_max_u16 v34, v34, v35
    v_and_b32 v32, 0x7fff7fff, v32
    v_and_b32 v34, 0x7fff7fff, v34
    v_pk_max_u16 v32, v32, v34
    v_lshrrev_b32 v33, 16, v32
    v_and_b32 v32, 0xffff, v32
    v_max_u32 v32, v32, v33
    s_nop 1
    v_max_u32_dpp v32, v32, v32 quad_perm:[1,0,3,2] row_mask:0xf bank_mask:0xf
    s_nop 1
    v_max_u32_dpp v32, v32, v32 quad_perm:[2,3,0,1] row_mask:0xf bank_mask:0xf
    s_nop 1
    v_max_u32_dpp v32, v32, v32 row_ror:4 row_mask:0xf bank_mask:0xf
    s_nop 1
    v_max_u32_dpp v32, v32, v32 row_ror:8 row_mask:0xf bank_mask:0xf
    s_nop 1
    v_max_u32_dpp v32, v32, v32 row_bcast:15 row_mask:0xa bank_mask:0xf
    s_nop 1
    v_max_u32_dpp v32, v32, v32 row_bcast:31 row_mask:0xc bank_mask:0xf
    s_nop 0
    v_readlane_b32 s82, v32, 63
    s_nop 0
    s_lshr_b32 s82, s82, 7
    s_max_u32 s82, s82, 15
    s_sub_u32 s82, s82, 15
    s_mul_i32 s74, s82, 0x00800080
    v_pk_sub_u16 v44, v80, s85
    v_pk_sub_u16 v42, v84, s85
    v_pk_min_u16 v44, v44, v42
    v_pk_sub_u16 v42, v88, s85
    v_pk_min_u16 v44, v44, v42
    v_pk_sub_u16 v42, v92, s85
    v_pk_min_u16 v44, v44, v42
    v_pk_sub_u16 v40, v80, s74 clamp
    v_pk_sub_u16 v41, v84, s74 clamp
    v_perm_b32 v32, v41, v40, s70
    v_perm_b32 v40, v41, v40, s71
    v_pk_sub_u16 v41, v88, s74 clamp
    v_pk_sub_u16 v42, v92, s74 clamp
    v_perm_b32 v33, v42, v41, s70
    v_perm_b32 v41, v42, v41, s71
    v_or_b32 v43, v40, v41
    v_alignbit_b32 v41, v41, v41, 4
    v_or_b32 v34, v40, v41
    v_accvgpr_write_b32 a0, v32
    v_accvgpr_write_b32 a1, v33
    v_accvgpr_write_b32 a2, v34
    v_pk_sub_u16 v42, v96, s85
    v_pk_min_u16 v44, v44, v42
    v_pk_sub_u16 v42, v100, s85
    v_pk_min_u16 v44, v44, v42
    v_pk_sub_u16 v42, v104, s85
    v_pk_min_u16 v44, v44, v42
    v_pk_sub_u16 v42, v108, s85
    v_pk_min_u16 v44, v44, v42
    v_pk_sub_u16 v40, v96, s74 clamp
    v_pk_sub_u16 v41, v100, s74 clamp
    v_perm_b32 v36, v41, v40, s70
    v_perm_b32 v40, v41, v40, s71
    v_pk_sub_u16 v41, v104, s74 clamp
    v_pk_sub_u16 v42, v108, s74 clamp
    v_perm_b32 v37, v42, v41, s70
    v_perm_b32 v41, v42, v41, s71
    v_or3_b32 v43, v43, v40, v41
    v_alignbit_b32 v41, v41, v41, 4
    v_or_b32 v38, v40, v41
    v_accvgpr_write_b32 a3, v36
    v_accvgpr_write_b32 a4, v37
    v_accvgpr_write_b32 a5, v38
    v_pk_sub_u16 v42, v81, s85
    v_pk_min_u16 v44, v44, v42
    v_pk_sub_u16 v42, v85, s85
    v_pk_min_u16 v44, v44, v42
    v_pk_sub_u16 v42, v89, s85
    v_pk_min_u16 v44, v44, v42
    v_pk_sub_u16 v42, v93, s85
    v_pk_min_u16 v44, v44, v42
    v_pk_sub_u16 v40, v81, s74 clamp
    v_pk_sub_u16 v41, v85, s74 clamp
    v_perm_b32 v32, v41, v40, s70
    v_perm_b32 v40, v41, v40, s71
    v_pk_sub_u16 v41, v89, s74 clamp
    v_pk_sub_u16 v42, v93, s74 clamp
    v_perm_b32 v33, v42, v41, s70
    v_perm_b32 v41, v42, v41, s71
    v_or3_b32 v43, v43, v40, v41
    v_alignbit_b32 v41, v41, v41, 4
    v_or_b32 v34, v40, v41
    v_accvgpr_write_b32 a6, v32
    v_accvgpr_write_b32 a7, v33
    v_accvgpr_write_b32 a8, v34
    v_pk_sub_u16 v42, v97, s85
    v_pk_min_u16 v44, v44, v42
    v_pk_sub_u16 v42, v101, s85
    v_pk_min_u16 v44, v44, v42
    v_pk_sub_u16 v42, v105, s85
    v_pk_min_u16 v44, v44, v42
    v_pk_sub_u16 v42, v109, s85
    v_pk_min_u16 v44, v44, v42
    v_pk_sub_u16 v40, v97, s74 clamp
    v_pk_sub_u16 v41, v101, s74 clamp
    v_perm_b32 v36, v41, v40, s70
    v_perm_b32 v40, v41, v40, s71
    v_pk_sub_u16 v41, v105, s74 clamp
    v_pk_sub_u16 v42, v109, s74 clamp
    v_perm_b32 v37, v42, v41, s70
    v_perm_b32 v41, v42, v41, s71
    v_or3_b32 v43, v43, v40, v41
    v_alignbit_b32 v41, v41, v41, 4
    v_or_b32 v38, v40, v41
    v_accvgpr_write_b32 a9, v36
    v_accvgpr_write_b32 a10, v37
    v_accvgpr_write_b32 a11, v38
    v_pk_sub_u16 v42, v82, s85
    v_pk_min_u16 v44, v44, v42
    v_pk_sub_u16 v42, v86, s85
    v_pk_min_u16 v44, v44, v42
    v_pk_sub_u16 v42, v90, s85
    v_pk_min_u16 v44, v44, v42
    v_pk_sub_u16 v42, v94, s85
    v_pk_min_u16 v44, v44, v42
    v_pk_sub_u16 v40, v82, s74 clamp
    v_pk_sub_u16 v41, v86, s74 clamp
    v_perm_b32 v32, v41, v40, s70
    v_perm_b32 v40, v41, v40, s71
    v_pk_sub_u16 v41, v90, s74 clamp
    v_pk_sub_u16 v42, v94, s74 clamp
    v_perm_b32 v33, v42, v41, s70
    v_perm_b32 v41, v42, v41, s71
    v_or3_b32 v43, v43, v40, v41
    v_alignbit_b32 v41, v41, v41, 4
    v_or_b32 v34, v40, v41
    v_accvgpr_write_b32 a12, v32
    v_accvgpr_write_b32 a13, v33
    v_accvgpr_write_b32 a14, v34
    v_pk_sub_u16 v42, v98, s85
    v_pk_min_u16 v44, v44, v42
    v_pk_sub_u16 v42, v102, s85
    v_pk_min_u16 v44, v44, v42
    v_pk_sub_u16 v42, v106, s85
    v_pk_min_u16 v44, v44, v42
    v_pk_sub_u16 v42, v110, s85
    v_pk_min_u16 v44, v44, v42
    v_pk_sub_u16 v40, v98, s74 clamp
    v_pk_sub_u16 v41, v102, s74 clamp
    v_perm_b32 v36, v41, v40, s70
    v_perm_b32 v40, v41, v40, s71
    v_pk_sub_u16 v41, v106, s74 clamp
    v_pk_sub_u16 v42, v110, s74 clamp
    v_perm_b32 v37, v42, v41, s70
    v_perm_b32 v41, v42, v41, s71
    v_or3_b32 v43, v43, v40, v41
    v_alignbit_b32 v41, v41, v41, 4
    v_or_b32 v38, v40, v41
    v_accvgpr_write_b32 a15, v36
    v_accvgpr_write_b32 a16, v37
    v_accvgpr_write_b32 a17, v38
    v_pk_sub_u16 v42, v83, s85
    v_pk_min_u16 v44, v44, v42
    v_pk_sub_u16 v42, v87, s85
    v_pk_min_u16 v44, v44, v42
    v_pk_sub_u16 v42, v91, s85
    v_pk_min_u16 v44, v44, v42
    v_pk_sub_u16 v42, v95, s85
    v_pk_min_u16 v44, v44, v42
    v_pk_sub_u16 v40, v83, s74 clamp
    v_pk_sub_u16 v41, v87, s74 clamp
    v_perm_b32 v32, v41, v40, s70
    v_perm_b32 v40, v41, v40, s71
    v_pk_sub_u16 v41, v91, s74 clamp
    v_pk_sub_u16 v42, v95, s74 clamp
    v_perm_b32 v33, v42, v41, s70
    v_perm_b32 v41, v42, v41, s71
    v_or3_b32 v43, v43, v40, v41
    v_alignbit_b32 v41, v41, v41, 4
    v_or_b32 v34, v40, v41
    v_accvgpr_write_b32 a18, v32
    v_accvgpr_write_b32 a19, v33
    v_accvgpr_write_b32 a20, v34
    v_pk_sub_u16 v42, v99, s85
    v_pk_min_u16 v44, v44, v42
    v_pk_sub_u16 v42, v103, s85
    v_pk_min_u16 v44, v44, v42
    v_pk_sub_u16 v42, v107, s85
    v_pk_min_u16 v44, v44, v42
    v_pk_sub_u16 v42, v111, s85
    v_pk_min_u16 v44, v44, v42
    v_pk_sub_u16 v40, v99, s74 clamp
    v_pk_sub_u16 v41, v103, s74 clamp
    v_perm_b32 v36, v41, v40, s70
    v_perm_b32 v40, v41, v40, s71
    v_pk_sub_u16 v41, v107, s74 clamp
    v_pk_sub_u16 v42, v111, s74 clamp
    v_perm_b32 v37, v42, v41, s70
    v_perm_b32 v41, v42, v41, s71
    v_or3_b32 v43, v43, v40, v41
    v_alignbit_b32 v41, v41, v41, 4
    v_or_b32 v38, v40, v41
    v_accvgpr_write_b32 a21, v36
    v_accvgpr_write_b32 a22, v37
    v_accvgpr_write_b32 a23, v38
    v_pk_sub_u16 v44, s74, v44 clamp
    v_and_b32 v43, 0x78787878, v43
    v_or_b32 v43, v43, v44
    v_cmp_ne_u32 vcc, 0, v43
    s_cbranch_vccnz L_xc_1
L_xcb_2:
    s_add_u32 s53, s99, 0x40000
    s_and_b32 s53, s53, 0x1fffff
    buffer_load_dwordx4 v[80:83], v3, s[12:15], s53 offen offset:0 nt
    buffer_load_dwordx4 v[84:87], v3, s[12:15], s53 offen offset:1024 nt
    buffer_load_dwordx4 v[88:91], v3, s[12:15], s53 offen offset:2048 nt
    buffer_load_dwordx4 v[92:95], v3, s[12:15], s53 offen offset:3072 nt
    s_add_u32 s53, s53, 0x1000
    buffer_load_dwordx4 v[96:99], v3, s[12:15], s53 offen offset:0 nt
    buffer_load_dwordx4 v[100:103], v3, s[12:15], s53 offen offset:1024 nt
    buffer_load_dwordx4 v[104:107], v3, s[12:15], s53 offen offset:2048 nt
    buffer_load_dwordx4 v[108:111], v3, s[12:15], s53 offen offset:3072 nt
    s_waitcnt vmcnt(8)
    v_pk_sub_u16 v44, v112, s85
    v_pk_sub_u16 v42, v116, s85
    v_pk_min_u16 v44, v44, v42
    v_pk_sub_u16 v42, v120, s85
    v_pk_min_u16 v44, v44, v42
    v_pk_sub_u16 v42, v124, s85
    v_pk_min_u16 v44, v44, v42
    v_pk_sub_u16 v40, v112, s74 clamp
    v_pk_sub_u16 v41, v116, s74 clamp
    v_perm_b32 v32, v41, v40, s70
    v_perm_b32 v40, v41, v40, s71
    v_pk_sub_u16 v41, v120, s74 clamp
    v_pk_sub_u16 v42, v124, s74 clamp
    v_perm_b32 v33, v42, v41, s70
    v_perm_b32 v41, v42, v41, s71
    v_or_b32 v43, v40, v41
    v_alignbit_b32 v41, v41, v41, 4
    v_or_b32 v34, v40, v41
    v_accvgpr_write_b32 a24, v32
    v_accvgpr_write_b32 a25, v33
    v_accvgpr_write_b32 a26, v34
    v_pk_sub_u16 v42, v128, s85
    v_pk_min_u16 v44, v44, v42
    v_pk_sub_u16 v42, v132, s85
    v_pk_min_u16 v44, v44, v42
    v_pk_sub_u16 v42, v136, s85
    v_pk_min_u16 v44, v44, v42
    v_pk_sub_u16 v42, v140, s85
    v_pk_min_u16 v44, v44, v42
    v_pk_sub_u16 v40, v128, s74 clamp
    v_pk_sub_u16 v41, v132, s74 clamp
    v_perm_b32 v36, v41, v40, s70
    v_perm_b32 v40, v41, v40, s71
    v_pk_sub_u16 v41, v136, s74 clamp
    v_pk_sub_u16 v42, v140, s74 clamp
    v_perm_b32 v37, v42, v41, s70
    v_perm_b32 v41, v42, v41, s71
    v_or3_b32 v43, v43, v40, v41
    v_alignbit_b32 v41, v41, v41, 4
    v_or_b32 v38, v40, v41
    v_accvgpr_write_b32 a27, v36
    v_accvgpr_write_b32 a28, v37
    v_accvgpr_write_b32 a29, v38
    v_pk_sub_u16 v42, v113, s85
    v_pk_min_u16 v44, v44, v42
    v_pk_sub_u16 v42, v117, s85
    v_pk_min_u16 v44, v44, v42
    v_pk_sub_u16 v42, v121, s85
    v_pk_min_u16 v44, v44, v42
    v_pk_sub_u16 v42, v125, s85
    v_pk_min_u16 v44, v44, v42
    v_pk_sub_u16 v40, v113, s74 clamp
    v_pk_sub_u16 v41, v117, s74 clamp
    v_perm_b32 v32, v41, v40, s70
    v_perm_b32 v40, v41, v40, s71
    v_pk_sub_u16 v41, v121, s74 clamp
    v_pk_sub_u16 v42, v125, s74 clamp
    v_perm_b32 v33, v42, v41, s70
    v_perm_b32 v41, v42, v41, s71
    v_or3_b32 v43, v43, v40, v41
    v_alignbit_b32 v41, v41, v41, 4
    v_or_b32 v144, v40, v41
    v_accvgpr_write_b32 a30, v32
    v_accvgpr_write_b32 a31, v33
    v_pk_sub_u16 v42, v129, s85
    v_pk_min_u16 v44, v44, v42
    v_pk_sub_u16 v42, v133, s85
    v_pk_min_u16 v44, v44, v42
    v_pk_sub_u16 v42, v137, s85
    v_pk_min_u16 v44, v44, v42
    v_pk_sub_u16 v42, v141, s85
    v_pk_min_u16 v44, v44, v42
    v_pk_sub_u16 v40, v129, s74 clamp
    v_pk_sub_u16 v41, v133, s74 clamp
    v_perm_b32 v145, v41, v40, s70
    v_perm_b32 v40, v41, v40, s71
    v_pk_sub_u16 v41, v137, s74 clamp
    v_pk_sub_u16 v42, v141, s74 clamp
    v_perm_b32 v146, v42, v41, s70
    v_perm_b32 v41, v42, v41, s71
    v_or3_b32 v43, v43, v40, v41
    v_alignbit_b32 v41, v41, v41, 4
    v_or_b32 v147, v40, v41
    v_pk_sub_u16 v42, v114, s85
    v_pk_min_u16 v44, v44, v42
    v_pk_sub_u16 v42, v118, s85
    v_pk_min_u16 v44, v44, v42
    v_pk_sub_u16 v42, v122, s85
    v_pk_min_u16 v44, v44, v42
    v_pk_sub_u16 v42, v126, s85
    v_pk_min_u16 v44, v44, v42
    v_pk_sub_u16 v40, v114, s74 clamp
    v_pk_sub_u16 v41, v118, s74 clamp
    v_perm_b32 v148, v41, v40, s70
    v_perm_b32 v40, v41, v40, s71
    v_pk_sub_u16 v41, v122, s74 clamp
    v_pk_sub_u16 v42, v126, s74 clamp
    v_perm_b32 v149, v42, v41, s70
    v_perm_b32 v41, v42, v41, s71
    v_or3_b32 v43, v43, v40, v41
    v_alignbit_b32 v41, v41, v41, 4
    v_or_b32 v150, v40, v41
    v_pk_sub_u16 v42, v130, s85
    v_pk_min_u16 v44, v44, v42
    v_pk_sub_u16 v42, v134, s85
    v_pk_min_u16 v44, v44, v42
    v_pk_sub_u16 v42, v138, s85
    v_pk_min_u16 v44, v44, v42
    v_pk_sub_u16 v42, v142, s85
    v_pk_min_u16 v44, v44, v42
    v_pk_sub_u16 v40, v130, s74 clamp
    v_pk_sub_u16 v41, v134, s74 clamp
    v_perm_b32 v151, v41, v40, s70
    v_perm_b32 v40, v41, v40, s71
    v_pk_sub_u16 v41, v138, s74 clamp
    v_pk_sub_u16 v42, v142, s74 clamp
    v_perm_b32 v152, v42, v41, s70
    v_perm_b32 v41, v42, v41, s71
    v_or3_b32 v43, v43, v40, v41
    v_alignbit_b32 v41, v41, v41, 4
    v_or_b32 v153, v40, v41
    v_pk_sub_u16 v42, v115, s85
    v_pk_min_u16 v44, v44, v42
    v_pk_sub_u16 v42, v119, s85
    v_pk_min_u16 v44, v44, v42
    v_pk_sub_u16 v42, v123, s85
    v_pk_min_u16 v44, v44, v42
    v_pk_sub_u16 v42, v127, s85
    v_pk_min_u16 v44, v44, v42
    v_pk_sub_u16 v40, v115, s74 clamp
    v_pk_sub_u16 v41, v119, s74 clamp
    v_perm_b32 v154, v41, v40, s70
    v_perm_b32 v40, v41, v40, s71
    v_pk_sub_u16 v41, v123, s74 clamp
    v_pk_sub_u16 v42, v127, s74 clamp
    v_perm_b32 v155, v42, v41, s70
    v_perm_b32 v41, v42, v41, s71
    v_or3_b32 v43, v43, v40, v41
    v_alignbit_b32 v41, v41, v41, 4
    v_or_b32 v156, v40, v41
    v_pk_sub_u16 v42, v131, s85
    v_pk_min_u16 v44, v44, v42
    v_pk_sub_u16 v42, v135, s85
    v_pk_min_u16 v44, v44, v42
    v_pk_sub_u16 v42, v139, s85
    v_pk_min_u16 v44, v44, v42
    v_pk_sub_u16 v42, v143, s85
    v_pk_min_u16 v44, v44, v42
    v_pk_sub_u16 v40, v131, s74 clamp
    v_pk_sub_u16 v41, v135, s74 clamp
    v_perm_b32 v157, v41, v40, s70
    v_perm_b32 v40, v41, v40, s71
    v_pk_sub_u16 v41, v139, s74 clamp
    v_pk_sub_u16 v42, v143, s74 clamp
    v_perm_b32 v158, v42, v41, s70
    v_perm_b32 v41, v42, v41, s71
    v_or3_b32 v43, v43, v40, v41
    v_alignbit_b32 v41, v41, v41, 4
    v_or_b32 v159, v40, v41
    v_pk_sub_u16 v44, s74, v44 clamp
    v_and_b32 v43, 0x78787878, v43
    v_or_b32 v43, v43, v44
    v_cmp_ne_u32 vcc, 0, v43
    s_cbranch_vccnz L_xc_4
L_xcb_5:
    s_add_u32 s53, s99, 0x60000
    s_and_b32 s53, s53, 0x1fffff
    buffer_load_dwordx4 v[112:115], v3, s[12:15], s53 offen offset:0 nt
    buffer_load_dwordx4 v[116:119], v3, s[12:15], s53 offen offset:1024 nt
    buffer_load_dwordx4 v[120:123], v3, s[12:15], s53 offen offset:2048 nt
    buffer_load_dwordx4 v[124:127], v3, s[12:15], s53 offen offset:3072 nt
    s_add_u32 s53, s53, 0x1000
    buffer_load_dwordx4 v[128:131], v3, s[12:15], s53 offen offset:0 nt
    buffer_load_dwordx4 v[132:135], v3, s[12:15], s53 offen offset:1024 nt
    buffer_load_dwordx4 v[136:139], v3, s[12:15], s53 offen offset:2048 nt
    buffer_load_dwordx4 v[140:143], v3, s[12:15], s53 offen offset:3072 nt
    s_waitcnt vmcnt(8)
    v_pk_sub_u16 v44, v80, s85
    v_pk_sub_u16 v42, v84, s85
    v_pk_min_u16 v44, v44, v42
    v_pk_sub_u16 v42, v88, s85
    v_pk_min_u16 v44, v44, v42
    v_pk_sub_u16 v42, v92, s85
    v_pk_min_u16 v44, v44, v42
    v_pk_sub_u16 v40, v80, s74 clamp
    v_pk_sub_u16 v41, v84, s74 clamp
    v_perm_b32 v160, v41, v40, s70
    v_perm_b32 v40, v41, v40, s71
    v_pk_sub_u16 v41, v88, s74 clamp
    v_pk_sub_u16 v42, v92, s74 clamp
    v_perm_b32 v161, v42, v41, s70
    v_perm_b32 v41, v42, v41, s71
    v_or_b32 v43, v40, v41
    v_alignbit_b32 v41, v41, v41, 4
    v_or_b32 v162, v40, v41
    v_pk_sub_u16 v42, v96, s85
    v_pk_min_u16 v44, v44, v42
    v_pk_sub_u16 v42, v100, s85
    v_pk_min_u16 v44, v44, v42
    v_pk_sub_u16 v42, v104, s85
    v_pk_min_u16 v44, v44, v42
    v_pk_sub_u16 v42, v108, s85
    v_pk_min_u16 v44, v44, v42
    v_pk_sub_u16 v40, v96, s74 clamp
    v_pk_sub_u16 v41, v100, s74 clamp
    v_perm_b32 v163, v41, v40, s70
    v_perm_b32 v40, v41, v40, s71
    v_pk_sub_u16 v41, v104, s74 clamp
    v_pk_sub_u16 v42, v108, s74 clamp
    v_perm_b32 v164, v42, v41, s70
    v_perm_b32 v41, v42, v41, s71
    v_or3_b32 v43, v43, v40, v41
    v_alignbit_b32 v41, v41, v41, 4
    v_or_b32 v165, v40, v41
    v_pk_sub_u16 v42, v81, s85
    v_pk_min_u16 v44, v44, v42
    v_pk_sub_u16 v42, v85, s85
    v_pk_min_u16 v44, v44, v42
    v_pk_sub_u16 v42, v89, s85
    v_pk_min_u16 v44, v44, v42
    v_pk_sub_u16 v42, v93, s85
    v_pk_min_u16 v44, v44, v42
    v_pk_sub_u16 v40, v81, s74 clamp
    v_pk_sub_u16 v41, v85, s74 clamp
    v_perm_b32 v166, v41, v40, s70
    v_perm_b32 v40, v41, v40, s71
    v_pk_sub_u16 v41, v89, s74 clamp
    v_pk_sub_u16 v42, v93, s74 clamp
    v_perm_b32 v167, v42, v41, s70
    v_perm_b32 v41, v42, v41, s71
    v_or3_b32 v43, v43, v40, v41
    v_alignbit_b32 v41, v41, v41, 4
    v_or_b32 v168, v40, v41
    v_pk_sub_u16 v42, v97, s85
    v_pk_min_u16 v44, v44, v42
    v_pk_sub_u16 v42, v101, s85
    v_pk_min_u16 v44, v44, v42
    v_pk_sub_u16 v42, v105, s85
    v_pk_min_u16 v44, v44, v42
    v_pk_sub_u16 v42, v109, s85
    v_pk_min_u16 v44, v44, v42
    v_pk_sub_u16 v40, v97, s74 clamp
    v_pk_sub_u16 v41, v101, s74 clamp
    v_perm_b32 v169, v41, v40, s70
    v_perm_b32 v40, v41, v40, s71
    v_pk_sub_u16 v41, v105, s74 clamp
    v_pk_sub_u16 v42, v109, s74 clamp
    v_perm_b32 v170, v42, v41, s70
    v_perm_b32 v41, v42, v41, s71
    v_or3_b32 v43, v43, v40, v41
    v_alignbit_b32 v41, v41, v41, 4
    v_or_b32 v171, v40, v41
    v_pk_sub_u16 v42, v82, s85
    v_pk_min_u16 v44, v44, v42
    v_pk_sub_u16 v42, v86, s85
    v_pk_min_u16 v44, v44, v42
    v_pk_sub_u16 v42, v90, s85
    v_pk_min_u16 v44, v44, v42
    v_pk_sub_u16 v42, v94, s85
    v_pk_min_u16 v44, v44, v42
    v_pk_sub_u16 v40, v82, s74 clamp
    v_pk_sub_u16 v41, v86, s74 clamp
    v_perm_b32 v172, v41, v40, s70
    v_perm_b32 v40, v41, v40, s71
    v_pk_sub_u16 v41, v90, s74 clamp
    v_pk_sub_u16 v42, v94, s74 clamp
    v_perm_b32 v173, v42, v41, s70
    v_perm_b32 v41, v42, v41, s71
    v_or3_b32 v43, v43, v40, v41
    v_alignbit_b32 v41, v41, v41, 4
    v_or_b32 v174, v40, v41
    v_pk_sub_u16 v42, v98, s85
    v_pk_min_u16 v44, v44, v42
    v_pk_sub_u16 v42, v102, s85
    v_pk_min_u16 v44, v44, v42
    v_pk_sub_u16 v42, v106, s85
    v_pk_min_u16 v44, v44, v42
    v_pk_sub_u16 v42, v110, s85
    v_pk_min_u16 v44, v44, v42
    v_pk_sub_u16 v40, v98, s74 clamp
    v_pk_sub_u16 v41, v102, s74 clamp
    v_perm_b32 v175, v41, v40, s70
    v_perm_b32 v40, v41, v40, s71
    v_pk_sub_u16 v41, v106, s74 clamp
    v_pk_sub_u16 v42, v110, s74 clamp
    v_perm_b32 v176, v42, v41, s70
    v_perm_b32 v41, v42, v41, s71
    v_or3_b32 v43, v43, v40, v41
    v_alignbit_b32 v41, v41, v41, 4
    v_or_b32 v177, v40, v41
    v_pk_sub_u16 v42, v83, s85
    v_pk_min_u16 v44, v44, v42
    v_pk_sub_u16 v42, v87, s85
    v_pk_min_u16 v44, v44, v42
    v_pk_sub_u16 v42, v91, s85
    v_pk_min_u16 v44, v44, v42
    v_pk_sub_u16 v42, v95, s85
    v_pk_min_u16 v44, v44, v42
    v_pk_sub_u16 v40, v83, s74 clamp
    v_pk_sub_u16 v41, v87, s74 clamp
    v_perm_b32 v178, v41, v40, s70
    v_perm_b32 v40, v41, v40, s71
    v_pk_sub_u16 v41, v91, s74 clamp
    v_pk_sub_u16 v42, v95, s74 clamp
    v_perm_b32 v179, v42, v41, s70
    v_perm_b32 v41, v42, v41, s71
    v_or3_b32 v43, v43, v40, v41
    v_alignbit_b32 v41, v41, v41, 4
    v_or_b32 v180, v40, v41
    v_pk_sub_u16 v42, v99, s85
    v_pk_min_u16 v44, v44, v42
    v_pk_sub_u16 v42, v103, s85
    v_pk_min_u16 v44, v44, v42
    v_pk_sub_u16 v42, v107, s85
    v_pk_min_u16 v44, v44, v42
    v_pk_sub_u16 v42, v111, s85
    v_pk_min_u16 v44, v44, v42
    v_pk_sub_u16 v40, v99, s74 clamp
    v_pk_sub_u16 v41, v103, s74 clamp
    v_perm_b32 v181, v41, v40, s70
    v_perm_b32 v40, v41, v40, s71
    v_pk_sub_u16 v41, v107, s74 clamp
    v_pk_sub_u16 v42, v111, s74 clamp
    v_perm_b32 v182, v42, v41, s70
    v_perm_b32 v41, v42, v41, s71
    v_or3_b32 v43, v43, v40, v41
    v_alignbit_b32 v41, v41, v41, 4
    v_or_b32 v183, v40, v41
    v_pk_sub_u16 v44, s74, v44 clamp
    v_and_b32 v43, 0x78787878, v43
    v_or_b32 v43, v43, v44
    v_cmp_ne_u32 vcc, 0, v43
    s_cbranch_vccnz L_xc_7
L_xcb_8:
    s_add_u32 s53, s99, 0x80000
    s_and_b32 s53, s53, 0x1fffff
    buffer_load_dwordx4 v[80:83], v3, s[12:15], s53 offen offset:0 nt
    buffer_load_dwordx4 v[84:87], v3, s[12:15], s53 offen offset:1024 nt
    buffer_load_dwordx4 v[88:91], v3, s[12:15], s53 offen offset:2048 nt
    buffer_load_dwordx4 v[92:95], v3, s[12:15], s53 offen offset:3072 nt
    s_add_u32 s53, s53, 0x1000
    buffer_load_dwordx4 v[96:99], v3, s[12:15], s53 offen offset:0 nt
    buffer_load_dwordx4 v[100:103], v3, s[12:15], s53 offen offset:1024 nt
    buffer_load_dwordx4 v[104:107], v3, s[12:15], s53 offen offset:2048 nt
    buffer_load_dwordx4 v[108:111], v3, s[12:15], s53 offen offset:3072 nt
    v_lshlrev_b32 v24, 16, v24
    v_lshlrev_b32 v25, 16, v25
    v_lshlrev_b32 v26, 16, v26
    v_lshlrev_b32 v27, 16, v27
    v_lshlrev_b32 v28, 16, v28
    v_lshlrev_b32 v29, 16, v29
    v_lshlrev_b32 v30, 16, v30
    v_lshlrev_b32 v31, 16, v31
    s_cmp_lg_u32 s52, 0
    s_cbranch_scc1 L_nox
    v_lshlrev_b32 v6, 2, v1
    ds_write_b32 v6, v24 offset:10496
    ds_write_b32 v6, v25 offset:10752
    ds_write_b32 v6, v26 offset:11008
    ds_write_b32 v6, v27 offset:11264
    ds_write_b32 v6, v28 offset:11520
    ds_write_b32 v6, v29 offset:11776
    ds_write_b32 v6, v30 offset:12032
    ds_write_b32 v6, v31 offset:12288
    s_waitcnt lgkmcnt(0)
L_nox:
    s_cmp_lt_u32 s52, 2
    s_cbranch_scc1 L_noq1
    v_lshlrev_b32 v240, 16, v240
    v_lshlrev_b32 v241, 16, v241
    v_lshlrev_b32 v242, 16, v242
    v_lshlrev_b32 v243, 16, v243
    v_lshlrev_b32 v244, 16, v244
    v_lshlrev_b32 v245, 16, v245
    v_lshlrev_b32 v246, 16, v246
    v_lshlrev_b32 v247, 16, v247
    v_perm_b32 v248, v52, v48, s57
    v_perm_b32 v52, v52, v48, s58
    v_perm_b32 v48, v53, v49, s57
    v_perm_b32 v53, v53, v49, s58
    v_perm_b32 v49, v54, v50, s57
    v_perm_b32 v54, v54, v50, s58
    v_perm_b32 v50, v55, v51, s57
    v_perm_b32 v55, v55, v51, s58
    v_perm_b32 v51, v60, v56, s57
    v_perm_b32 v60, v60, v56, s58
    v_perm_b32 v56, v61, v57, s57
    v_perm_b32 v61, v61, v57, s58
    v_perm_b32 v57, v62, v58, s57
    v_perm_b32 v62, v62, v58, s58
    v_perm_b32 v58, v63, v59, s57
    v_perm_b32 v63, v63, v59, s58
    v_perm_b32 v59, v68, v64, s57
    v_perm_b32 v68, v68, v64, s58
    v_perm_b32 v64, v69, v65, s57
    v_perm_b32 v69, v69, v65, s58
    v_perm_b32 v65, v70, v66, s57
    v_perm_b32 v70, v70, v66, s58
    v_perm_b32 v66, v71, v67, s57
    v_perm_b32 v71, v71, v67, s58
    v_perm_b32 v67, v76, v72, s57
    v_perm_b32 v76, v76, v72, s58
    v_perm_b32 v72, v77, v73, s57
    v_perm_b32 v77, v77, v73, s58
    v_perm_b32 v73, v78, v74, s57
    v_perm_b32 v78, v78, v74, s58
    v_perm_b32 v74, v79, v75, s57
    v_perm_b32 v79, v79, v75, s58
    v_readfirstlane_b32 s0, v24
    s_nop 1
    v_pk_add_f32 v[24:25], v[24:25], s[0:1] op_sel_hi:[1,0] neg_lo:[0,1] neg_hi:[0,1]
    v_pk_add_f32 v[26:27], v[26:27], s[0:1] op_sel_hi:[1,0] neg_lo:[0,1] neg_hi:[0,1]
    v_pk_add_f32 v[28:29], v[28:29], s[0:1] op_sel_hi:[1,0] neg_lo:[0,1] neg_hi:[0,1]
    v_pk_add_f32 v[30:31], v[30:31], s[0:1] op_sel_hi:[1,0] neg_lo:[0,1] neg_hi:[0,1]
    v_pk_mul_f32 v[36:37], v[24:25], v[24:25]
    v_pk_add_f32 v[38:39], v[24:25], v[26:27]
    v_pk_fma_f32 v[36:37], v[26:27], v[26:27], v[36:37]
    v_pk_add_f32 v[24:25], v[28:29], v[30:31]
    v_pk_fma_f32 v[36:37], v[28:29], v[28:29], v[36:37]
    v_pk_add_f32 v[38:39], v[38:39], v[24:25]
    v_pk_fma_f32 v[36:37], v[30:31], v[30:31], v[36:37]
    v_add_f32 v4, v38, v39
    v_add_f32 v5, v36, v37
    s_nop 0
    v_add_f32_dpp v4, v4, v4 quad_perm:[1,0,3,2] row_mask:0xf bank_mask:0xf
    v_add_f32_dpp v5, v5, v5 quad_perm:[1,0,3,2] row_mask:0xf bank_mask:0xf
    s_nop 0
    v_add_f32_dpp v4, v4, v4 quad_perm:[2,3,0,1] row_mask:0xf bank_mask:0xf
    v_add_f32_dpp v5, v5, v5 quad_perm:[2,3,0,1] row_mask:0xf bank_mask:0xf
    s_nop 0
    v_add_f32_dpp v4, v4, v4 row_ror:4 row_mask:0xf bank_mask:0xf
    v_add_f32_dpp v5, v5, v5 row_ror:4 row_mask:0xf bank_mask:0xf
    s_nop 0
    v_add_f32_dpp v4, v4, v4 row_ror:8 row_mask:0xf bank_mask:0xf
    v_add_f32_dpp v5, v5, v5 row_ror:8 row_mask:0xf bank_mask:0xf
    s_nop 0
    v_add_f32_dpp v4, v4, v4 row_bcast:15 row_mask:0xa bank_mask:0xf
    v_add_f32_dpp v5, v5, v5 row_bcast:15 row_mask:0xa bank_mask:0xf
    s_nop 0
    v_add_f32_dpp v4, v4, v4 row_bcast:31 row_mask:0xc bank_mask:0xf
    v_add_f32_dpp v5, v5, v5 row_bcast:31 row_mask:0xc bank_mask:0xf
    v_mul_f32 v4, 0x3b000000, v4
    v_mul_f32 v5, 0x3b000000, v5
    v_fma_f32 v5, -v4, v4, v5
    v_add_f32 v4, s0, v4
    v_max_f32 v5, 0, v5
    v_cvt_pk_bf16_f32 v6, v4, v5
    v_lshlrev_b32 v4, 16, v6
    v_and_b32 v5, s59, v6
    v_add_f32 v5, 0x3727c5ac, v5
    v_readlane_b32 s62, v4, 63
    v_cvt_pk_bf16_f32 v5, v5, v5
    v_lshlrev_b32 v5, 16, v5
    v_sqrt_f32 v5, v5
    s_waitcnt lgkmcnt(0)
    v_pk_add_f32 v[240:241], v[240:241], s[62:63] op_sel_hi:[1,0] neg_lo:[0,1] neg_hi:[0,1]
    v_pk_add_f32 v[242:243], v[242:243], s[62:63] op_sel_hi:[1,0] neg_lo:[0,1] neg_hi:[0,1]
    v_pk_add_f32 v[244:245], v[244:245], s[62:63] op_sel_hi:[1,0] neg_lo:[0,1] neg_hi:[0,1]
    v_pk_add_f32 v[246:247], v[246:247], s[62:63] op_sel_hi:[1,0] neg_lo:[0,1] neg_hi:[0,1]
    v_cvt_pk_bf16_f32 v5, v5, v5
    v_lshlrev_b32 v5, 16, v5
    v_rcp_f32 v6, v5
    v_cvt_pk_bf16_f32 v32, v240, v241
    v_cvt_pk_bf16_f32 v33, v242, v243
    v_cvt_pk_bf16_f32 v34, v244, v245
    v_cvt_pk_bf16_f32 v35, v246, v247
    v_readlane_b32 s64, v5, 63
    v_readlane_b32 s0, v6, 63
    v_lshlrev_b32 v240, 16, v32
    v_and_b32 v241, s59, v32
    v_lshlrev_b32 v242, 16, v33
    v_and_b32 v243, s59, v33
    v_lshlrev_b32 v244, 16, v34
    v_and_b32 v245, s59, v34
    v_lshlrev_b32 v246, 16, v35
    v_and_b32 v247, s59, v35
    v_pk_mul_f32 v[24:25], v[240:241], s[0:1] op_sel_hi:[1,0]
    v_pk_mul_f32 v[26:27], v[242:243], s[0:1] op_sel_hi:[1,0]
    v_pk_mul_f32 v[28:29], v[244:245], s[0:1] op_sel_hi:[1,0]
    v_pk_mul_f32 v[30:31], v[246:247], s[0:1] op_sel_hi:[1,0]
    v_pk_fma_f32 v[240:241], v[24:25], s[64:65], v[240:241] op_sel_hi:[1,0,1] neg_lo:[1,0,0] neg_hi:[1,0,0]
    v_pk_fma_f32 v[242:243], v[26:27], s[64:65], v[242:243] op_sel_hi:[1,0,1] neg_lo:[1,0,0] neg_hi:[1,0,0]
    v_pk_fma_f32 v[244:245], v[28:29], s[64:65], v[244:245] op_sel_hi:[1,0,1] neg_lo:[1,0,0] neg_hi:[1,0,0]
    v_pk_fma_f32 v[246:247], v[30:31], s[64:65], v[246:247] op_sel_hi:[1,0,1] neg_lo:[1,0,0] neg_hi:[1,0,0]
    v_pk_fma_f32 v[24:25], v[240:241], s[0:1], v[24:25] op_sel_hi:[1,0,1]
    v_pk_fma_f32 v[26:27], v[242:243], s[0:1], v[26:27] op_sel_hi:[1,0,1]
    v_pk_fma_f32 v[28:29], v[244:245], s[0:1], v[28:29] op_sel_hi:[1,0,1]
    v_pk_fma_f32 v[30:31], v[246:247], s[0:1], v[30:31] op_sel_hi:[1,0,1]
    v_cvt_pk_bf16_f32 v32, v24, v25
    v_cvt_pk_bf16_f32 v33, v26, v27
    v_cvt_pk_bf16_f32 v34, v28, v29
    v_cvt_pk_bf16_f32 v35, v30, v31
    s_lshl_b32 s68, s3, 8
    s_lshl_b32 s69, s52, 7
    s_add_u32 s68, s68, s69
    s_mov_b32 s69, 0xc0000
    s_cmp_lt_u32 s52, 2
    s_cselect_b32 s69, s69, 0xaff00
    s_add_u32 s68, s68, s69
    v_and_b32 v7, 3, v1
    v_lshlrev_b32 v7, 3, v7
    v_lshrrev_b32 v8, 4, v1
    v_lshl_add_u32 v7, v8, 5, v7
    v_add_u32 v7, s68, v7
    v_dot2_f32_bf16 v16, v248, v32, 0
    v_dot2_f32_bf16 v17, v52, v32, 0
    v_dot2_f32_bf16 v18, v48, v32, 0
    v_dot2_f32_bf16 v19, v53, v32, 0
    v_dot2_f32_bf16 v20, v49, v32, 0
    v_dot2_f32_bf16 v21, v54, v32, 0
    v_dot2_f32_bf16 v22, v50, v32, 0
    v_dot2_f32_bf16 v23, v55, v32, 0
    v_dot2c_f32_bf16 v16, v51, v33
    v_dot2c_f32_bf16 v17, v60, v33
    v_dot2c_f32_bf16 v18, v56, v33
    v_dot2c_f32_bf16 v19, v61, v33
    v_dot2c_f32_bf16 v20, v57, v33
    v_dot2c_f32_bf16 v21, v62, v33
    v_dot2c_f32_bf16 v22, v58, v33
    v_dot2c_f32_bf16 v23, v63, v33
    v_dot2c_f32_bf16 v16, v59, v34
    v_dot2c_f32_bf16 v17, v68, v34
    v_dot2c_f32_bf16 v18, v64, v34
    v_dot2c_f32_bf16 v19, v69, v34
    v_dot2c_f32_bf16 v20, v65, v34
    v_dot2c_f32_bf16 v21, v70, v34
    v_dot2c_f32_bf16 v22, v66, v34
    v_dot2c_f32_bf16 v23, v71, v34
    v_dot2c_f32_bf16 v16, v67, v35
    v_dot2c_f32_bf16 v17, v76, v35
    v_dot2c_f32_bf16 v18, v72, v35
    v_dot2c_f32_bf16 v19, v77, v35
    v_dot2c_f32_bf16 v20, v73, v35
    v_dot2c_f32_bf16 v21, v78, v35
    v_dot2c_f32_bf16 v22, v74, v35
    v_dot2c_f32_bf16 v23, v79, v35
    v_permlane32_swap_b32 v16, v20
    v_permlane32_swap_b32 v17, v21
    v_permlane32_swap_b32 v18, v22
    v_permlane32_swap_b32 v19, v23
    v_add_f32 v16, v16, v20
    v_add_f32 v17, v17, v21
    v_add_f32 v18, v18, v22
    v_add_f32 v19, v19, v23
    s_nop 0
    v_permlane16_swap_b32 v16, v18
    v_permlane16_swap_b32 v17, v19
    v_add_f32 v16, v16, v18
    v_add_f32 v17, v17, v19
    s_nop 0
    v_add_f32_dpp v16, v16, v16 row_ror:4 row_mask:0xf bank_mask:0xf
    v_add_f32_dpp v17, v17, v17 row_ror:4 row_mask:0xf bank_mask:0xf
    s_nop 0
    v_add_f32_dpp v16, v16, v16 row_ror:8 row_mask:0xf bank_mask:0xf
    v_add_f32_dpp v17, v17, v17 row_ror:8 row_mask:0xf bank_mask:0xf
    s_nop 0
    v_mov_b32_dpp v18, v16 quad_perm:[1,1,3,3] row_mask:0xf bank_mask:0xf
    v_mov_b32_dpp v19, v17 quad_perm:[1,1,3,3] row_mask:0xf bank_mask:0xf
    s_mov_b32 exec_lo, 0x50005
    s_mov_b32 exec_hi, 0x50005
    buffer_store_dwordx4 v[16:19], v7, s[16:19], 0 offen sc1
    s_mov_b64 exec, -1
L_noq1:
    s_waitcnt vmcnt(8)
    v_pk_sub_u16 v44, v112, s85
    v_pk_sub_u16 v42, v116, s85
    v_pk_min_u16 v44, v44, v42
    v_pk_sub_u16 v42, v120, s85
    v_pk_min_u16 v44, v44, v42
    v_pk_sub_u16 v42, v124, s85
    v_pk_min_u16 v44, v44, v42
    v_pk_sub_u16 v40, v112, s74 clamp
    v_pk_sub_u16 v41, v116, s74 clamp
    v_perm_b32 v48, v41, v40, s70
    v_perm_b32 v40, v41, v40, s71
    v_pk_sub_u16 v41, v120, s74 clamp
    v_pk_sub_u16 v42, v124, s74 clamp
    v_perm_b32 v49, v42, v41, s70
    v_perm_b32 v41, v42, v41, s71
    v_or_b32 v43, v40, v41
    v_alignbit_b32 v41, v41, v41, 4
    v_or_b32 v64, v40, v41
    v_pk_sub_u16 v42, v128, s85
    v_pk_min_u16 v44, v44, v42
    v_pk_sub_u16 v42, v132, s85
    v_pk_min_u16 v44, v44, v42
    v_pk_sub_u16 v42, v136, s85
    v_pk_min_u16 v44, v44, v42
    v_pk_sub_u16 v42, v140, s85
    v_pk_min_u16 v44, v44, v42
    v_pk_sub_u16 v40, v128, s74 clamp
    v_pk_sub_u16 v41, v132, s74 clamp
    v_perm_b32 v50, v41, v40, s70
    v_perm_b32 v40, v41, v40, s71
    v_pk_sub_u16 v41, v136, s74 clamp
    v_pk_sub_u16 v42, v140, s74 clamp
    v_perm_b32 v51, v42, v41, s70
    v_perm_b32 v41, v42, v41, s71
    v_or3_b32 v43, v43, v40, v41
    v_alignbit_b32 v41, v41, v41, 4
    v_or_b32 v65, v40, v41
    ds_write_b128 v9, v[48:51] offset:0
    v_pk_sub_u16 v42, v113, s85
    v_pk_min_u16 v44, v44, v42
    v_pk_sub_u16 v42, v117, s85
    v_pk_min_u16 v44, v44, v42
    v_pk_sub_u16 v42, v121, s85
    v_pk_min_u16 v44, v44, v42
    v_pk_sub_u16 v42, v125, s85
    v_pk_min_u16 v44, v44, v42
    v_pk_sub_u16 v40, v113, s74 clamp
    v_pk_sub_u16 v41, v117, s74 clamp
    v_perm_b32 v52, v41, v40, s70
    v_perm_b32 v40, v41, v40, s71
    v_pk_sub_u16 v41, v121, s74 clamp
    v_pk_sub_u16 v42, v125, s74 clamp
    v_perm_b32 v53, v42, v41, s70
    v_perm_b32 v41, v42, v41, s71
    v_or3_b32 v43, v43, v40, v41
    v_alignbit_b32 v41, v41, v41, 4
    v_or_b32 v66, v40, v41
    v_pk_sub_u16 v42, v129, s85
    v_pk_min_u16 v44, v44, v42
    v_pk_sub_u16 v42, v133, s85
    v_pk_min_u16 v44, v44, v42
    v_pk_sub_u16 v42, v137, s85
    v_pk_min_u16 v44, v44, v42
    v_pk_sub_u16 v42, v141, s85
    v_pk_min_u16 v44, v44, v42
    v_pk_sub_u16 v40, v129, s74 clamp
    v_pk_sub_u16 v41, v133, s74 clamp
    v_perm_b32 v54, v41, v40, s70
    v_perm_b32 v40, v41, v40, s71
    v_pk_sub_u16 v41, v137, s74 clamp
    v_pk_sub_u16 v42, v141, s74 clamp
    v_perm_b32 v55, v42, v41, s70
    v_perm_b32 v41, v42, v41, s71
    v_or3_b32 v43, v43, v40, v41
    v_alignbit_b32 v41, v41, v41, 4
    v_or_b32 v67, v40, v41
    ds_write_b128 v9, v[52:55] offset:1024
    ds_write_b128 v9, v[64:67] offset:4096
    v_pk_sub_u16 v42, v114, s85
    v_pk_min_u16 v44, v44, v42
    v_pk_sub_u16 v42, v118, s85
    v_pk_min_u16 v44, v44, v42
    v_pk_sub_u16 v42, v122, s85
    v_pk_min_u16 v44, v44, v42
    v_pk_sub_u16 v42, v126, s85
    v_pk_min_u16 v44, v44, v42
    v_pk_sub_u16 v40, v114, s74 clamp
    v_pk_sub_u16 v41, v118, s74 clamp
    v_perm_b32 v56, v41, v40, s70
    v_perm_b32 v40, v41, v40, s71
    v_pk_sub_u16 v41, v122, s74 clamp
    v_pk_sub_u16 v42, v126, s74 clamp
    v_perm_b32 v57, v42, v41, s70
    v_perm_b32 v41, v42, v41, s71
    v_or3_b32 v43, v43, v40, v41
    v_alignbit_b32 v41, v41, v41, 4
    v_or_b32 v68, v40, v41
    v_pk_sub_u16 v42, v130, s85
    v_pk_min_u16 v44, v44, v42
    v_pk_sub_u16 v42, v134, s85
    v_pk_min_u16 v44, v44, v42
    v_pk_sub_u16 v42, v138, s85
    v_pk_min_u16 v44, v44, v42
    v_pk_sub_u16 v42, v142, s85
    v_pk_min_u16 v44, v44, v42
    v_pk_sub_u16 v40, v130, s74 clamp
    v_pk_sub_u16 v41, v134, s74 clamp
    v_perm_b32 v58, v41, v40, s70
    v_perm_b32 v40, v41, v40, s71
    v_pk_sub_u16 v41, v138, s74 clamp
    v_pk_sub_u16 v42, v142, s74 clamp
    v_perm_b32 v59, v42, v41, s70
    v_perm_b32 v41, v42, v41, s71
    v_or3_b32 v43, v43, v40, v41
    v_alignbit_b32 v41, v41, v41, 4
    v_or_b32 v69, v40, v41
    ds_write_b128 v9, v[56:59] offset:2048
    v_pk_sub_u16 v42, v115, s85
    v_pk_min_u16 v44, v44, v42
    v_pk_sub_u16 v42, v119, s85
    v_pk_min_u16 v44, v44, v42
    v_pk_sub_u16 v42, v123, s85
    v_pk_min_u16 v44, v44, v42
    v_pk_sub_u16 v42, v127, s85
    v_pk_min_u16 v44, v44, v42
    v_pk_sub_u16 v40, v115, s74 clamp
    v_pk_sub_u16 v41, v119, s74 clamp
    v_perm_b32 v60, v41, v40, s70
    v_perm_b32 v40, v41, v40, s71
    v_pk_sub_u16 v41, v123, s74 clamp
    v_pk_sub_u16 v42, v127, s74 clamp
    v_perm_b32 v61, v42, v41, s70
    v_perm_b32 v41, v42, v41, s71
    v_or3_b32 v43, v43, v40, v41
    v_alignbit_b32 v41, v41, v41, 4
    v_or_b32 v70, v40, v41
    v_pk_sub_u16 v42, v131, s85
    v_pk_min_u16 v44, v44, v42
    v_pk_sub_u16 v42, v135, s85
    v_pk_min_u16 v44, v44, v42
    v_pk_sub_u16 v42, v139, s85
    v_pk_min_u16 v44, v44, v42
    v_pk_sub_u16 v42, v143, s85
    v_pk_min_u16 v44, v44, v42
    v_pk_sub_u16 v40, v131, s74 clamp
    v_pk_sub_u16 v41, v135, s74 clamp
    v_perm_b32 v62, v41, v40, s70
    v_perm_b32 v40, v41, v40, s71
    v_pk_sub_u16 v41, v139, s74 clamp
    v_pk_sub_u16 v42, v143, s74 clamp
    v_perm_b32 v63, v42, v41, s70
    v_perm_b32 v41, v42, v41, s71
    v_or3_b32 v43, v43, v40, v41
    v_alignbit_b32 v41, v41, v41, 4
    v_or_b32 v71, v40, v41
    ds_write_b128 v9, v[60:63] offset:3072
    ds_write_b128 v9, v[68:71] offset:5120
    v_pk_sub_u16 v44, s74, v44 clamp
    v_and_b32 v43, 0x78787878, v43
    v_or_b32 v43, v43, v44
    v_cmp_ne_u32 vcc, 0, v43
    s_cbranch_vccnz L_xc_10
L_xcb_11:
    s_add_u32 s53, s99, 0xa0000
    s_and_b32 s53, s53, 0x1fffff
    buffer_load_dwordx4 v[112:115], v3, s[12:15], s53 offen offset:0 nt
    buffer_load_dwordx4 v[116:119], v3, s[12:15], s53 offen offset:1024 nt
    buffer_load_dwordx4 v[120:123], v3, s[12:15], s53 offen offset:2048 nt
    buffer_load_dwordx4 v[124:127], v3, s[12:15], s53 offen offset:3072 nt
    s_add_u32 s53, s53, 0x1000
    buffer_load_dwordx4 v[128:131], v3, s[12:15], s53 offen offset:0 nt
    buffer_load_dwordx4 v[132:135], v3, s[12:15], s53 offen offset:1024 nt
    buffer_load_dwordx4 v[136:139], v3, s[12:15], s53 offen offset:2048 nt
    buffer_load_dwordx4 v[140:143], v3, s[12:15], s53 offen offset:3072 nt
    s_waitcnt vmcnt(8)
    s_waitcnt lgkmcnt(0)
    v_pk_sub_u16 v44, v80, s85
    v_pk_sub_u16 v42, v84, s85
    v_pk_min_u16 v44, v44, v42
    v_pk_sub_u16 v42, v88, s85
    v_pk_min_u16 v44, v44, v42
    v_pk_sub_u16 v42, v92, s85
    v_pk_min_u16 v44, v44, v42
    v_pk_sub_u16 v40, v80, s74 clamp
    v_pk_sub_u16 v41, v84, s74 clamp
    v_perm_b32 v48, v41, v40, s70
    v_perm_b32 v40, v41, v40, s71
    v_pk_sub_u16 v41, v88, s74 clamp
    v_pk_sub_u16 v42, v92, s74 clamp
    v_perm_b32 v49, v42, v41, s70
    v_perm_b32 v41, v42, v41, s71
    v_or_b32 v43, v40, v41
    v_alignbit_b32 v41, v41, v41, 4
    v_or_b32 v64, v40, v41
    v_pk_sub_u16 v42, v96, s85
    v_pk_min_u16 v44, v44, v42
    v_pk_sub_u16 v42, v100, s85
    v_pk_min_u16 v44, v44, v42
    v_pk_sub_u16 v42, v104, s85
    v_pk_min_u16 v44, v44, v42
    v_pk_sub_u16 v42, v108, s85
    v_pk_min_u16 v44, v44, v42
    v_pk_sub_u16 v40, v96, s74 clamp
    v_pk_sub_u16 v41, v100, s74 clamp
    v_perm_b32 v50, v41, v40, s70
    v_perm_b32 v40, v41, v40, s71
    v_pk_sub_u16 v41, v104, s74 clamp
    v_pk_sub_u16 v42, v108, s74 clamp
    v_perm_b32 v51, v42, v41, s70
    v_perm_b32 v41, v42, v41, s71
    v_or3_b32 v43, v43, v40, v41
    v_alignbit_b32 v41, v41, v41, 4
    v_or_b32 v65, v40, v41
    ds_write_b128 v9, v[48:51] offset:6144
    v_pk_sub_u16 v42, v81, s85
    v_pk_min_u16 v44, v44, v42
    v_pk_sub_u16 v42, v85, s85
    v_pk_min_u16 v44, v44, v42
    v_pk_sub_u16 v42, v89, s85
    v_pk_min_u16 v44, v44, v42
    v_pk_sub_u16 v42, v93, s85
    v_pk_min_u16 v44, v44, v42
    v_pk_sub_u16 v40, v81, s74 clamp
    v_pk_sub_u16 v41, v85, s74 clamp
    v_perm_b32 v52, v41, v40, s70
    v_perm_b32 v40, v41, v40, s71
    v_pk_sub_u16 v41, v89, s74 clamp
    v_pk_sub_u16 v42, v93, s74 clamp
    v_perm_b32 v53, v42, v41, s70
    v_perm_b32 v41, v42, v41, s71
    v_or3_b32 v43, v43, v40, v41
    v_alignbit_b32 v41, v41, v41, 4
    v_or_b32 v66, v40, v41
    v_pk_sub_u16 v42, v97, s85
    v_pk_min_u16 v44, v44, v42
    v_pk_sub_u16 v42, v101, s85
    v_pk_min_u16 v44, v44, v42
    v_pk_sub_u16 v42, v105, s85
    v_pk_min_u16 v44, v44, v42
    v_pk_sub_u16 v42, v109, s85
    v_pk_min_u16 v44, v44, v42
    v_pk_sub_u16 v40, v97, s74 clamp
    v_pk_sub_u16 v41, v101, s74 clamp
    v_perm_b32 v54, v41, v40, s70
    v_perm_b32 v40, v41, v40, s71
    v_pk_sub_u16 v41, v105, s74 clamp
    v_pk_sub_u16 v42, v109, s74 clamp
    v_perm_b32 v55, v42, v41, s70
    v_perm_b32 v41, v42, v41, s71
    v_or3_b32 v43, v43, v40, v41
    v_alignbit_b32 v41, v41, v41, 4
    v_or_b32 v67, v40, v41
    ds_write_b128 v9, v[52:55] offset:7168
    ds_write_b128 v9, v[64:67] offset:10240
    v_pk_sub_u16 v42, v82, s85
    v_pk_min_u16 v44, v44, v42
    v_pk_sub_u16 v42, v86, s85
    v_pk_min_u16 v44, v44, v42
    v_pk_sub_u16 v42, v90, s85
    v_pk_min_u16 v44, v44, v42
    v_pk_sub_u16 v42, v94, s85
    v_pk_min_u16 v44, v44, v42
    v_pk_sub_u16 v40, v82, s74 clamp
    v_pk_sub_u16 v41, v86, s74 clamp
    v_perm_b32 v56, v41, v40, s70
    v_perm_b32 v40, v41, v40, s71
    v_pk_sub_u16 v41, v90, s74 clamp
    v_pk_sub_u16 v42, v94, s74 clamp
    v_perm_b32 v57, v42, v41, s70
    v_perm_b32 v41, v42, v41, s71
    v_or3_b32 v43, v43, v40, v41
    v_alignbit_b32 v41, v41, v41, 4
    v_or_b32 v68, v40, v41
    v_pk_sub_u16 v42, v98, s85
    v_pk_min_u16 v44, v44, v42
    v_pk_sub_u16 v42, v102, s85
    v_pk_min_u16 v44, v44, v42
    v_pk_sub_u16 v42, v106, s85
    v_pk_min_u16 v44, v44, v42
    v_pk_sub_u16 v42, v110, s85
    v_pk_min_u16 v44, v44, v42
    v_pk_sub_u16 v40, v98, s74 clamp
    v_pk_sub_u16 v41, v102, s74 clamp
    v_perm_b32 v58, v41, v40, s70
    v_perm_b32 v40, v41, v40, s71
    v_pk_sub_u16 v41, v106, s74 clamp
    v_pk_sub_u16 v42, v110, s74 clamp
    v_perm_b32 v59, v42, v41, s70
    v_perm_b32 v41, v42, v41, s71
    v_or3_b32 v43, v43, v40, v41
    v_alignbit_b32 v41, v41, v41, 4
    v_or_b32 v69, v40, v41
    ds_write_b128 v9, v[56:59] offset:8192
    v_pk_sub_u16 v42, v83, s85
    v_pk_min_u16 v44, v44, v42
    v_pk_sub_u16 v42, v87, s85
    v_pk_min_u16 v44, v44, v42
    v_pk_sub_u16 v42, v91, s85
    v_pk_min_u16 v44, v44, v42
    v_pk_sub_u16 v42, v95, s85
    v_pk_min_u16 v44, v44, v42
    v_pk_sub_u16 v40, v83, s74 clamp
    v_pk_sub_u16 v41, v87, s74 clamp
    v_perm_b32 v60, v41, v40, s70
    v_perm_b32 v40, v41, v40, s71
    v_pk_sub_u16 v41, v91, s74 clamp
    v_pk_sub_u16 v42, v95, s74 clamp
    v_perm_b32 v61, v42, v41, s70
    v_perm_b32 v41, v42, v41, s71
    v_or3_b32 v43, v43, v40, v41
    v_alignbit_b32 v41, v41, v41, 4
    v_or_b32 v70, v40, v41
    v_pk_sub_u16 v42, v99, s85
    v_pk_min_u16 v44, v44, v42
    v_pk_sub_u16 v42, v103, s85
    v_pk_min_u16 v44, v44, v42
    v_pk_sub_u16 v42, v107, s85
    v_pk_min_u16 v44, v44, v42
    v_pk_sub_u16 v42, v111, s85
    v_pk_min_u16 v44, v44, v42
    v_pk_sub_u16 v40, v99, s74 clamp
    v_pk_sub_u16 v41, v103, s74 clamp
    v_perm_b32 v62, v41, v40, s70
    v_perm_b32 v40, v41, v40, s71
    v_pk_sub_u16 v41, v107, s74 clamp
    v_pk_sub_u16 v42, v111, s74 clamp
    v_perm_b32 v63, v42, v41, s70
    v_perm_b32 v41, v42, v41, s71
    v_or3_b32 v43, v43, v40, v41
    v_alignbit_b32 v41, v41, v41, 4
    v_or_b32 v71, v40, v41
    ds_write_b128 v9, v[60:63] offset:9216
    ds_write_b128 v9, v[68:71] offset:11264
    v_pk_sub_u16 v44, s74, v44 clamp
    v_and_b32 v43, 0x78787878, v43
    v_or_b32 v43, v43, v44
    v_cmp_ne_u32 vcc, 0, v43
    s_cbranch_vccnz L_xc_13
L_xcb_14:
    s_add_u32 s53, s99, 0xc0000
    s_and_b32 s53, s53, 0x1fffff
    buffer_load_dwordx4 v[80:83], v3, s[12:15], s53 offen offset:0 nt
    buffer_load_dwordx4 v[84:87], v3, s[12:15], s53 offen offset:1024 nt
    buffer_load_dwordx4 v[88:91], v3, s[12:15], s53 offen offset:2048 nt
    buffer_load_dwordx4 v[92:95], v3, s[12:15], s53 offen offset:3072 nt
    s_add_u32 s53, s53, 0x1000
    buffer_load_dwordx4 v[96:99], v3, s[12:15], s53 offen offset:0 nt
    buffer_load_dwordx4 v[100:103], v3, s[12:15], s53 offen offset:1024 nt
    buffer_load_dwordx4 v[104:107], v3, s[12:15], s53 offen offset:2048 nt
    buffer_load_dwordx4 v[108:111], v3, s[12:15], s53 offen offset:3072 nt
    s_barrier
    s_cmp_lg_u32 s52, 0
    s_cbranch_scc1 L_noarr
    v_mov_b32 v4, 0
    v_mov_b32 v5, 1
    s_mov_b64 exec, 1
    buffer_atomic_add v5, v4, s[48:51], 0 offen sc1
    s_mov_b64 exec, -1
L_noarr:
    s_waitcnt vmcnt(8)
    s_waitcnt lgkmcnt(0)
    v_pk_sub_u16 v44, v112, s85
    v_pk_sub_u16 v42, v116, s85
    v_pk_min_u16 v44, v44, v42
    v_pk_sub_u16 v42, v120, s85
    v_pk_min_u16 v44, v44, v42
    v_pk_sub_u16 v42, v124, s85
    v_pk_min_u16 v44, v44, v42
    v_pk_sub_u16 v40, v112, s74 clamp
    v_pk_sub_u16 v41, v116, s74 clamp
    v_perm_b32 v48, v41, v40, s70
    v_perm_b32 v40, v41, v40, s71
    v_pk_sub_u16 v41, v120, s74 clamp
    v_pk_sub_u16 v42, v124, s74 clamp
    v_perm_b32 v49, v42, v41, s70
    v_perm_b32 v41, v42, v41, s71
    v_or_b32 v43, v40, v41
    v_alignbit_b32 v41, v41, v41, 4
    v_or_b32 v64, v40, v41
    v_pk_sub_u16 v42, v128, s85
    v_pk_min_u16 v44, v44, v42
    v_pk_sub_u16 v42, v132, s85
    v_pk_min_u16 v44, v44, v42
    v_pk_sub_u16 v42, v136, s85
    v_pk_min_u16 v44, v44, v42
    v_pk_sub_u16 v42, v140, s85
    v_pk_min_u16 v44, v44, v42
    v_pk_sub_u16 v40, v128, s74 clamp
    v_pk_sub_u16 v41, v132, s74 clamp
    v_perm_b32 v50, v41, v40, s70
    v_perm_b32 v40, v41, v40, s71
    v_pk_sub_u16 v41, v136, s74 clamp
    v_pk_sub_u16 v42, v140, s74 clamp
    v_perm_b32 v51, v42, v41, s70
    v_perm_b32 v41, v42, v41, s71
    v_or3_b32 v43, v43, v40, v41
    v_alignbit_b32 v41, v41, v41, 4
    v_or_b32 v65, v40, v41
    ds_write_b128 v9, v[48:51] offset:12288
    v_pk_sub_u16 v42, v113, s85
    v_pk_min_u16 v44, v44, v42
    v_pk_sub_u16 v42, v117, s85
    v_pk_min_u16 v44, v44, v42
    v_pk_sub_u16 v42, v121, s85
    v_pk_min_u16 v44, v44, v42
    v_pk_sub_u16 v42, v125, s85
    v_pk_min_u16 v44, v44, v42
    v_pk_sub_u16 v40, v113, s74 clamp
    v_pk_sub_u16 v41, v117, s74 clamp
    v_perm_b32 v52, v41, v40, s70
    v_perm_b32 v40, v41, v40, s71
    v_pk_sub_u16 v41, v121, s74 clamp
    v_pk_sub_u16 v42, v125, s74 clamp
    v_perm_b32 v53, v42, v41, s70
    v_perm_b32 v41, v42, v41, s71
    v_or3_b32 v43, v43, v40, v41
    v_alignbit_b32 v41, v41, v41, 4
    v_or_b32 v66, v40, v41
    v_pk_sub_u16 v42, v129, s85
    v_pk_min_u16 v44, v44, v42
    v_pk_sub_u16 v42, v133, s85
    v_pk_min_u16 v44, v44, v42
    v_pk_sub_u16 v42, v137, s85
    v_pk_min_u16 v44, v44, v42
    v_pk_sub_u16 v42, v141, s85
    v_pk_min_u16 v44, v44, v42
    v_pk_sub_u16 v40, v129, s74 clamp
    v_pk_sub_u16 v41, v133, s74 clamp
    v_perm_b32 v54, v41, v40, s70
    v_perm_b32 v40, v41, v40, s71
    v_pk_sub_u16 v41, v137, s74 clamp
    v_pk_sub_u16 v42, v141, s74 clamp
    v_perm_b32 v55, v42, v41, s70
    v_perm_b32 v41, v42, v41, s71
    v_or3_b32 v43, v43, v40, v41
    v_alignbit_b32 v41, v41, v41, 4
    v_or_b32 v67, v40, v41
    ds_write_b128 v9, v[52:55] offset:13312
    ds_write_b128 v9, v[64:67] offset:16384
    v_pk_sub_u16 v42, v114, s85
    v_pk_min_u16 v44, v44, v42
    v_pk_sub_u16 v42, v118, s85
    v_pk_min_u16 v44, v44, v42
    v_pk_sub_u16 v42, v122, s85
    v_pk_min_u16 v44, v44, v42
    v_pk_sub_u16 v42, v126, s85
    v_pk_min_u16 v44, v44, v42
    v_pk_sub_u16 v40, v114, s74 clamp
    v_pk_sub_u16 v41, v118, s74 clamp
    v_perm_b32 v56, v41, v40, s70
    v_perm_b32 v40, v41, v40, s71
    v_pk_sub_u16 v41, v122, s74 clamp
    v_pk_sub_u16 v42, v126, s74 clamp
    v_perm_b32 v57, v42, v41, s70
    v_perm_b32 v41, v42, v41, s71
    v_or3_b32 v43, v43, v40, v41
    v_alignbit_b32 v41, v41, v41, 4
    v_or_b32 v68, v40, v41
    v_pk_sub_u16 v42, v130, s85
    v_pk_min_u16 v44, v44, v42
    v_pk_sub_u16 v42, v134, s85
    v_pk_min_u16 v44, v44, v42
    v_pk_sub_u16 v42, v138, s85
    v_pk_min_u16 v44, v44, v42
    v_pk_sub_u16 v42, v142, s85
    v_pk_min_u16 v44, v44, v42
    v_pk_sub_u16 v40, v130, s74 clamp
    v_pk_sub_u16 v41, v134, s74 clamp
    v_perm_b32 v58, v41, v40, s70
    v_perm_b32 v40, v41, v40, s71
    v_pk_sub_u16 v41, v138, s74 clamp
    v_pk_sub_u16 v42, v142, s74 clamp
    v_perm_b32 v59, v42, v41, s70
    v_perm_b32 v41, v42, v41, s71
    v_or3_b32 v43, v43, v40, v41
    v_alignbit_b32 v41, v41, v41, 4
    v_or_b32 v69, v40, v41
    ds_write_b128 v9, v[56:59] offset:14336
    v_pk_sub_u16 v42, v115, s85
    v_pk_min_u16 v44, v44, v42
    v_pk_sub_u16 v42, v119, s85
    v_pk_min_u16 v44, v44, v42
    v_pk_sub_u16 v42, v123, s85
    v_pk_min_u16 v44, v44, v42
    v_pk_sub_u16 v42, v127, s85
    v_pk_min_u16 v44, v44, v42
    v_pk_sub_u16 v40, v115, s74 clamp
    v_pk_sub_u16 v41, v119, s74 clamp
    v_perm_b32 v60, v41, v40, s70
    v_perm_b32 v40, v41, v40, s71
    v_pk_sub_u16 v41, v123, s74 clamp
    v_pk_sub_u16 v42, v127, s74 clamp
    v_perm_b32 v61, v42, v41, s70
    v_perm_b32 v41, v42, v41, s71
    v_or3_b32 v43, v43, v40, v41
    v_alignbit_b32 v41, v41, v41, 4
    v_or_b32 v70, v40, v41
    v_pk_sub_u16 v42, v131, s85
    v_pk_min_u16 v44, v44, v42
    v_pk_sub_u16 v42, v135, s85
    v_pk_min_u16 v44, v44, v42
    v_pk_sub_u16 v42, v139, s85
    v_pk_min_u16 v44, v44, v42
    v_pk_sub_u16 v42, v143, s85
    v_pk_min_u16 v44, v44, v42
    v_pk_sub_u16 v40, v131, s74 clamp
    v_pk_sub_u16 v41, v135, s74 clamp
    v_perm_b32 v62, v41, v40, s70
    v_perm_b32 v40, v41, v40, s71
    v_pk_sub_u16 v41, v139, s74 clamp
    v_pk_sub_u16 v42, v143, s74 clamp
    v_perm_b32 v63, v42, v41, s70
    v_perm_b32 v41, v42, v41, s71
    v_or3_b32 v43, v43, v40, v41
    v_alignbit_b32 v41, v41, v41, 4
    v_or_b32 v71, v40, v41
    ds_write_b128 v9, v[60:63] offset:15360
    ds_write_b128 v9, v[68:71] offset:17408
    v_pk_sub_u16 v44, s74, v44 clamp
    v_and_b32 v43, 0x78787878, v43
    v_or_b32 v43, v43, v44
    v_cmp_ne_u32 vcc, 0, v43
    s_cbranch_vccnz L_xc_16
L_xcb_17:
    s_add_u32 s53, s99, 0xe0000
    s_and_b32 s53, s53, 0x1fffff
    buffer_load_dwordx4 v[112:115], v3, s[12:15], s53 offen offset:0 nt
    buffer_load_dwordx4 v[116:119], v3, s[12:15], s53 offen offset:1024 nt
    buffer_load_dwordx4 v[120:123], v3, s[12:15], s53 offen offset:2048 nt
    buffer_load_dwordx4 v[124:127], v3, s[12:15], s53 offen offset:3072 nt
    s_add_u32 s53, s53, 0x1000
    buffer_load_dwordx4 v[128:131], v3, s[12:15], s53 offen offset:0 nt
    buffer_load_dwordx4 v[132:135], v3, s[12:15], s53 offen offset:1024 nt
    buffer_load_dwordx4 v[136:139], v3, s[12:15], s53 offen offset:2048 nt
    buffer_load_dwordx4 v[140:143], v3, s[12:15], s53 offen offset:3072 nt
    s_waitcnt vmcnt(8)
    s_waitcnt lgkmcnt(0)
    v_pk_sub_u16 v44, v80, s85
    v_pk_sub_u16 v42, v84, s85
    v_pk_min_u16 v44, v44, v42
    v_pk_sub_u16 v42, v88, s85
    v_pk_min_u16 v44, v44, v42
    v_pk_sub_u16 v42, v92, s85
    v_pk_min_u16 v44, v44, v42
    v_pk_sub_u16 v40, v80, s74 clamp
    v_pk_sub_u16 v41, v84, s74 clamp
    v_perm_b32 v48, v41, v40, s70
    v_perm_b32 v40, v41, v40, s71
    v_pk_sub_u16 v41, v88, s74 clamp
    v_pk_sub_u16 v42, v92, s74 clamp
    v_perm_b32 v49, v42, v41, s70
    v_perm_b32 v41, v42, v41, s71
    v_or_b32 v43, v40, v41
    v_alignbit_b32 v41, v41, v41, 4
    v_or_b32 v64, v40, v41
    v_pk_sub_u16 v42, v96, s85
    v_pk_min_u16 v44, v44, v42
    v_pk_sub_u16 v42, v100, s85
    v_pk_min_u16 v44, v44, v42
    v_pk_sub_u16 v42, v104, s85
    v_pk_min_u16 v44, v44, v42
    v_pk_sub_u16 v42, v108, s85
    v_pk_min_u16 v44, v44, v42
    v_pk_sub_u16 v40, v96, s74 clamp
    v_pk_sub_u16 v41, v100, s74 clamp
    v_perm_b32 v50, v41, v40, s70
    v_perm_b32 v40, v41, v40, s71
    v_pk_sub_u16 v41, v104, s74 clamp
    v_pk_sub_u16 v42, v108, s74 clamp
    v_perm_b32 v51, v42, v41, s70
    v_perm_b32 v41, v42, v41, s71
    v_or3_b32 v43, v43, v40, v41
    v_alignbit_b32 v41, v41, v41, 4
    v_or_b32 v65, v40, v41
    ds_write_b128 v9, v[48:51] offset:18432
    v_pk_sub_u16 v42, v81, s85
    v_pk_min_u16 v44, v44, v42
    v_pk_sub_u16 v42, v85, s85
    v_pk_min_u16 v44, v44, v42
    v_pk_sub_u16 v42, v89, s85
    v_pk_min_u16 v44, v44, v42
    v_pk_sub_u16 v42, v93, s85
    v_pk_min_u16 v44, v44, v42
    v_pk_sub_u16 v40, v81, s74 clamp
    v_pk_sub_u16 v41, v85, s74 clamp
    v_perm_b32 v52, v41, v40, s70
    v_perm_b32 v40, v41, v40, s71
    v_pk_sub_u16 v41, v89, s74 clamp
    v_pk_sub_u16 v42, v93, s74 clamp
    v_perm_b32 v53, v42, v41, s70
    v_perm_b32 v41, v42, v41, s71
    v_or3_b32 v43, v43, v40, v41
    v_alignbit_b32 v41, v41, v41, 4
    v_or_b32 v66, v40, v41
    v_pk_sub_u16 v42, v97, s85
    v_pk_min_u16 v44, v44, v42
    v_pk_sub_u16 v42, v101, s85
    v_pk_min_u16 v44, v44, v42
    v_pk_sub_u16 v42, v105, s85
    v_pk_min_u16 v44, v44, v42
    v_pk_sub_u16 v42, v109, s85
    v_pk_min_u16 v44, v44, v42
    v_pk_sub_u16 v40, v97, s74 clamp
    v_pk_sub_u16 v41, v101, s74 clamp
    v_perm_b32 v54, v41, v40, s70
    v_perm_b32 v40, v41, v40, s71
    v_pk_sub_u16 v41, v105, s74 clamp
    v_pk_sub_u16 v42, v109, s74 clamp
    v_perm_b32 v55, v42, v41, s70
    v_perm_b32 v41, v42, v41, s71
    v_or3_b32 v43, v43, v40, v41
    v_alignbit_b32 v41, v41, v41, 4
    v_or_b32 v67, v40, v41
    ds_write_b128 v9, v[52:55] offset:19456
    ds_write_b128 v9, v[64:67] offset:22528
    v_pk_sub_u16 v42, v82, s85
    v_pk_min_u16 v44, v44, v42
    v_pk_sub_u16 v42, v86, s85
    v_pk_min_u16 v44, v44, v42
    v_pk_sub_u16 v42, v90, s85
    v_pk_min_u16 v44, v44, v42
    v_pk_sub_u16 v42, v94, s85
    v_pk_min_u16 v44, v44, v42
    v_pk_sub_u16 v40, v82, s74 clamp
    v_pk_sub_u16 v41, v86, s74 clamp
    v_perm_b32 v56, v41, v40, s70
    v_perm_b32 v40, v41, v40, s71
    v_pk_sub_u16 v41, v90, s74 clamp
    v_pk_sub_u16 v42, v94, s74 clamp
    v_perm_b32 v57, v42, v41, s70
    v_perm_b32 v41, v42, v41, s71
    v_or3_b32 v43, v43, v40, v41
    v_alignbit_b32 v41, v41, v41, 4
    v_or_b32 v68, v40, v41
    v_pk_sub_u16 v42, v98, s85
    v_pk_min_u16 v44, v44, v42
    v_pk_sub_u16 v42, v102, s85
    v_pk_min_u16 v44, v44, v42
    v_pk_sub_u16 v42, v106, s85
    v_pk_min_u16 v44, v44, v42
    v_pk_sub_u16 v42, v110, s85
    v_pk_min_u16 v44, v44, v42
    v_pk_sub_u16 v40, v98, s74 clamp
    v_pk_sub_u16 v41, v102, s74 clamp
    v_perm_b32 v58, v41, v40, s70
    v_perm_b32 v40, v41, v40, s71
    v_pk_sub_u16 v41, v106, s74 clamp
    v_pk_sub_u16 v42, v110, s74 clamp
    v_perm_b32 v59, v42, v41, s70
    v_perm_b32 v41, v42, v41, s71
    v_or3_b32 v43, v43, v40, v41
    v_alignbit_b32 v41, v41, v41, 4
    v_or_b32 v69, v40, v41
    ds_write_b128 v9, v[56:59] offset:20480
    v_pk_sub_u16 v42, v83, s85
    v_pk_min_u16 v44, v44, v42
    v_pk_sub_u16 v42, v87, s85
    v_pk_min_u16 v44, v44, v42
    v_pk_sub_u16 v42, v91, s85
    v_pk_min_u16 v44, v44, v42
    v_pk_sub_u16 v42, v95, s85
    v_pk_min_u16 v44, v44, v42
    v_pk_sub_u16 v40, v83, s74 clamp
    v_pk_sub_u16 v41, v87, s74 clamp
    v_perm_b32 v60, v41, v40, s70
    v_perm_b32 v40, v41, v40, s71
    v_pk_sub_u16 v41, v91, s74 clamp
    v_pk_sub_u16 v42, v95, s74 clamp
    v_perm_b32 v61, v42, v41, s70
    v_perm_b32 v41, v42, v41, s71
    v_or3_b32 v43, v43, v40, v41
    v_alignbit_b32 v41, v41, v41, 4
    v_or_b32 v70, v40, v41
    v_pk_sub_u16 v42, v99, s85
    v_pk_min_u16 v44, v44, v42
    v_pk_sub_u16 v42, v103, s85
    v_pk_min_u16 v44, v44, v42
    v_pk_sub_u16 v42, v107, s85
    v_pk_min_u16 v44, v44, v42
    v_pk_sub_u16 v42, v111, s85
    v_pk_min_u16 v44, v44, v42
    v_pk_sub_u16 v40, v99, s74 clamp
    v_pk_sub_u16 v41, v103, s74 clamp
    v_perm_b32 v62, v41, v40, s70
    v_perm_b32 v40, v41, v40, s71
    v_pk_sub_u16 v41, v107, s74 clamp
    v_pk_sub_u16 v42, v111, s74 clamp
    v_perm_b32 v63, v42, v41, s70
    v_perm_b32 v41, v42, v41, s71
    v_or3_b32 v43, v43, v40, v41
    v_alignbit_b32 v41, v41, v41, 4
    v_or_b32 v71, v40, v41
    ds_write_b128 v9, v[60:63] offset:21504
    ds_write_b128 v9, v[68:71] offset:23552
    v_pk_sub_u16 v44, s74, v44 clamp
    v_and_b32 v43, 0x78787878, v43
    v_or_b32 v43, v43, v44
    v_cmp_ne_u32 vcc, 0, v43
    s_cbranch_vccnz L_xc_19
L_xcb_20:
    s_add_u32 s53, s99, 0x100000
    s_and_b32 s53, s53, 0x1fffff
    buffer_load_dwordx4 v[80:83], v3, s[12:15], s53 offen offset:0 nt
    buffer_load_dwordx4 v[84:87], v3, s[12:15], s53 offen offset:1024 nt
    buffer_load_dwordx4 v[88:91], v3, s[12:15], s53 offen offset:2048 nt
    buffer_load_dwordx4 v[92:95], v3, s[12:15], s53 offen offset:3072 nt
    s_add_u32 s53, s53, 0x1000
    buffer_load_dwordx4 v[96:99], v3, s[12:15], s53 offen offset:0 nt
    buffer_load_dwordx4 v[100:103], v3, s[12:15], s53 offen offset:1024 nt
    buffer_load_dwordx4 v[104:107], v3, s[12:15], s53 offen offset:2048 nt
    buffer_load_dwordx4 v[108:111], v3, s[12:15], s53 offen offset:3072 nt
    s_waitcnt vmcnt(8)
    s_waitcnt lgkmcnt(0)
    v_pk_sub_u16 v44, v112, s85
    v_pk_sub_u16 v42, v116, s85
    v_pk_min_u16 v44, v44, v42
    v_pk_sub_u16 v42, v120, s85
    v_pk_min_u16 v44, v44, v42
    v_pk_sub_u16 v42, v124, s85
    v_pk_min_u16 v44, v44, v42
    v_pk_sub_u16 v40, v112, s74 clamp
    v_pk_sub_u16 v41, v116, s74 clamp
    v_perm_b32 v48, v41, v40, s70
    v_perm_b32 v40, v41, v40, s71
    v_pk_sub_u16 v41, v120, s74 clamp
    v_pk_sub_u16 v42, v124, s74 clamp
    v_perm_b32 v49, v42, v41, s70
    v_perm_b32 v41, v42, v41, s71
    v_or_b32 v43, v40, v41
    v_alignbit_b32 v41, v41, v41, 4
    v_or_b32 v64, v40, v41
    v_pk_sub_u16 v42, v128, s85
    v_pk_min_u16 v44, v44, v42
    v_pk_sub_u16 v42, v132, s85
    v_pk_min_u16 v44, v44, v42
    v_pk_sub_u16 v42, v136, s85
    v_pk_min_u16 v44, v44, v42
    v_pk_sub_u16 v42, v140, s85
    v_pk_min_u16 v44, v44, v42
    v_pk_sub_u16 v40, v128, s74 clamp
    v_pk_sub_u16 v41, v132, s74 clamp
    v_perm_b32 v50, v41, v40, s70
    v_perm_b32 v40, v41, v40, s71
    v_pk_sub_u16 v41, v136, s74 clamp
    v_pk_sub_u16 v42, v140, s74 clamp
    v_perm_b32 v51, v42, v41, s70
    v_perm_b32 v41, v42, v41, s71
    v_or3_b32 v43, v43, v40, v41
    v_alignbit_b32 v41, v41, v41, 4
    v_or_b32 v65, v40, v41
    ds_write_b128 v9, v[48:51] offset:24576
    v_pk_sub_u16 v42, v113, s85
    v_pk_min_u16 v44, v44, v42
    v_pk_sub_u16 v42, v117, s85
    v_pk_min_u16 v44, v44, v42
    v_pk_sub_u16 v42, v121, s85
    v_pk_min_u16 v44, v44, v42
    v_pk_sub_u16 v42, v125, s85
    v_pk_min_u16 v44, v44, v42
    v_pk_sub_u16 v40, v113, s74 clamp
    v_pk_sub_u16 v41, v117, s74 clamp
    v_perm_b32 v52, v41, v40, s70
    v_perm_b32 v40, v41, v40, s71
    v_pk_sub_u16 v41, v121, s74 clamp
    v_pk_sub_u16 v42, v125, s74 clamp
    v_perm_b32 v53, v42, v41, s70
    v_perm_b32 v41, v42, v41, s71
    v_or3_b32 v43, v43, v40, v41
    v_alignbit_b32 v41, v41, v41, 4
    v_or_b32 v66, v40, v41
    v_pk_sub_u16 v42, v129, s85
    v_pk_min_u16 v44, v44, v42
    v_pk_sub_u16 v42, v133, s85
    v_pk_min_u16 v44, v44, v42
    v_pk_sub_u16 v42, v137, s85
    v_pk_min_u16 v44, v44, v42
    v_pk_sub_u16 v42, v141, s85
    v_pk_min_u16 v44, v44, v42
    v_pk_sub_u16 v40, v129, s74 clamp
    v_pk_sub_u16 v41, v133, s74 clamp
    v_perm_b32 v54, v41, v40, s70
    v_perm_b32 v40, v41, v40, s71
    v_pk_sub_u16 v41, v137, s74 clamp
    v_pk_sub_u16 v42, v141, s74 clamp
    v_perm_b32 v55, v42, v41, s70
    v_perm_b32 v41, v42, v41, s71
    v_or3_b32 v43, v43, v40, v41
    v_alignbit_b32 v41, v41, v41, 4
    v_or_b32 v67, v40, v41
    ds_write_b128 v9, v[52:55] offset:25600
    ds_write_b128 v9, v[64:67] offset:28672
    v_pk_sub_u16 v42, v114, s85
    v_pk_min_u16 v44, v44, v42
    v_pk_sub_u16 v42, v118, s85
    v_pk_min_u16 v44, v44, v42
    v_pk_sub_u16 v42, v122, s85
    v_pk_min_u16 v44, v44, v42
    v_pk_sub_u16 v42, v126, s85
    v_pk_min_u16 v44, v44, v42
    v_pk_sub_u16 v40, v114, s74 clamp
    v_pk_sub_u16 v41, v118, s74 clamp
    v_perm_b32 v56, v41, v40, s70
    v_perm_b32 v40, v41, v40, s71
    v_pk_sub_u16 v41, v122, s74 clamp
    v_pk_sub_u16 v42, v126, s74 clamp
    v_perm_b32 v57, v42, v41, s70
    v_perm_b32 v41, v42, v41, s71
    v_or3_b32 v43, v43, v40, v41
    v_alignbit_b32 v41, v41, v41, 4
    v_or_b32 v68, v40, v41
    v_pk_sub_u16 v42, v130, s85
    v_pk_min_u16 v44, v44, v42
    v_pk_sub_u16 v42, v134, s85
    v_pk_min_u16 v44, v44, v42
    v_pk_sub_u16 v42, v138, s85
    v_pk_min_u16 v44, v44, v42
    v_pk_sub_u16 v42, v142, s85
    v_pk_min_u16 v44, v44, v42
    v_pk_sub_u16 v40, v130, s74 clamp
    v_pk_sub_u16 v41, v134, s74 clamp
    v_perm_b32 v58, v41, v40, s70
    v_perm_b32 v40, v41, v40, s71
    v_pk_sub_u16 v41, v138, s74 clamp
    v_pk_sub_u16 v42, v142, s74 clamp
    v_perm_b32 v59, v42, v41, s70
    v_perm_b32 v41, v42, v41, s71
    v_or3_b32 v43, v43, v40, v41
    v_alignbit_b32 v41, v41, v41, 4
    v_or_b32 v69, v40, v41
    ds_write_b128 v9, v[56:59] offset:26624
    v_pk_sub_u16 v42, v115, s85
    v_pk_min_u16 v44, v44, v42
    v_pk_sub_u16 v42, v119, s85
    v_pk_min_u16 v44, v44, v42
    v_pk_sub_u16 v42, v123, s85
    v_pk_min_u16 v44, v44, v42
    v_pk_sub_u16 v42, v127, s85
    v_pk_min_u16 v44, v44, v42
    v_pk_sub_u16 v40, v115, s74 clamp
    v_pk_sub_u16 v41, v119, s74 clamp
    v_perm_b32 v60, v41, v40, s70
    v_perm_b32 v40, v41, v40, s71
    v_pk_sub_u16 v41, v123, s74 clamp
    v_pk_sub_u16 v42, v127, s74 clamp
    v_perm_b32 v61, v42, v41, s70
    v_perm_b32 v41, v42, v41, s71
    v_or3_b32 v43, v43, v40, v41
    v_alignbit_b32 v41, v41, v41, 4
    v_or_b32 v70, v40, v41
    v_pk_sub_u16 v42, v131, s85
    v_pk_min_u16 v44, v44, v42
    v_pk_sub_u16 v42, v135, s85
    v_pk_min_u16 v44, v44, v42
    v_pk_sub_u16 v42, v139, s85
    v_pk_min_u16 v44, v44, v42
    v_pk_sub_u16 v42, v143, s85
    v_pk_min_u16 v44, v44, v42
    v_pk_sub_u16 v40, v131, s74 clamp
    v_pk_sub_u16 v41, v135, s74 clamp
    v_perm_b32 v62, v41, v40, s70
    v_perm_b32 v40, v41, v40, s71
    v_pk_sub_u16 v41, v139, s74 clamp
    v_pk_sub_u16 v42, v143, s74 clamp
    v_perm_b32 v63, v42, v41, s70
    v_perm_b32 v41, v42, v41, s71
    v_or3_b32 v43, v43, v40, v41
    v_alignbit_b32 v41, v41, v41, 4
    v_or_b32 v71, v40, v41
    ds_write_b128 v9, v[60:63] offset:27648
    ds_write_b128 v9, v[68:71] offset:29696
    v_pk_sub_u16 v44, s74, v44 clamp
    v_and_b32 v43, 0x78787878, v43
    v_or_b32 v43, v43, v44
    v_cmp_ne_u32 vcc, 0, v43
    s_cbranch_vccnz L_xc_22
L_xcb_23:
    s_add_u32 s53, s99, 0x120000
    s_and_b32 s53, s53, 0x1fffff
    buffer_load_dwordx4 v[112:115], v3, s[12:15], s53 offen offset:0 nt
    buffer_load_dwordx4 v[116:119], v3, s[12:15], s53 offen offset:1024 nt
    buffer_load_dwordx4 v[120:123], v3, s[12:15], s53 offen offset:2048 nt
    buffer_load_dwordx4 v[124:127], v3, s[12:15], s53 offen offset:3072 nt
    s_add_u32 s53, s53, 0x1000
    buffer_load_dwordx4 v[128:131], v3, s[12:15], s53 offen offset:0 nt
    buffer_load_dwordx4 v[132:135], v3, s[12:15], s53 offen offset:1024 nt
    buffer_load_dwordx4 v[136:139], v3, s[12:15], s53 offen offset:2048 nt
    buffer_load_dwordx4 v[140:143], v3, s[12:15], s53 offen offset:3072 nt
    s_waitcnt vmcnt(8)
    s_waitcnt lgkmcnt(0)
    v_pk_sub_u16 v44, v80, s85
    v_pk_sub_u16 v42, v84, s85
    v_pk_min_u16 v44, v44, v42
    v_pk_sub_u16 v42, v88, s85
    v_pk_min_u16 v44, v44, v42
    v_pk_sub_u16 v42, v92, s85
    v_pk_min_u16 v44, v44, v42
    v_pk_sub_u16 v40, v80, s74 clamp
    v_pk_sub_u16 v41, v84, s74 clamp
    v_perm_b32 v48, v41, v40, s70
    v_perm_b32 v40, v41, v40, s71
    v_pk_sub_u16 v41, v88, s74 clamp
    v_pk_sub_u16 v42, v92, s74 clamp
    v_perm_b32 v49, v42, v41, s70
    v_perm_b32 v41, v42, v41, s71
    v_or_b32 v43, v40, v41
    v_alignbit_b32 v41, v41, v41, 4
    v_or_b32 v64, v40, v41
    v_pk_sub_u16 v42, v96, s85
    v_pk_min_u16 v44, v44, v42
    v_pk_sub_u16 v42, v100, s85
    v_pk_min_u16 v44, v44, v42
    v_pk_sub_u16 v42, v104, s85
    v_pk_min_u16 v44, v44, v42
    v_pk_sub_u16 v42, v108, s85
    v_pk_min_u16 v44, v44, v42
    v_pk_sub_u16 v40, v96, s74 clamp
    v_pk_sub_u16 v41, v100, s74 clamp
    v_perm_b32 v50, v41, v40, s70
    v_perm_b32 v40, v41, v40, s71
    v_pk_sub_u16 v41, v104, s74 clamp
    v_pk_sub_u16 v42, v108, s74 clamp
    v_perm_b32 v51, v42, v41, s70
    v_perm_b32 v41, v42, v41, s71
    v_or3_b32 v43, v43, v40, v41
    v_alignbit_b32 v41, v41, v41, 4
    v_or_b32 v65, v40, v41
    ds_write_b128 v9, v[48:51] offset:30720
    v_pk_sub_u16 v42, v81, s85
    v_pk_min_u16 v44, v44, v42
    v_pk_sub_u16 v42, v85, s85
    v_pk_min_u16 v44, v44, v42
    v_pk_sub_u16 v42, v89, s85
    v_pk_min_u16 v44, v44, v42
    v_pk_sub_u16 v42, v93, s85
    v_pk_min_u16 v44, v44, v42
    v_pk_sub_u16 v40, v81, s74 clamp
    v_pk_sub_u16 v41, v85, s74 clamp
    v_perm_b32 v52, v41, v40, s70
    v_perm_b32 v40, v41, v40, s71
    v_pk_sub_u16 v41, v89, s74 clamp
    v_pk_sub_u16 v42, v93, s74 clamp
    v_perm_b32 v53, v42, v41, s70
    v_perm_b32 v41, v42, v41, s71
    v_or3_b32 v43, v43, v40, v41
    v_alignbit_b32 v41, v41, v41, 4
    v_or_b32 v66, v40, v41
    v_pk_sub_u16 v42, v97, s85
    v_pk_min_u16 v44, v44, v42
    v_pk_sub_u16 v42, v101, s85
    v_pk_min_u16 v44, v44, v42
    v_pk_sub_u16 v42, v105, s85
    v_pk_min_u16 v44, v44, v42
    v_pk_sub_u16 v42, v109, s85
    v_pk_min_u16 v44, v44, v42
    v_pk_sub_u16 v40, v97, s74 clamp
    v_pk_sub_u16 v41, v101, s74 clamp
    v_perm_b32 v54, v41, v40, s70
    v_perm_b32 v40, v41, v40, s71
    v_pk_sub_u16 v41, v105, s74 clamp
    v_pk_sub_u16 v42, v109, s74 clamp
    v_perm_b32 v55, v42, v41, s70
    v_perm_b32 v41, v42, v41, s71
    v_or3_b32 v43, v43, v40, v41
    v_alignbit_b32 v41, v41, v41, 4
    v_or_b32 v67, v40, v41
    ds_write_b128 v9, v[52:55] offset:31744
    ds_write_b128 v9, v[64:67] offset:34816
    v_pk_sub_u16 v42, v82, s85
    v_pk_min_u16 v44, v44, v42
    v_pk_sub_u16 v42, v86, s85
    v_pk_min_u16 v44, v44, v42
    v_pk_sub_u16 v42, v90, s85
    v_pk_min_u16 v44, v44, v42
    v_pk_sub_u16 v42, v94, s85
    v_pk_min_u16 v44, v44, v42
    v_pk_sub_u16 v40, v82, s74 clamp
    v_pk_sub_u16 v41, v86, s74 clamp
    v_perm_b32 v56, v41, v40, s70
    v_perm_b32 v40, v41, v40, s71
    v_pk_sub_u16 v41, v90, s74 clamp
    v_pk_sub_u16 v42, v94, s74 clamp
    v_perm_b32 v57, v42, v41, s70
    v_perm_b32 v41, v42, v41, s71
    v_or3_b32 v43, v43, v40, v41
    v_alignbit_b32 v41, v41, v41, 4
    v_or_b32 v68, v40, v41
    v_pk_sub_u16 v42, v98, s85
    v_pk_min_u16 v44, v44, v42
    v_pk_sub_u16 v42, v102, s85
    v_pk_min_u16 v44, v44, v42
    v_pk_sub_u16 v42, v106, s85
    v_pk_min_u16 v44, v44, v42
    v_pk_sub_u16 v42, v110, s85
    v_pk_min_u16 v44, v44, v42
    v_pk_sub_u16 v40, v98, s74 clamp
    v_pk_sub_u16 v41, v102, s74 clamp
    v_perm_b32 v58, v41, v40, s70
    v_perm_b32 v40, v41, v40, s71
    v_pk_sub_u16 v41, v106, s74 clamp
    v_pk_sub_u16 v42, v110, s74 clamp
    v_perm_b32 v59, v42, v41, s70
    v_perm_b32 v41, v42, v41, s71
    v_or3_b32 v43, v43, v40, v41
    v_alignbit_b32 v41, v41, v41, 4
    v_or_b32 v69, v40, v41
    ds_write_b128 v9, v[56:59] offset:32768
    v_pk_sub_u16 v42, v83, s85
    v_pk_min_u16 v44, v44, v42
    v_pk_sub_u16 v42, v87, s85
    v_pk_min_u16 v44, v44, v42
    v_pk_sub_u16 v42, v91, s85
    v_pk_min_u16 v44, v44, v42
    v_pk_sub_u16 v42, v95, s85
    v_pk_min_u16 v44, v44, v42
    v_pk_sub_u16 v40, v83, s74 clamp
    v_pk_sub_u16 v41, v87, s74 clamp
    v_perm_b32 v60, v41, v40, s70
    v_perm_b32 v40, v41, v40, s71
    v_pk_sub_u16 v41, v91, s74 clamp
    v_pk_sub_u16 v42, v95, s74 clamp
    v_perm_b32 v61, v42, v41, s70
    v_perm_b32 v41, v42, v41, s71
    v_or3_b32 v43, v43, v40, v41
    v_alignbit_b32 v41, v41, v41, 4
    v_or_b32 v70, v40, v41
    v_pk_sub_u16 v42, v99, s85
    v_pk_min_u16 v44, v44, v42
    v_pk_sub_u16 v42, v103, s85
    v_pk_min_u16 v44, v44, v42
    v_pk_sub_u16 v42, v107, s85
    v_pk_min_u16 v44, v44, v42
    v_pk_sub_u16 v42, v111, s85
    v_pk_min_u16 v44, v44, v42
    v_pk_sub_u16 v40, v99, s74 clamp
    v_pk_sub_u16 v41, v103, s74 clamp
    v_perm_b32 v62, v41, v40, s70
    v_perm_b32 v40, v41, v40, s71
    v_pk_sub_u16 v41, v107, s74 clamp
    v_pk_sub_u16 v42, v111, s74 clamp
    v_perm_b32 v63, v42, v41, s70
    v_perm_b32 v41, v42, v41, s71
    v_or3_b32 v43, v43, v40, v41
    v_alignbit_b32 v41, v41, v41, 4
    v_or_b32 v71, v40, v41
    ds_write_b128 v9, v[60:63] offset:33792
    ds_write_b128 v9, v[68:71] offset:35840
    v_pk_sub_u16 v44, s74, v44 clamp
    v_and_b32 v43, 0x78787878, v43
    v_or_b32 v43, v43, v44
    v_cmp_ne_u32 vcc, 0, v43
    s_cbranch_vccnz L_xc_25
L_xcb_26:
    s_add_u32 s53, s99, 0x140000
    s_and_b32 s53, s53, 0x1fffff
    buffer_load_dwordx4 v[80:83], v3, s[12:15], s53 offen offset:0 nt
    buffer_load_dwordx4 v[84:87], v3, s[12:15], s53 offen offset:1024 nt
    buffer_load_dwordx4 v[88:91], v3, s[12:15], s53 offen offset:2048 nt
    buffer_load_dwordx4 v[92:95], v3, s[12:15], s53 offen offset:3072 nt
    s_add_u32 s53, s53, 0x1000
    buffer_load_dwordx4 v[96:99], v3, s[12:15], s53 offen offset:0 nt
    buffer_load_dwordx4 v[100:103], v3, s[12:15], s53 offen offset:1024 nt
    buffer_load_dwordx4 v[104:107], v3, s[12:15], s53 offen offset:2048 nt
    buffer_load_dwordx4 v[108:111], v3, s[12:15], s53 offen offset:3072 nt
    s_waitcnt vmcnt(8)
    s_waitcnt lgkmcnt(0)
    v_perm_b32 v32, v116, v112, s57
    v_perm_b32 v33, v124, v120, s57
    v_perm_b32 v34, v132, v128, s57
    v_perm_b32 v35, v140, v136, s57
    v_accvgpr_write_b32 a60, v32
    v_accvgpr_write_b32 a61, v33
    v_accvgpr_write_b32 a62, v34
    v_accvgpr_write_b32 a63, v35
    v_perm_b32 v36, v116, v112, s58
    v_perm_b32 v37, v124, v120, s58
    v_perm_b32 v38, v132, v128, s58
    v_perm_b32 v39, v140, v136, s58
    v_accvgpr_write_b32 a56, v36
    v_accvgpr_write_b32 a57, v37
    v_accvgpr_write_b32 a58, v38
    v_accvgpr_write_b32 a59, v39
    v_perm_b32 v40, v117, v113, s57
    v_perm_b32 v41, v125, v121, s57
    v_perm_b32 v42, v133, v129, s57
    v_perm_b32 v43, v141, v137, s57
    v_accvgpr_write_b32 a52, v40
    v_accvgpr_write_b32 a53, v41
    v_accvgpr_write_b32 a54, v42
    v_accvgpr_write_b32 a55, v43
    v_perm_b32 v44, v117, v113, s58
    v_perm_b32 v45, v125, v121, s58
    v_perm_b32 v46, v133, v129, s58
    v_perm_b32 v47, v141, v137, s58
    v_accvgpr_write_b32 a48, v44
    v_accvgpr_write_b32 a49, v45
    v_accvgpr_write_b32 a50, v46
    v_accvgpr_write_b32 a51, v47
    v_perm_b32 v32, v118, v114, s57
    v_perm_b32 v33, v126, v122, s57
    v_perm_b32 v34, v134, v130, s57
    v_perm_b32 v35, v142, v138, s57
    v_accvgpr_write_b32 a44, v32
    v_accvgpr_write_b32 a45, v33
    v_accvgpr_write_b32 a46, v34
    v_accvgpr_write_b32 a47, v35
    v_perm_b32 v36, v118, v114, s58
    v_perm_b32 v37, v126, v122, s58
    v_perm_b32 v38, v134, v130, s58
    v_perm_b32 v39, v142, v138, s58
    v_accvgpr_write_b32 a40, v36
    v_accvgpr_write_b32 a41, v37
    v_accvgpr_write_b32 a42, v38
    v_accvgpr_write_b32 a43, v39
    v_perm_b32 v40, v119, v115, s57
    v_perm_b32 v41, v127, v123, s57
    v_perm_b32 v42, v135, v131, s57
    v_perm_b32 v43, v143, v139, s57
    v_accvgpr_write_b32 a36, v40
    v_accvgpr_write_b32 a37, v41
    v_accvgpr_write_b32 a38, v42
    v_accvgpr_write_b32 a39, v43
    v_perm_b32 v44, v119, v115, s58
    v_perm_b32 v45, v127, v123, s58
    v_perm_b32 v46, v135, v131, s58
    v_perm_b32 v47, v143, v139, s58
    v_accvgpr_write_b32 a32, v44
    v_accvgpr_write_b32 a33, v45
    v_accvgpr_write_b32 a34, v46
    v_accvgpr_write_b32 a35, v47
    s_add_u32 s53, s99, 0x160000
    s_and_b32 s53, s53, 0x1fffff
    buffer_load_dwordx4 v[112:115], v3, s[12:15], s53 offen offset:0 nt
    buffer_load_dwordx4 v[116:119], v3, s[12:15], s53 offen offset:1024 nt
    buffer_load_dwordx4 v[120:123], v3, s[12:15], s53 offen offset:2048 nt
    buffer_load_dwordx4 v[124:127], v3, s[12:15], s53 offen offset:3072 nt
    s_add_u32 s53, s53, 0x1000
    buffer_load_dwordx4 v[128:131], v3, s[12:15], s53 offen offset:0 nt
    buffer_load_dwordx4 v[132:135], v3, s[12:15], s53 offen offset:1024 nt
    buffer_load_dwordx4 v[136:139], v3, s[12:15], s53 offen offset:2048 nt
    buffer_load_dwordx4 v[140:143], v3, s[12:15], s53 offen offset:3072 nt
    s_waitcnt vmcnt(8)
    v_perm_b32 v32, v84, v80, s57
    v_perm_b32 v33, v92, v88, s57
    v_perm_b32 v34, v100, v96, s57
    v_perm_b32 v35, v108, v104, s57
    v_accvgpr_write_b32 a92, v32
    v_accvgpr_write_b32 a93, v33
    v_accvgpr_write_b32 a94, v34
    v_accvgpr_write_b32 a95, v35
    v_perm_b32 v36, v84, v80, s58
    v_perm_b32 v37, v92, v88, s58
    v_perm_b32 v38, v100, v96, s58
    v_perm_b32 v39, v108, v104, s58
    v_accvgpr_write_b32 a88, v36
    v_accvgpr_write_b32 a89, v37
    v_accvgpr_write_b32 a90, v38
    v_accvgpr_write_b32 a91, v39
    v_perm_b32 v40, v85, v81, s57
    v_perm_b32 v41, v93, v89, s57
    v_perm_b32 v42, v101, v97, s57
    v_perm_b32 v43, v109, v105, s57
    v_accvgpr_write_b32 a84, v40
    v_accvgpr_write_b32 a85, v41
    v_accvgpr_write_b32 a86, v42
    v_accvgpr_write_b32 a87, v43
    v_perm_b32 v44, v85, v81, s58
    v_perm_b32 v45, v93, v89, s58
    v_perm_b32 v46, v101, v97, s58
    v_perm_b32 v47, v109, v105, s58
    v_accvgpr_write_b32 a80, v44
    v_accvgpr_write_b32 a81, v45
    v_accvgpr_write_b32 a82, v46
    v_accvgpr_write_b32 a83, v47
    v_perm_b32 v32, v86, v82, s57
    v_perm_b32 v33, v94, v90, s57
    v_perm_b32 v34, v102, v98, s57
    v_perm_b32 v35, v110, v106, s57
    v_accvgpr_write_b32 a76, v32
    v_accvgpr_write_b32 a77, v33
    v_accvgpr_write_b32 a78, v34
    v_accvgpr_write_b32 a79, v35
    v_perm_b32 v36, v86, v82, s58
    v_perm_b32 v37, v94, v90, s58
    v_perm_b32 v38, v102, v98, s58
    v_perm_b32 v39, v110, v106, s58
    v_accvgpr_write_b32 a72, v36
    v_accvgpr_write_b32 a73, v37
    v_accvgpr_write_b32 a74, v38
    v_accvgpr_write_b32 a75, v39
    v_perm_b32 v40, v87, v83, s57
    v_perm_b32 v41, v95, v91, s57
    v_perm_b32 v42, v103, v99, s57
    v_perm_b32 v43, v111, v107, s57
    v_accvgpr_write_b32 a68, v40
    v_accvgpr_write_b32 a69, v41
    v_accvgpr_write_b32 a70, v42
    v_accvgpr_write_b32 a71, v43
    v_perm_b32 v44, v87, v83, s58
    v_perm_b32 v45, v95, v91, s58
    v_perm_b32 v46, v103, v99, s58
    v_perm_b32 v47, v111, v107, s58
    v_accvgpr_write_b32 a64, v44
    v_accvgpr_write_b32 a65, v45
    v_accvgpr_write_b32 a66, v46
    v_accvgpr_write_b32 a67, v47
    s_add_u32 s53, s99, 0x180000
    s_and_b32 s53, s53, 0x1fffff
    buffer_load_dwordx4 v[80:83], v3, s[12:15], s53 offen offset:0 nt
    buffer_load_dwordx4 v[84:87], v3, s[12:15], s53 offen offset:1024 nt
    buffer_load_dwordx4 v[88:91], v3, s[12:15], s53 offen offset:2048 nt
    buffer_load_dwordx4 v[92:95], v3, s[12:15], s53 offen offset:3072 nt
    s_add_u32 s53, s53, 0x1000
    buffer_load_dwordx4 v[96:99], v3, s[12:15], s53 offen offset:0 nt
    buffer_load_dwordx4 v[100:103], v3, s[12:15], s53 offen offset:1024 nt
    buffer_load_dwordx4 v[104:107], v3, s[12:15], s53 offen offset:2048 nt
    buffer_load_dwordx4 v[108:111], v3, s[12:15], s53 offen offset:3072 nt
    v_mov_b32 v4, 0
    buffer_load_dword v12, v4, s[48:51], 0 offen sc1
    s_waitcnt vmcnt(9)
    v_perm_b32 v32, v116, v112, s57
    v_perm_b32 v33, v124, v120, s57
    v_perm_b32 v34, v132, v128, s57
    v_perm_b32 v35, v140, v136, s57
    v_accvgpr_write_b32 a124, v32
    v_accvgpr_write_b32 a125, v33
    v_accvgpr_write_b32 a126, v34
    v_accvgpr_write_b32 a127, v35
    v_perm_b32 v36, v116, v112, s58
    v_perm_b32 v37, v124, v120, s58
    v_perm_b32 v38, v132, v128, s58
    v_perm_b32 v39, v140, v136, s58
    v_accvgpr_write_b32 a120, v36
    v_accvgpr_write_b32 a121, v37
    v_accvgpr_write_b32 a122, v38
    v_accvgpr_write_b32 a123, v39
    v_perm_b32 v40, v117, v113, s57
    v_perm_b32 v41, v125, v121, s57
    v_perm_b32 v42, v133, v129, s57
    v_perm_b32 v43, v141, v137, s57
    v_accvgpr_write_b32 a116, v40
    v_accvgpr_write_b32 a117, v41
    v_accvgpr_write_b32 a118, v42
    v_accvgpr_write_b32 a119, v43
    v_perm_b32 v44, v117, v113, s58
    v_perm_b32 v45, v125, v121, s58
    v_perm_b32 v46, v133, v129, s58
    v_perm_b32 v47, v141, v137, s58
    v_accvgpr_write_b32 a112, v44
    v_accvgpr_write_b32 a113, v45
    v_accvgpr_write_b32 a114, v46
    v_accvgpr_write_b32 a115, v47
    v_perm_b32 v32, v118, v114, s57
    v_perm_b32 v33, v126, v122, s57
    v_perm_b32 v34, v134, v130, s57
    v_perm_b32 v35, v142, v138, s57
    v_accvgpr_write_b32 a108, v32
    v_accvgpr_write_b32 a109, v33
    v_accvgpr_write_b32 a110, v34
    v_accvgpr_write_b32 a111, v35
    v_perm_b32 v36, v118, v114, s58
    v_perm_b32 v37, v126, v122, s58
    v_perm_b32 v38, v134, v130, s58
    v_perm_b32 v39, v142, v138, s58
    v_accvgpr_write_b32 a104, v36
    v_accvgpr_write_b32 a105, v37
    v_accvgpr_write_b32 a106, v38
    v_accvgpr_write_b32 a107, v39
    v_perm_b32 v40, v119, v115, s57
    v_perm_b32 v41, v127, v123, s57
    v_perm_b32 v42, v135, v131, s57
    v_perm_b32 v43, v143, v139, s57
    v_accvgpr_write_b32 a100, v40
    v_accvgpr_write_b32 a101, v41
    v_accvgpr_write_b32 a102, v42
    v_accvgpr_write_b32 a103, v43
    v_perm_b32 v44, v119, v115, s58
    v_perm_b32 v45, v127, v123, s58
    v_perm_b32 v46, v135, v131, s58
    v_perm_b32 v47, v143, v139, s58
    v_accvgpr_write_b32 a96, v44
    v_accvgpr_write_b32 a97, v45
    v_accvgpr_write_b32 a98, v46
    v_accvgpr_write_b32 a99, v47
    s_add_u32 s53, s99, 0x1a0000
    s_and_b32 s53, s53, 0x1fffff
    buffer_load_dwordx4 v[112:115], v3, s[12:15], s53 offen offset:0 nt
    buffer_load_dwordx4 v[116:119], v3, s[12:15], s53 offen offset:1024 nt
    buffer_load_dwordx4 v[120:123], v3, s[12:15], s53 offen offset:2048 nt
    buffer_load_dwordx4 v[124:127], v3, s[12:15], s53 offen offset:3072 nt
    s_add_u32 s53, s53, 0x1000
    buffer_load_dwordx4 v[128:131], v3, s[12:15], s53 offen offset:0 nt
    buffer_load_dwordx4 v[132:135], v3, s[12:15], s53 offen offset:1024 nt
    buffer_load_dwordx4 v[136:139], v3, s[12:15], s53 offen offset:2048 nt
    buffer_load_dwordx4 v[140:143], v3, s[12:15], s53 offen offset:3072 nt
    s_waitcnt vmcnt(9)
    v_perm_b32 v32, v84, v80, s57
    v_perm_b32 v33, v92, v88, s57
    v_perm_b32 v34, v100, v96, s57
    v_perm_b32 v35, v108, v104, s57
    v_accvgpr_write_b32 a156, v32
    v_accvgpr_write_b32 a157, v33
    v_accvgpr_write_b32 a158, v34
    v_accvgpr_write_b32 a159, v35
    v_perm_b32 v36, v84, v80, s58
    v_perm_b32 v37, v92, v88, s58
    v_perm_b32 v38, v100, v96, s58
    v_perm_b32 v39, v108, v104, s58
    v_accvgpr_write_b32 a152, v36
    v_accvgpr_write_b32 a153, v37
    v_accvgpr_write_b32 a154, v38
    v_accvgpr_write_b32 a155, v39
    v_perm_b32 v40, v85, v81, s57
    v_perm_b32 v41, v93, v89, s57
    v_perm_b32 v42, v101, v97, s57
    v_perm_b32 v43, v109, v105, s57
    v_accvgpr_write_b32 a148, v40
    v_accvgpr_write_b32 a149, v41
    v_accvgpr_write_b32 a150, v42
    v_accvgpr_write_b32 a151, v43
    v_perm_b32 v44, v85, v81, s58
    v_perm_b32 v45, v93, v89, s58
    v_perm_b32 v46, v101, v97, s58
    v_perm_b32 v47, v109, v105, s58
    v_accvgpr_write_b32 a144, v44
    v_accvgpr_write_b32 a145, v45
    v_accvgpr_write_b32 a146, v46
    v_accvgpr_write_b32 a147, v47
    v_perm_b32 v32, v86, v82, s57
    v_perm_b32 v33, v94, v90, s57
    v_perm_b32 v34, v102, v98, s57
    v_perm_b32 v35, v110, v106, s57
    v_accvgpr_write_b32 a140, v32
    v_accvgpr_write_b32 a141, v33
    v_accvgpr_write_b32 a142, v34
    v_accvgpr_write_b32 a143, v35
    v_perm_b32 v36, v86, v82, s58
    v_perm_b32 v37, v94, v90, s58
    v_perm_b32 v38, v102, v98, s58
    v_perm_b32 v39, v110, v106, s58
    v_accvgpr_write_b32 a136, v36
    v_accvgpr_write_b32 a137, v37
    v_accvgpr_write_b32 a138, v38
    v_accvgpr_write_b32 a139, v39
    v_perm_b32 v40, v87, v83, s57
    v_perm_b32 v41, v95, v91, s57
    v_perm_b32 v42, v103, v99, s57
    v_perm_b32 v43, v111, v107, s57
    v_accvgpr_write_b32 a132, v40
    v_accvgpr_write_b32 a133, v41
    v_accvgpr_write_b32 a134, v42
    v_accvgpr_write_b32 a135, v43
    v_perm_b32 v44, v87, v83, s58
    v_perm_b32 v45, v95, v91, s58
    v_perm_b32 v46, v103, v99, s58
    v_perm_b32 v47, v111, v107, s58
    v_accvgpr_write_b32 a128, v44
    v_accvgpr_write_b32 a129, v45
    v_accvgpr_write_b32 a130, v46
    v_accvgpr_write_b32 a131, v47
    s_add_u32 s53, s99, 0x1c0000
    s_and_b32 s53, s53, 0x1fffff
    buffer_load_dwordx4 v[80:83], v3, s[12:15], s53 offen offset:0 nt
    buffer_load_dwordx4 v[84:87], v3, s[12:15], s53 offen offset:1024 nt
    buffer_load_dwordx4 v[88:91], v3, s[12:15], s53 offen offset:2048 nt
    buffer_load_dwordx4 v[92:95], v3, s[12:15], s53 offen offset:3072 nt
    s_add_u32 s53, s53, 0x1000
    buffer_load_dwordx4 v[96:99], v3, s[12:15], s53 offen offset:0 nt
    buffer_load_dwordx4 v[100:103], v3, s[12:15], s53 offen offset:1024 nt
    buffer_load_dwordx4 v[104:107], v3, s[12:15], s53 offen offset:2048 nt
    buffer_load_dwordx4 v[108:111], v3, s[12:15], s53 offen offset:3072 nt
    s_waitcnt vmcnt(16)
    v_mov_b32 v4, 0
L_cnt_28:
    v_readfirstlane_b32 s66, v12
    s_nop 0
    s_cmp_ge_u32 s66, 256
    s_cbranch_scc1 L_cdone_29
    buffer_load_dword v12, v4, s[48:51], 0 offen sc1
    s_waitcnt vmcnt(0)
    s_sub_u32 s56, s56, 1
    s_cmp_eq_u32 s56, 0
    s_cbranch_scc0 L_cnt_28
    s_mov_b32 s56, 1
L_cdone_29:
    s_lshr_b32 s66, s3, 5
    s_lshl_b32 s66, s66, 7
    s_add_u32 s66, s66, 0xd1000
    v_and_b32 v5, 31, v1
    v_lshlrev_b32 v5, 2, v5
    buffer_load_dword v13, v5, s[16:19], s66 offen sc1
    v_and_b32 v4, 3, v1
    v_lshlrev_b32 v4, 11, v4
    v_lshrrev_b32 v5, 5, v1
    v_lshl_add_u32 v4, v5, 10, v4
    v_bfe_u32 v5, v1, 4, 1
    v_lshl_add_u32 v4, v5, 7, v4
    v_bfe_u32 v5, v1, 2, 2
    v_lshl_add_u32 v4, v5, 3, v4
    s_lshr_b32 s66, s3, 5
    s_lshl_b32 s66, s66, 13
    s_add_u32 s66, s66, 0xb0000
    v_add_u32 v4, s66, v4
    buffer_load_dwordx2 v[48:49], v4, s[16:19], 0 offen offset:0 sc1
    buffer_load_dwordx2 v[50:51], v4, s[16:19], 0 offen offset:32 sc1
    buffer_load_dwordx2 v[52:53], v4, s[16:19], 0 offen offset:64 sc1
    buffer_load_dwordx2 v[54:55], v4, s[16:19], 0 offen offset:96 sc1
    buffer_load_dwordx2 v[56:57], v4, s[16:19], 0 offen offset:256 sc1
    buffer_load_dwordx2 v[58:59], v4, s[16:19], 0 offen offset:288 sc1
    buffer_load_dwordx2 v[60:61], v4, s[16:19], 0 offen offset:320 sc1
    buffer_load_dwordx2 v[62:63], v4, s[16:19], 0 offen offset:352 sc1
    buffer_load_dwordx2 v[64:65], v4, s[16:19], 0 offen offset:512 sc1
    buffer_load_dwordx2 v[66:67], v4, s[16:19], 0 offen offset:544 sc1
    buffer_load_dwordx2 v[68:69], v4, s[16:19], 0 offen offset:576 sc1
    buffer_load_dwordx2 v[70:71], v4, s[16:19], 0 offen offset:608 sc1
    buffer_load_dwordx2 v[72:73], v4, s[16:19], 0 offen offset:768 sc1
    buffer_load_dwordx2 v[74:75], v4, s[16:19], 0 offen offset:800 sc1
    buffer_load_dwordx2 v[76:77], v4, s[16:19], 0 offen offset:832 sc1
    buffer_load_dwordx2 v[78:79], v4, s[16:19], 0 offen offset:864 sc1
    s_waitcnt vmcnt(25)
    v_perm_b32 v32, v116, v112, s57
    v_perm_b32 v33, v124, v120, s57
    v_perm_b32 v34, v132, v128, s57
    v_perm_b32 v35, v140, v136, s57
    v_accvgpr_write_b32 a188, v32
    v_accvgpr_write_b32 a189, v33
    v_accvgpr_write_b32 a190, v34
    v_accvgpr_write_b32 a191, v35
    v_perm_b32 v36, v116, v112, s58
    v_perm_b32 v37, v124, v120, s58
    v_perm_b32 v38, v132, v128, s58
    v_perm_b32 v39, v140, v136, s58
    v_accvgpr_write_b32 a184, v36
    v_accvgpr_write_b32 a185, v37
    v_accvgpr_write_b32 a186, v38
    v_accvgpr_write_b32 a187, v39
    v_perm_b32 v40, v117, v113, s57
    v_perm_b32 v41, v125, v121, s57
    v_perm_b32 v42, v133, v129, s57
    v_perm_b32 v43, v141, v137, s57
    v_accvgpr_write_b32 a180, v40
    v_accvgpr_write_b32 a181, v41
    v_accvgpr_write_b32 a182, v42
    v_accvgpr_write_b32 a183, v43
    v_perm_b32 v44, v117, v113, s58
    v_perm_b32 v45, v125, v121, s58
    v_perm_b32 v46, v133, v129, s58
    v_perm_b32 v47, v141, v137, s58
    v_accvgpr_write_b32 a176, v44
    v_accvgpr_write_b32 a177, v45
    v_accvgpr_write_b32 a178, v46
    v_accvgpr_write_b32 a179, v47
    v_perm_b32 v32, v118, v114, s57
    v_perm_b32 v33, v126, v122, s57
    v_perm_b32 v34, v134, v130, s57
    v_perm_b32 v35, v142, v138, s57
    v_accvgpr_write_b32 a172, v32
    v_accvgpr_write_b32 a173, v33
    v_accvgpr_write_b32 a174, v34
    v_accvgpr_write_b32 a175, v35
    v_perm_b32 v36, v118, v114, s58
    v_perm_b32 v37, v126, v122, s58
    v_perm_b32 v38, v134, v130, s58
    v_perm_b32 v39, v142, v138, s58
    v_accvgpr_write_b32 a168, v36
    v_accvgpr_write_b32 a169, v37
    v_accvgpr_write_b32 a170, v38
    v_accvgpr_write_b32 a171, v39
    v_perm_b32 v40, v119, v115, s57
    v_perm_b32 v41, v127, v123, s57
    v_perm_b32 v42, v135, v131, s57
    v_perm_b32 v43, v143, v139, s57
    v_accvgpr_write_b32 a164, v40
    v_accvgpr_write_b32 a165, v41
    v_accvgpr_write_b32 a166, v42
    v_accvgpr_write_b32 a167, v43
    v_perm_b32 v44, v119, v115, s58
    v_perm_b32 v45, v127, v123, s58
    v_perm_b32 v46, v135, v131, s58
    v_perm_b32 v47, v143, v139, s58
    v_accvgpr_write_b32 a160, v44
    v_accvgpr_write_b32 a161, v45
    v_accvgpr_write_b32 a162, v46
    v_accvgpr_write_b32 a163, v47
    s_add_u32 s53, s99, 0x1e0000
    s_and_b32 s53, s53, 0x1fffff
    buffer_load_dwordx4 v[112:115], v3, s[12:15], s53 offen offset:0 nt
    buffer_load_dwordx4 v[116:119], v3, s[12:15], s53 offen offset:1024 nt
    buffer_load_dwordx4 v[120:123], v3, s[12:15], s53 offen offset:2048 nt
    buffer_load_dwordx4 v[124:127], v3, s[12:15], s53 offen offset:3072 nt
    s_add_u32 s53, s53, 0x1000
    buffer_load_dwordx4 v[128:131], v3, s[12:15], s53 offen offset:0 nt
    buffer_load_dwordx4 v[132:135], v3, s[12:15], s53 offen offset:1024 nt
    buffer_load_dwordx4 v[136:139], v3, s[12:15], s53 offen offset:2048 nt
    buffer_load_dwordx4 v[140:143], v3, s[12:15], s53 offen offset:3072 nt
    s_waitcnt vmcnt(25)
    v_perm_b32 v32, v84, v80, s57
    v_perm_b32 v33, v92, v88, s57
    v_perm_b32 v34, v100, v96, s57
    v_perm_b32 v35, v108, v104, s57
    v_accvgpr_write_b32 a220, v32
    v_accvgpr_write_b32 a221, v33
    v_accvgpr_write_b32 a222, v34
    v_accvgpr_write_b32 a223, v35
    v_perm_b32 v36, v84, v80, s58
    v_perm_b32 v37, v92, v88, s58
    v_perm_b32 v38, v100, v96, s58
    v_perm_b32 v39, v108, v104, s58
    v_accvgpr_write_b32 a216, v36
    v_accvgpr_write_b32 a217, v37
    v_accvgpr_write_b32 a218, v38
    v_accvgpr_write_b32 a219, v39
    v_perm_b32 v40, v85, v81, s57
    v_perm_b32 v41, v93, v89, s57
    v_perm_b32 v42, v101, v97, s57
    v_perm_b32 v43, v109, v105, s57
    v_accvgpr_write_b32 a212, v40
    v_accvgpr_write_b32 a213, v41
    v_accvgpr_write_b32 a214, v42
    v_accvgpr_write_b32 a215, v43
    v_perm_b32 v44, v85, v81, s58
    v_perm_b32 v45, v93, v89, s58
    v_perm_b32 v46, v101, v97, s58
    v_perm_b32 v47, v109, v105, s58
    v_accvgpr_write_b32 a208, v44
    v_accvgpr_write_b32 a209, v45
    v_accvgpr_write_b32 a210, v46
    v_accvgpr_write_b32 a211, v47
    v_perm_b32 v32, v86, v82, s57
    v_perm_b32 v33, v94, v90, s57
    v_perm_b32 v34, v102, v98, s57
    v_perm_b32 v35, v110, v106, s57
    v_accvgpr_write_b32 a204, v32
    v_accvgpr_write_b32 a205, v33
    v_accvgpr_write_b32 a206, v34
    v_accvgpr_write_b32 a207, v35
    v_perm_b32 v36, v86, v82, s58
    v_perm_b32 v37, v94, v90, s58
    v_perm_b32 v38, v102, v98, s58
    v_perm_b32 v39, v110, v106, s58
    v_accvgpr_write_b32 a200, v36
    v_accvgpr_write_b32 a201, v37
    v_accvgpr_write_b32 a202, v38
    v_accvgpr_write_b32 a203, v39
    v_perm_b32 v40, v87, v83, s57
    v_perm_b32 v41, v95, v91, s57
    v_perm_b32 v42, v103, v99, s57
    v_perm_b32 v43, v111, v107, s57
    v_accvgpr_write_b32 a196, v40
    v_accvgpr_write_b32 a197, v41
    v_accvgpr_write_b32 a198, v42
    v_accvgpr_write_b32 a199, v43
    v_perm_b32 v44, v87, v83, s58
    v_perm_b32 v45, v95, v91, s58
    v_perm_b32 v46, v103, v99, s58
    v_perm_b32 v47, v111, v107, s58
    v_accvgpr_write_b32 a192, v44
    v_accvgpr_write_b32 a193, v45
    v_accvgpr_write_b32 a194, v46
    v_accvgpr_write_b32 a195, v47
    s_add_u32 s53, s99, 0x0
    s_and_b32 s53, s53, 0x1fffff
    buffer_load_dwordx4 v[80:83], v2, s[8:11], s53 offen offset:0
    buffer_load_dwordx4 v[84:87], v2, s[8:11], s53 offen offset:1024
    buffer_load_dwordx4 v[88:91], v2, s[8:11], s53 offen offset:2048
    buffer_load_dwordx4 v[92:95], v2, s[8:11], s53 offen offset:3072
    s_add_u32 s53, s53, 0x1000
    buffer_load_dwordx4 v[96:99], v2, s[8:11], s53 offen offset:0
    buffer_load_dwordx4 v[100:103], v2, s[8:11], s53 offen offset:1024
    buffer_load_dwordx4 v[104:107], v2, s[8:11], s53 offen offset:2048
    buffer_load_dwordx4 v[108:111], v2, s[8:11], s53 offen offset:3072
    s_waitcnt vmcnt(8)
    v_perm_b32 v32, v116, v112, s57
    v_perm_b32 v33, v124, v120, s57
    v_perm_b32 v34, v132, v128, s57
    v_perm_b32 v35, v140, v136, s57
    v_accvgpr_write_b32 a252, v32
    v_accvgpr_write_b32 a253, v33
    v_accvgpr_write_b32 a254, v34
    v_accvgpr_write_b32 a255, v35
    v_perm_b32 v36, v116, v112, s58
    v_perm_b32 v37, v124, v120, s58
    v_perm_b32 v38, v132, v128, s58
    v_perm_b32 v39, v140, v136, s58
    v_accvgpr_write_b32 a248, v36
    v_accvgpr_write_b32 a249, v37
    v_accvgpr_write_b32 a250, v38
    v_accvgpr_write_b32 a251, v39
    v_perm_b32 v40, v117, v113, s57
    v_perm_b32 v41, v125, v121, s57
    v_perm_b32 v42, v133, v129, s57
    v_perm_b32 v43, v141, v137, s57
    v_accvgpr_write_b32 a244, v40
    v_accvgpr_write_b32 a245, v41
    v_accvgpr_write_b32 a246, v42
    v_accvgpr_write_b32 a247, v43
    v_perm_b32 v44, v117, v113, s58
    v_perm_b32 v45, v125, v121, s58
    v_perm_b32 v46, v133, v129, s58
    v_perm_b32 v47, v141, v137, s58
    v_accvgpr_write_b32 a240, v44
    v_accvgpr_write_b32 a241, v45
    v_accvgpr_write_b32 a242, v46
    v_accvgpr_write_b32 a243, v47
    v_perm_b32 v32, v118, v114, s57
    v_perm_b32 v33, v126, v122, s57
    v_perm_b32 v34, v134, v130, s57
    v_perm_b32 v35, v142, v138, s57
    v_accvgpr_write_b32 a236, v32
    v_accvgpr_write_b32 a237, v33
    v_accvgpr_write_b32 a238, v34
    v_accvgpr_write_b32 a239, v35
    v_perm_b32 v36, v118, v114, s58
    v_perm_b32 v37, v126, v122, s58
    v_perm_b32 v38, v134, v130, s58
    v_perm_b32 v39, v142, v138, s58
    v_accvgpr_write_b32 a232, v36
    v_accvgpr_write_b32 a233, v37
    v_accvgpr_write_b32 a234, v38
    v_accvgpr_write_b32 a235, v39
    v_perm_b32 v40, v119, v115, s57
    v_perm_b32 v41, v127, v123, s57
    v_perm_b32 v42, v135, v131, s57
    v_perm_b32 v43, v143, v139, s57
    v_accvgpr_write_b32 a228, v40
    v_accvgpr_write_b32 a229, v41
    v_accvgpr_write_b32 a230, v42
    v_accvgpr_write_b32 a231, v43
    v_perm_b32 v44, v119, v115, s58
    v_perm_b32 v45, v127, v123, s58
    v_perm_b32 v46, v135, v131, s58
    v_perm_b32 v47, v143, v139, s58
    v_accvgpr_write_b32 a224, v44
    v_accvgpr_write_b32 a225, v45
    v_accvgpr_write_b32 a226, v46
    v_accvgpr_write_b32 a227, v47
    s_add_u32 s53, s99, 0x20000
    s_and_b32 s53, s53, 0x1fffff
    buffer_load_dwordx4 v[112:115], v2, s[8:11], s53 offen offset:0
    buffer_load_dwordx4 v[116:119], v2, s[8:11], s53 offen offset:1024
    buffer_load_dwordx4 v[120:123], v2, s[8:11], s53 offen offset:2048
    buffer_load_dwordx4 v[124:127], v2, s[8:11], s53 offen offset:3072
    s_add_u32 s53, s53, 0x1000
    buffer_load_dwordx4 v[128:131], v2, s[8:11], s53 offen offset:0
    buffer_load_dwordx4 v[132:135], v2, s[8:11], s53 offen offset:1024
    buffer_load_dwordx4 v[136:139], v2, s[8:11], s53 offen offset:2048
    buffer_load_dwordx4 v[140:143], v2, s[8:11], s53 offen offset:3072
    s_getreg_b32 s88, hwreg(HW_REG_XCC_ID, 0, 4)
    s_waitcnt vmcnt(24)
    v_cmp_ne_u32 vcc, s88, v13
    s_nop 0
    s_cmp_eq_u64 vcc, 0
    s_cselect_b32 s88, 1, 0
    v_max3_u32 v5, v48, v49, v50
    v_max3_u32 v5, v5, v51, v52
    v_max3_u32 v5, v5, v53, v54
    v_max3_u32 v5, v5, v55, v56
    v_max3_u32 v5, v5, v57, v58
    v_max3_u32 v5, v5, v59, v60
    v_max3_u32 v5, v5, v61, v62
    v_max3_u32 v5, v5, v63, v64
    v_max3_u32 v5, v5, v65, v66
    v_max3_u32 v5, v5, v67, v68
    v_max3_u32 v5, v5, v69, v70
    v_max3_u32 v5, v5, v71, v72
    v_max3_u32 v5, v5, v73, v74
    v_max3_u32 v5, v5, v75, v76
    v_max3_u32 v5, v5, v77, v78
    v_max_u32 v5, v5, v79
    v_cmp_eq_u32 vcc, -1, v5
    v_add_f32 v48, v48, v56
    v_add_f32 v64, v64, v72
    v_add_f32 v49, v49, v57
    v_add_f32 v65, v65, v73
    v_add_f32 v50, v50, v58
    v_add_f32 v66, v66, v74
    v_add_f32 v51, v51, v59
    v_add_f32 v67, v67, v75
    v_add_f32 v52, v52, v60
    v_add_f32 v68, v68, v76
    v_add_f32 v53, v53, v61
    v_add_f32 v69, v69, v77
    v_add_f32 v54, v54, v62
    v_add_f32 v70, v70, v78
    v_add_f32 v55, v55, v63
    v_add_f32 v71, v71, v79
    v_add_f32 v48, v48, v64
    v_add_f32 v49, v49, v65
    v_add_f32 v50, v50, v66
    v_add_f32 v51, v51, v67
    v_add_f32 v52, v52, v68
    v_add_f32 v53, v53, v69
    v_add_f32 v54, v54, v70
    v_add_f32 v55, v55, v71
    v_cvt_pk_bf16_f32 v12, v48, v49
    v_cvt_pk_bf16_f32 v13, v50, v51
    v_cvt_pk_bf16_f32 v14, v52, v53
    v_cvt_pk_bf16_f32 v15, v54, v55
    s_cbranch_vccz L_q1ok
    v_and_b32 v4, 3, v1
    v_lshlrev_b32 v4, 11, v4
    v_lshrrev_b32 v5, 5, v1
    v_lshl_add_u32 v4, v5, 10, v4
    v_bfe_u32 v5, v1, 4, 1
    v_lshl_add_u32 v4, v5, 7, v4
    v_bfe_u32 v5, v1, 2, 2
    v_lshl_add_u32 v4, v5, 3, v4
    s_lshr_b32 s66, s3, 5
    s_lshl_b32 s66, s66, 13
    s_add_u32 s66, s66, 0xb0000
    v_add_u32 v4, s66, v4
L_poll_30:
    buffer_load_dwordx2 v[16:17], v4, s[16:19], 0 offen offset:0 sc1
    buffer_load_dwordx2 v[18:19], v4, s[16:19], 0 offen offset:32 sc1
    buffer_load_dwordx2 v[20:21], v4, s[16:19], 0 offen offset:64 sc1
    buffer_load_dwordx2 v[22:23], v4, s[16:19], 0 offen offset:96 sc1
    buffer_load_dwordx2 v[24:25], v4, s[16:19], 0 offen offset:256 sc1
    buffer_load_dwordx2 v[26:27], v4, s[16:19], 0 offen offset:288 sc1
    buffer_load_dwordx2 v[28:29], v4, s[16:19], 0 offen offset:320 sc1
    buffer_load_dwordx2 v[30:31], v4, s[16:19], 0 offen offset:352 sc1
    buffer_load_dwordx2 v[32:33], v4, s[16:19], 0 offen offset:512 sc1
    buffer_load_dwordx2 v[34:35], v4, s[16:19], 0 offen offset:544 sc1
    buffer_load_dwordx2 v[36:37], v4, s[16:19], 0 offen offset:576 sc1
    buffer_load_dwordx2 v[38:39], v4, s[16:19], 0 offen offset:608 sc1
    buffer_load_dwordx2 v[40:41], v4, s[16:19], 0 offen offset:768 sc1
    buffer_load_dwordx2 v[42:43], v4, s[16:19], 0 offen offset:800 sc1
    buffer_load_dwordx2 v[44:45], v4, s[16:19], 0 offen offset:832 sc1
    buffer_load_dwordx2 v[46:47], v4, s[16:19], 0 offen offset:864 sc1
    s_waitcnt vmcnt(0)
    v_max3_u32 v5, v16, v17, v18
    v_max3_u32 v5, v5, v19, v20
    v_max3_u32 v5, v5, v21, v22
    v_max3_u32 v5, v5, v23, v24
    v_max3_u32 v5, v5, v25, v26
    v_max3_u32 v5, v5, v27, v28
    v_max3_u32 v5, v5, v29, v30
    v_max3_u32 v5, v5, v31, v32
    v_max3_u32 v5, v5, v33, v34
    v_max3_u32 v5, v5, v35, v36
    v_max3_u32 v5, v5, v37, v38
    v_max3_u32 v5, v5, v39, v40
    v_max3_u32 v5, v5, v41, v42
    v_max3_u32 v5, v5, v43, v44
    v_max3_u32 v5, v5, v45, v46
    v_max_u32 v5, v5, v47
    v_cmp_eq_u32 vcc, -1, v5
    s_cbranch_vccz L_pdone_31
    s_mov_b64 exec, vcc
    s_sub_u32 s56, s56, 1
    s_cmp_eq_u32 s56, 0
    s_cbranch_scc0 L_poll_30
    s_mov_b32 s56, 1
L_pdone_31:
    s_mov_b64 exec, -1
    v_add_f32 v16, v16, v24
    v_add_f32 v32, v32, v40
    v_add_f32 v17, v17, v25
    v_add_f32 v33, v33, v41
    v_add_f32 v18, v18, v26
    v_add_f32 v34, v34, v42
    v_add_f32 v19, v19, v27
    v_add_f32 v35, v35, v43
    v_add_f32 v20, v20, v28
    v_add_f32 v36, v36, v44
    v_add_f32 v21, v21, v29
    v_add_f32 v37, v37, v45
    v_add_f32 v22, v22, v30
    v_add_f32 v38, v38, v46
    v_add_f32 v23, v23, v31
    v_add_f32 v39, v39, v47
    v_add_f32 v16, v16, v32
    v_add_f32 v17, v17, v33
    v_add_f32 v18, v18, v34
    v_add_f32 v19, v19, v35
    v_add_f32 v20, v20, v36
    v_add_f32 v21, v21, v37
    v_add_f32 v22, v22, v38
    v_add_f32 v23, v23, v39
    v_cvt_pk_bf16_f32 v12, v16, v17
    v_cvt_pk_bf16_f32 v13, v18, v19
    v_cvt_pk_bf16_f32 v14, v20, v21
    v_cvt_pk_bf16_f32 v15, v22, v23
L_q1ok:
    s_waitcnt lgkmcnt(0)
L_pass:
    v_mov_b32 v48, 0
    v_mov_b32 v49, 0
    v_mov_b32 v50, 0
    v_mov_b32 v51, 0
    v_mov_b32 v52, 0
    v_mov_b32 v53, 0
    v_mov_b32 v54, 0
    v_mov_b32 v55, 0
    v_mov_b32 v56, 0
    v_mov_b32 v57, 0
    v_mov_b32 v58, 0
    v_mov_b32 v59, 0
    v_mov_b32 v60, 0
    v_mov_b32 v61, 0
    v_mov_b32 v62, 0
    v_mov_b32 v63, 0
    v_mov_b32 v64, 0
    v_mov_b32 v65, 0
    v_mov_b32 v66, 0
    v_mov_b32 v67, 0
    v_mov_b32 v68, 0
    v_mov_b32 v69, 0
    v_mov_b32 v70, 0
    v_mov_b32 v71, 0
    v_mov_b32 v72, 0
    v_mov_b32 v73, 0
    v_mov_b32 v74, 0
    v_mov_b32 v75, 0
    v_mov_b32 v76, 0
    v_mov_b32 v77, 0
    v_mov_b32 v78, 0
    v_mov_b32 v79, 0
    v_mov_b32 v11, 0
    s_waitcnt vmcnt(8)
    v_mfma_f32_16x16x32_bf16 v[32:35], v[80:83], v[12:15], 0
    v_mfma_f32_16x16x32_bf16 v[36:39], v[84:87], v[12:15], 0
    v_mfma_f32_16x16x32_bf16 v[40:43], v[88:91], v[12:15], 0
    v_mfma_f32_16x16x32_bf16 v[44:47], v[92:95], v[12:15], 0
    s_nop 4
    v_add_f32_dpp v4, v33, v32 row_ror:12 row_mask:0xf bank_mask:0xf
    v_add_f32_dpp v5, v37, v36 row_ror:12 row_mask:0xf bank_mask:0xf
    v_add_f32_dpp v6, v41, v40 row_ror:12 row_mask:0xf bank_mask:0xf
    v_add_f32_dpp v7, v45, v44 row_ror:12 row_mask:0xf bank_mask:0xf
    v_add_f32_dpp v4, v34, v4 row_ror:8 row_mask:0xf bank_mask:0xf
    v_add_f32_dpp v5, v38, v5 row_ror:8 row_mask:0xf bank_mask:0xf
    v_add_f32_dpp v6, v42, v6 row_ror:8 row_mask:0xf bank_mask:0xf
    v_add_f32_dpp v7, v46, v7 row_ror:8 row_mask:0xf bank_mask:0xf
    v_add_f32_dpp v16, v35, v4 row_ror:4 row_mask:0xf bank_mask:0x1
    v_add_f32_dpp v17, v39, v5 row_ror:4 row_mask:0xf bank_mask:0x1
    v_add_f32_dpp v18, v43, v6 row_ror:4 row_mask:0xf bank_mask:0x1
    v_add_f32_dpp v19, v47, v7 row_ror:4 row_mask:0xf bank_mask:0x1
    v_mfma_f32_16x16x32_bf16 v[32:35], v[96:99], v[12:15], 0
    v_mfma_f32_16x16x32_bf16 v[36:39], v[100:103], v[12:15], 0
    v_mfma_f32_16x16x32_bf16 v[40:43], v[104:107], v[12:15], 0
    v_mfma_f32_16x16x32_bf16 v[44:47], v[108:111], v[12:15], 0
    s_add_u32 s53, s99, 0x40000
    s_and_b32 s53, s53, 0x1fffff
    buffer_load_dwordx4 v[80:83], v2, s[8:11], s53 offen offset:0 nt
    buffer_load_dwordx4 v[84:87], v2, s[8:11], s53 offen offset:1024 nt
    buffer_load_dwordx4 v[88:91], v2, s[8:11], s53 offen offset:2048 nt
    buffer_load_dwordx4 v[92:95], v2, s[8:11], s53 offen offset:3072 nt
    s_add_u32 s53, s53, 0x1000
    buffer_load_dwordx4 v[96:99], v2, s[8:11], s53 offen offset:0 nt
    buffer_load_dwordx4 v[100:103], v2, s[8:11], s53 offen offset:1024 nt
    buffer_load_dwordx4 v[104:107], v2, s[8:11], s53 offen offset:2048 nt
    buffer_load_dwordx4 v[108:111], v2, s[8:11], s53 offen offset:3072 nt
    v_add_f32_dpp v4, v33, v32 row_ror:12 row_mask:0xf bank_mask:0xf
    v_add_f32_dpp v5, v37, v36 row_ror:12 row_mask:0xf bank_mask:0xf
    v_add_f32_dpp v6, v41, v40 row_ror:12 row_mask:0xf bank_mask:0xf
    v_add_f32_dpp v7, v45, v44 row_ror:12 row_mask:0xf bank_mask:0xf
    v_add_f32_dpp v4, v34, v4 row_ror:8 row_mask:0xf bank_mask:0xf
    v_add_f32_dpp v5, v38, v5 row_ror:8 row_mask:0xf bank_mask:0xf
    v_add_f32_dpp v6, v42, v6 row_ror:8 row_mask:0xf bank_mask:0xf
    v_add_f32_dpp v7, v46, v7 row_ror:8 row_mask:0xf bank_mask:0xf
    v_add_f32_dpp v20, v35, v4 row_ror:4 row_mask:0xf bank_mask:0x1
    v_add_f32_dpp v21, v39, v5 row_ror:4 row_mask:0xf bank_mask:0x1
    v_add_f32_dpp v22, v43, v6 row_ror:4 row_mask:0xf bank_mask:0x1
    v_add_f32_dpp v23, v47, v7 row_ror:4 row_mask:0xf bank_mask:0x1
    s_waitcnt vmcnt(8)
    v_mfma_f32_16x16x32_bf16 v[32:35], v[112:115], v[12:15], 0
    v_mfma_f32_16x16x32_bf16 v[36:39], v[116:119], v[12:15], 0
    v_mfma_f32_16x16x32_bf16 v[40:43], v[120:123], v[12:15], 0
    v_mfma_f32_16x16x32_bf16 v[44:47], v[124:127], v[12:15], 0
    s_nop 4
    v_add_f32_dpp v4, v32, v33 row_ror:4 row_mask:0xf bank_mask:0xf
    v_add_f32_dpp v5, v36, v37 row_ror:4 row_mask:0xf bank_mask:0xf
    v_add_f32_dpp v6, v40, v41 row_ror:4 row_mask:0xf bank_mask:0xf
    v_add_f32_dpp v7, v44, v45 row_ror:4 row_mask:0xf bank_mask:0xf
    v_add_f32_dpp v4, v34, v4 row_ror:12 row_mask:0xf bank_mask:0xf
    v_add_f32_dpp v5, v38, v5 row_ror:12 row_mask:0xf bank_mask:0xf
    v_add_f32_dpp v6, v42, v6 row_ror:12 row_mask:0xf bank_mask:0xf
    v_add_f32_dpp v7, v46, v7 row_ror:12 row_mask:0xf bank_mask:0xf
    v_add_f32_dpp v16, v35, v4 row_ror:8 row_mask:0xf bank_mask:0x2
    v_add_f32_dpp v17, v39, v5 row_ror:8 row_mask:0xf bank_mask:0x2
    v_add_f32_dpp v18, v43, v6 row_ror:8 row_mask:0xf bank_mask:0x2
    v_add_f32_dpp v19, v47, v7 row_ror:8 row_mask:0xf bank_mask:0x2
    v_mfma_f32_16x16x32_bf16 v[32:35], v[128:131], v[12:15], 0
    v_mfma_f32_16x16x32_bf16 v[36:39], v[132:135], v[12:15], 0
    v_mfma_f32_16x16x32_bf16 v[40:43], v[136:139], v[12:15], 0
    v_mfma_f32_16x16x32_bf16 v[44:47], v[140:143], v[12:15], 0
    s_mul_i32 s66, s54, 0x40000
    s_add_u32 s99, s99, s66
    s_add_u32 s53, s99, 0x60000
    s_and_b32 s53, s53, 0x1fffff
    buffer_load_dwordx4 v[112:115], v2, s[8:11], s53 offen offset:0 nt
    buffer_load_dwordx4 v[116:119], v2, s[8:11], s53 offen offset:1024 nt
    buffer_load_dwordx4 v[120:123], v2, s[8:11], s53 offen offset:2048 nt
    buffer_load_dwordx4 v[124:127], v2, s[8:11], s53 offen offset:3072 nt
    s_add_u32 s53, s53, 0x1000
    buffer_load_dwordx4 v[128:131], v2, s[8:11], s53 offen offset:0 nt
    buffer_load_dwordx4 v[132:135], v2, s[8:11], s53 offen offset:1024 nt
    buffer_load_dwordx4 v[136:139], v2, s[8:11], s53 offen offset:2048 nt
    buffer_load_dwordx4 v[140:143], v2, s[8:11], s53 offen offset:3072 nt
    s_sub_u32 s99, s99, s66
    v_add_f32_dpp v4, v32, v33 row_ror:4 row_mask:0xf bank_mask:0xf
    v_add_f32_dpp v5, v36, v37 row_ror:4 row_mask:0xf bank_mask:0xf
    v_add_f32_dpp v6, v40, v41 row_ror:4 row_mask:0xf bank_mask:0xf
    v_add_f32_dpp v7, v44, v45 row_ror:4 row_mask:0xf bank_mask:0xf
    v_add_f32_dpp v4, v34, v4 row_ror:12 row_mask:0xf bank_mask:0xf
    v_add_f32_dpp v5, v38, v5 row_ror:12 row_mask:0xf bank_mask:0xf
    v_add_f32_dpp v6, v42, v6 row_ror:12 row_mask:0xf bank_mask:0xf
    v_add_f32_dpp v7, v46, v7 row_ror:12 row_mask:0xf bank_mask:0xf
    v_add_f32_dpp v20, v35, v4 row_ror:8 row_mask:0xf bank_mask:0x2
    v_add_f32_dpp v21, v39, v5 row_ror:8 row_mask:0xf bank_mask:0x2
    v_add_f32_dpp v22, v43, v6 row_ror:8 row_mask:0xf bank_mask:0x2
    v_add_f32_dpp v23, v47, v7 row_ror:8 row_mask:0xf bank_mask:0x2
    s_waitcnt vmcnt(8)
    v_mfma_f32_16x16x32_bf16 v[32:35], v[80:83], v[12:15], 0
    v_mfma_f32_16x16x32_bf16 v[36:39], v[84:87], v[12:15], 0
    v_mfma_f32_16x16x32_bf16 v[40:43], v[88:91], v[12:15], 0
    v_mfma_f32_16x16x32_bf16 v[44:47], v[92:95], v[12:15], 0
    s_nop 4
    v_add_f32_dpp v4, v32, v34 row_ror:8 row_mask:0xf bank_mask:0xf
    v_add_f32_dpp v5, v36, v38 row_ror:8 row_mask:0xf bank_mask:0xf
    v_add_f32_dpp v6, v40, v42 row_ror:8 row_mask:0xf bank_mask:0xf
    v_add_f32_dpp v7, v44, v46 row_ror:8 row_mask:0xf bank_mask:0xf
    v_add_f32_dpp v4, v33, v4 row_ror:4 row_mask:0xf bank_mask:0xf
    v_add_f32_dpp v5, v37, v5 row_ror:4 row_mask:0xf bank_mask:0xf
    v_add_f32_dpp v6, v41, v6 row_ror:4 row_mask:0xf bank_mask:0xf
    v_add_f32_dpp v7, v45, v7 row_ror:4 row_mask:0xf bank_mask:0xf
    v_add_f32_dpp v16, v35, v4 row_ror:12 row_mask:0xf bank_mask:0x4
    v_add_f32_dpp v17, v39, v5 row_ror:12 row_mask:0xf bank_mask:0x4
    v_add_f32_dpp v18, v43, v6 row_ror:12 row_mask:0xf bank_mask:0x4
    v_add_f32_dpp v19, v47, v7 row_ror:12 row_mask:0xf bank_mask:0x4
    v_mfma_f32_16x16x32_bf16 v[32:35], v[96:99], v[12:15], 0
    v_mfma_f32_16x16x32_bf16 v[36:39], v[100:103], v[12:15], 0
    v_mfma_f32_16x16x32_bf16 v[40:43], v[104:107], v[12:15], 0
    v_mfma_f32_16x16x32_bf16 v[44:47], v[108:111], v[12:15], 0
    s_add_u32 s53, s99, 0x80000
    s_and_b32 s53, s53, 0x1fffff
    buffer_load_dwordx4 v[80:83], v2, s[8:11], s53 offen offset:0 nt
    buffer_load_dwordx4 v[84:87], v2, s[8:11], s53 offen offset:1024 nt
    buffer_load_dwordx4 v[88:91], v2, s[8:11], s53 offen offset:2048 nt
    buffer_load_dwordx4 v[92:95], v2, s[8:11], s53 offen offset:3072 nt
    s_add_u32 s53, s53, 0x1000
    buffer_load_dwordx4 v[96:99], v2, s[8:11], s53 offen offset:0 nt
    buffer_load_dwordx4 v[100:103], v2, s[8:11], s53 offen offset:1024 nt
    buffer_load_dwordx4 v[104:107], v2, s[8:11], s53 offen offset:2048 nt
    buffer_load_dwordx4 v[108:111], v2, s[8:11], s53 offen offset:3072 nt
    v_add_f32_dpp v4, v32, v34 row_ror:8 row_mask:0xf bank_mask:0xf
    v_add_f32_dpp v5, v36, v38 row_ror:8 row_mask:0xf bank_mask:0xf
    v_add_f32_dpp v6, v40, v42 row_ror:8 row_mask:0xf bank_mask:0xf
    v_add_f32_dpp v7, v44, v46 row_ror:8 row_mask:0xf bank_mask:0xf
    v_add_f32_dpp v4, v33, v4 row_ror:4 row_mask:0xf bank_mask:0xf
    v_add_f32_dpp v5, v37, v5 row_ror:4 row_mask:0xf bank_mask:0xf
    v_add_f32_dpp v6, v41, v6 row_ror:4 row_mask:0xf bank_mask:0xf
    v_add_f32_dpp v7, v45, v7 row_ror:4 row_mask:0xf bank_mask:0xf
    v_add_f32_dpp v20, v35, v4 row_ror:12 row_mask:0xf bank_mask:0x4
    v_add_f32_dpp v21, v39, v5 row_ror:12 row_mask:0xf bank_mask:0x4
    v_add_f32_dpp v22, v43, v6 row_ror:12 row_mask:0xf bank_mask:0x4
    v_add_f32_dpp v23, v47, v7 row_ror:12 row_mask:0xf bank_mask:0x4
    s_cmp_lg_u32 s54, 0
    s_cbranch_scc1 L_kd3
    s_waitcnt vmcnt(8)
    v_mfma_f32_16x16x32_bf16 v[32:35], v[112:115], v[12:15], 0
    v_mfma_f32_16x16x32_bf16 v[36:39], v[116:119], v[12:15], 0
    v_mfma_f32_16x16x32_bf16 v[40:43], v[120:123], v[12:15], 0
    v_mfma_f32_16x16x32_bf16 v[44:47], v[124:127], v[12:15], 0
    s_nop 4
    v_add_f32_dpp v4, v32, v35 row_ror:12 row_mask:0xf bank_mask:0xf
    v_add_f32_dpp v5, v36, v39 row_ror:12 row_mask:0xf bank_mask:0xf
    v_add_f32_dpp v6, v40, v43 row_ror:12 row_mask:0xf bank_mask:0xf
    v_add_f32_dpp v7, v44, v47 row_ror:12 row_mask:0xf bank_mask:0xf
    v_add_f32_dpp v4, v33, v4 row_ror:8 row_mask:0xf bank_mask:0xf
    v_add_f32_dpp v5, v37, v5 row_ror:8 row_mask:0xf bank_mask:0xf
    v_add_f32_dpp v6, v41, v6 row_ror:8 row_mask:0xf bank_mask:0xf
    v_add_f32_dpp v7, v45, v7 row_ror:8 row_mask:0xf bank_mask:0xf
    v_add_f32_dpp v16, v34, v4 row_ror:4 row_mask:0xf bank_mask:0x8
    v_add_f32_dpp v17, v38, v5 row_ror:4 row_mask:0xf bank_mask:0x8
    v_add_f32_dpp v18, v42, v6 row_ror:4 row_mask:0xf bank_mask:0x8
    v_add_f32_dpp v19, v46, v7 row_ror:4 row_mask:0xf bank_mask:0x8
    v_mfma_f32_16x16x32_bf16 v[32:35], v[128:131], v[12:15], 0
    v_mfma_f32_16x16x32_bf16 v[36:39], v[132:135], v[12:15], 0
    v_mfma_f32_16x16x32_bf16 v[40:43], v[136:139], v[12:15], 0
    v_mfma_f32_16x16x32_bf16 v[44:47], v[140:143], v[12:15], 0
    s_nop 4
    v_add_f32_dpp v4, v32, v35 row_ror:12 row_mask:0xf bank_mask:0xf
    v_add_f32_dpp v5, v36, v39 row_ror:12 row_mask:0xf bank_mask:0xf
    v_add_f32_dpp v6, v40, v43 row_ror:12 row_mask:0xf bank_mask:0xf
    v_add_f32_dpp v7, v44, v47 row_ror:12 row_mask:0xf bank_mask:0xf
    v_add_f32_dpp v4, v33, v4 row_ror:8 row_mask:0xf bank_mask:0xf
    v_add_f32_dpp v5, v37, v5 row_ror:8 row_mask:0xf bank_mask:0xf
    v_add_f32_dpp v6, v41, v6 row_ror:8 row_mask:0xf bank_mask:0xf
    v_add_f32_dpp v7, v45, v7 row_ror:8 row_mask:0xf bank_mask:0xf
    v_add_f32_dpp v20, v34, v4 row_ror:4 row_mask:0xf bank_mask:0x8
    v_add_f32_dpp v21, v38, v5 row_ror:4 row_mask:0xf bank_mask:0x8
    v_add_f32_dpp v22, v42, v6 row_ror:4 row_mask:0xf bank_mask:0x8
    v_add_f32_dpp v23, v46, v7 row_ror:4 row_mask:0xf bank_mask:0x8
    v_pk_max_i16 v32, v112, v113
    v_pk_max_i16 v33, v120, v121
    v_pk_max_u16 v34, v128, v129
    v_pk_max_u16 v35, v136, v137
    v_pk_max_i16 v32, v32, v114
    v_pk_max_i16 v33, v33, v122
    v_pk_max_u16 v34, v34, v130
    v_pk_max_u16 v35, v35, v138
    v_pk_max_i16 v32, v32, v115
    v_pk_max_i16 v33, v33, v123
    v_pk_max_u16 v34, v34, v131
    v_pk_max_u16 v35, v35, v139
    v_pk_max_i16 v32, v32, v116
    v_pk_max_i16 v33, v33, v124
    v_pk_max_u16 v34, v34, v132
    v_pk_max_u16 v35, v35, v140
    v_pk_max_i16 v32, v32, v117
    v_pk_max_i16 v33, v33, v125
    v_pk_max_u16 v34, v34, v133
    v_pk_max_u16 v35, v35, v141
    v_pk_max_i16 v32, v32, v118
    v_pk_max_i16 v33, v33, v126
    v_pk_max_u16 v34, v34, v134
    v_pk_max_u16 v35, v35, v142
    v_pk_max_i16 v32, v32, v119
    v_pk_max_i16 v33, v33, v127
    v_pk_max_u16 v34, v34, v135
    v_pk_max_u16 v35, v35, v143
    v_pk_max_i16 v32, v32, v33
    v_pk_max_u16 v34, v34, v35
    v_and_b32 v32, 0x7fff7fff, v32
    v_and_b32 v34, 0x7fff7fff, v34
    v_pk_max_u16 v32, v32, v34
    v_lshrrev_b32 v33, 16, v32
    v_and_b32 v32, 0xffff, v32
    v_max_u32 v32, v32, v33
    s_nop 1
    v_max_u32_dpp v32, v32, v32 quad_perm:[1,0,3,2] row_mask:0xf bank_mask:0xf
    s_nop 1
    v_max_u32_dpp v32, v32, v32 quad_perm:[2,3,0,1] row_mask:0xf bank_mask:0xf
    s_nop 1
    v_max_u32_dpp v32, v32, v32 row_ror:4 row_mask:0xf bank_mask:0xf
    s_nop 1
    v_max_u32_dpp v32, v32, v32 row_ror:8 row_mask:0xf bank_mask:0xf
    s_nop 1
    v_max_u32_dpp v32, v32, v32 row_bcast:15 row_mask:0xa bank_mask:0xf
    s_nop 1
    v_max_u32_dpp v32, v32, v32 row_bcast:31 row_mask:0xc bank_mask:0xf
    s_nop 0
    v_readlane_b32 s82, v32, 63
    s_nop 0
    s_lshr_b32 s82, s82, 7
    s_max_u32 s82, s82, 15
    s_sub_u32 s82, s82, 15
    s_mul_i32 s75, s82, 0x00800080
    v_pk_sub_u16 v44, v112, s85
    v_pk_sub_u16 v42, v113, s85
    v_pk_min_u16 v44, v44, v42
    v_pk_sub_u16 v42, v114, s85
    v_pk_min_u16 v44, v44, v42
    v_pk_sub_u16 v42, v115, s85
    v_pk_min_u16 v44, v44, v42
    v_pk_sub_u16 v40, v112, s75 clamp
    v_pk_sub_u16 v41, v113, s75 clamp
    v_perm_b32 v184, v41, v40, s70
    v_perm_b32 v40, v41, v40, s71
    v_pk_sub_u16 v41, v114, s75 clamp
    v_pk_sub_u16 v42, v115, s75 clamp
    v_perm_b32 v185, v42, v41, s70
    v_perm_b32 v41, v42, v41, s71
    v_or_b32 v43, v40, v41
    v_alignbit_b32 v41, v41, v41, 4
    v_or_b32 v186, v40, v41
    v_pk_sub_u16 v42, v116, s85
    v_pk_min_u16 v44, v44, v42
    v_pk_sub_u16 v42, v117, s85
    v_pk_min_u16 v44, v44, v42
    v_pk_sub_u16 v42, v118, s85
    v_pk_min_u16 v44, v44, v42
    v_pk_sub_u16 v42, v119, s85
    v_pk_min_u16 v44, v44, v42
    v_pk_sub_u16 v40, v116, s75 clamp
    v_pk_sub_u16 v41, v117, s75 clamp
    v_perm_b32 v187, v41, v40, s70
    v_perm_b32 v40, v41, v40, s71
    v_pk_sub_u16 v41, v118, s75 clamp
    v_pk_sub_u16 v42, v119, s75 clamp
    v_perm_b32 v188, v42, v41, s70
    v_perm_b32 v41, v42, v41, s71
    v_or3_b32 v43, v43, v40, v41
    v_alignbit_b32 v41, v41, v41, 4
    v_or_b32 v189, v40, v41
    v_pk_sub_u16 v42, v120, s85
    v_pk_min_u16 v44, v44, v42
    v_pk_sub_u16 v42, v121, s85
    v_pk_min_u16 v44, v44, v42
    v_pk_sub_u16 v42, v122, s85
    v_pk_min_u16 v44, v44, v42
    v_pk_sub_u16 v42, v123, s85
    v_pk_min_u16 v44, v44, v42
    v_pk_sub_u16 v40, v120, s75 clamp
    v_pk_sub_u16 v41, v121, s75 clamp
    v_perm_b32 v190, v41, v40, s70
    v_perm_b32 v40, v41, v40, s71
    v_pk_sub_u16 v41, v122, s75 clamp
    v_pk_sub_u16 v42, v123, s75 clamp
    v_perm_b32 v191, v42, v41, s70
    v_perm_b32 v41, v42, v41, s71
    v_or3_b32 v43, v43, v40, v41
    v_alignbit_b32 v41, v41, v41, 4
    v_or_b32 v192, v40, v41
    v_pk_sub_u16 v42, v124, s85
    v_pk_min_u16 v44, v44, v42
    v_pk_sub_u16 v42, v125, s85
    v_pk_min_u16 v44, v44, v42
    v_pk_sub_u16 v42, v126, s85
    v_pk_min_u16 v44, v44, v42
    v_pk_sub_u16 v42, v127, s85
    v_pk_min_u16 v44, v44, v42
    v_pk_sub_u16 v40, v124, s75 clamp
    v_pk_sub_u16 v41, v125, s75 clamp
    v_perm_b32 v193, v41, v40, s70
    v_perm_b32 v40, v41, v40, s71
    v_pk_sub_u16 v41, v126, s75 clamp
    v_pk_sub_u16 v42, v127, s75 clamp
    v_perm_b32 v194, v42, v41, s70
    v_perm_b32 v41, v42, v41, s71
    v_or3_b32 v43, v43, v40, v41
    v_alignbit_b32 v41, v41, v41, 4
    v_or_b32 v195, v40, v41
    v_pk_sub_u16 v42, v128, s85
    v_pk_min_u16 v44, v44, v42
    v_pk_sub_u16 v42, v129, s85
    v_pk_min_u16 v44, v44, v42
    v_pk_sub_u16 v42, v130, s85
    v_pk_min_u16 v44, v44, v42
    v_pk_sub_u16 v42, v131, s85
    v_pk_min_u16 v44, v44, v42
    v_pk_sub_u16 v40, v128, s75 clamp
    v_pk_sub_u16 v41, v129, s75 clamp
    v_perm_b32 v196, v41, v40, s70
    v_perm_b32 v40, v41, v40, s71
    v_pk_sub_u16 v41, v130, s75 clamp
    v_pk_sub_u16 v42, v131, s75 clamp
    v_perm_b32 v197, v42, v41, s70
    v_perm_b32 v41, v42, v41, s71
    v_or3_b32 v43, v43, v40, v41
    v_alignbit_b32 v41, v41, v41, 4
    v_or_b32 v198, v40, v41
    v_pk_sub_u16 v42, v132, s85
    v_pk_min_u16 v44, v44, v42
    v_pk_sub_u16 v42, v133, s85
    v_pk_min_u16 v44, v44, v42
    v_pk_sub_u16 v42, v134, s85
    v_pk_min_u16 v44, v44, v42
    v_pk_sub_u16 v42, v135, s85
    v_pk_min_u16 v44, v44, v42
    v_pk_sub_u16 v40, v132, s75 clamp
    v_pk_sub_u16 v41, v133, s75 clamp
    v_perm_b32 v199, v41, v40, s70
    v_perm_b32 v40, v41, v40, s71
    v_pk_sub_u16 v41, v134, s75 clamp
    v_pk_sub_u16 v42, v135, s75 clamp
    v_perm_b32 v200, v42, v41, s70
    v_perm_b32 v41, v42, v41, s71
    v_or3_b32 v43, v43, v40, v41
    v_alignbit_b32 v41, v41, v41, 4
    v_or_b32 v201, v40, v41
    v_pk_sub_u16 v42, v136, s85
    v_pk_min_u16 v44, v44, v42
    v_pk_sub_u16 v42, v137, s85
    v_pk_min_u16 v44, v44, v42
    v_pk_sub_u16 v42, v138, s85
    v_pk_min_u16 v44, v44, v42
    v_pk_sub_u16 v42, v139, s85
    v_pk_min_u16 v44, v44, v42
    v_pk_sub_u16 v40, v136, s75 clamp
    v_pk_sub_u16 v41, v137, s75 clamp
    v_perm_b32 v202, v41, v40, s70
    v_perm_b32 v40, v41, v40, s71
    v_pk_sub_u16 v41, v138, s75 clamp
    v_pk_sub_u16 v42, v139, s75 clamp
    v_perm_b32 v203, v42, v41, s70
    v_perm_b32 v41, v42, v41, s71
    v_or3_b32 v43, v43, v40, v41
    v_alignbit_b32 v41, v41, v41, 4
    v_or_b32 v204, v40, v41
    v_pk_sub_u16 v42, v140, s85
    v_pk_min_u16 v44, v44, v42
    v_pk_sub_u16 v42, v141, s85
    v_pk_min_u16 v44, v44, v42
    v_pk_sub_u16 v42, v142, s85
    v_pk_min_u16 v44, v44, v42
    v_pk_sub_u16 v42, v143, s85
    v_pk_min_u16 v44, v44, v42
    v_pk_sub_u16 v40, v140, s75 clamp
    v_pk_sub_u16 v41, v141, s75 clamp
    v_perm_b32 v205, v41, v40, s70
    v_perm_b32 v40, v41, v40, s71
    v_pk_sub_u16 v41, v142, s75 clamp
    v_pk_sub_u16 v42, v143, s75 clamp
    v_perm_b32 v206, v42, v41, s70
    v_perm_b32 v41, v42, v41, s71
    v_or3_b32 v43, v43, v40, v41
    v_alignbit_b32 v41, v41, v41, 4
    v_or_b32 v207, v40, v41
    v_pk_sub_u16 v44, s75, v44 clamp
    v_and_b32 v43, 0x78787878, v43
    v_or_b32 v43, v43, v44
    v_cmp_ne_u32 vcc, 0, v43
    s_cbranch_vccnz L_xc_32
L_xcb_33:
    s_add_u32 s53, s99, 0xa0000
    s_and_b32 s53, s53, 0x1fffff
    buffer_load_dwordx4 v[112:115], v2, s[8:11], s53 offen offset:0 nt
    buffer_load_dwordx4 v[116:119], v2, s[8:11], s53 offen offset:1024 nt
    buffer_load_dwordx4 v[120:123], v2, s[8:11], s53 offen offset:2048 nt
    buffer_load_dwordx4 v[124:127], v2, s[8:11], s53 offen offset:3072 nt
    s_add_u32 s53, s53, 0x1000
    buffer_load_dwordx4 v[128:131], v2, s[8:11], s53 offen offset:0 nt
    buffer_load_dwordx4 v[132:135], v2, s[8:11], s53 offen offset:1024 nt
    buffer_load_dwordx4 v[136:139], v2, s[8:11], s53 offen offset:2048 nt
    buffer_load_dwordx4 v[140:143], v2, s[8:11], s53 offen offset:3072 nt
    s_branch L_kj3
L_kd3:
    v_and_b32 v29, s81, v186
    v_alignbit_b32 v31, v186, v186, 28
    v_and_b32 v31, s81, v31
    v_perm_b32 v28, v29, v184, s70
    v_perm_b32 v29, v29, v184, s71
    v_pk_min_u16 v8, v28, s85
    v_pk_mad_u16 v28, v8, s75, v28
    v_pk_min_u16 v8, v29, s85
    v_pk_mad_u16 v29, v8, s75, v29
    v_perm_b32 v30, v31, v185, s70
    v_perm_b32 v31, v31, v185, s71
    v_pk_min_u16 v8, v30, s85
    v_pk_mad_u16 v30, v8, s75, v30
    v_pk_min_u16 v8, v31, s85
    v_pk_mad_u16 v31, v8, s75, v31
    s_bitcmp1_b64 s[92:93], 0
    s_cbranch_scc1 L_xp_35
L_xpb_36:
    v_mfma_f32_16x16x32_bf16 v[32:35], v[28:31], v[12:15], 0
    v_and_b32 v29, s81, v189
    v_alignbit_b32 v31, v189, v189, 28
    v_and_b32 v31, s81, v31
    v_perm_b32 v28, v29, v187, s70
    v_perm_b32 v29, v29, v187, s71
    v_pk_min_u16 v8, v28, s85
    v_pk_mad_u16 v28, v8, s75, v28
    v_pk_min_u16 v8, v29, s85
    v_pk_mad_u16 v29, v8, s75, v29
    v_perm_b32 v30, v31, v188, s70
    v_perm_b32 v31, v31, v188, s71
    v_pk_min_u16 v8, v30, s85
    v_pk_mad_u16 v30, v8, s75, v30
    v_pk_min_u16 v8, v31, s85
    v_pk_mad_u16 v31, v8, s75, v31
    s_bitcmp1_b64 s[92:93], 1
    s_cbranch_scc1 L_xp_37
L_xpb_38:
    v_mfma_f32_16x16x32_bf16 v[36:39], v[28:31], v[12:15], 0
    v_and_b32 v29, s81, v192
    v_alignbit_b32 v31, v192, v192, 28
    v_and_b32 v31, s81, v31
    v_perm_b32 v28, v29, v190, s70
    v_perm_b32 v29, v29, v190, s71
    v_pk_min_u16 v8, v28, s85
    v_pk_mad_u16 v28, v8, s75, v28
    v_pk_min_u16 v8, v29, s85
    v_pk_mad_u16 v29, v8, s75, v29
    v_perm_b32 v30, v31, v191, s70
    v_perm_b32 v31, v31, v191, s71
    v_pk_min_u16 v8, v30, s85
    v_pk_mad_u16 v30, v8, s75, v30
    v_pk_min_u16 v8, v31, s85
    v_pk_mad_u16 v31, v8, s75, v31
    s_bitcmp1_b64 s[92:93], 2
    s_cbranch_scc1 L_xp_39
L_xpb_40:
    v_mfma_f32_16x16x32_bf16 v[40:43], v[28:31], v[12:15], 0
    v_and_b32 v29, s81, v195
    v_alignbit_b32 v31, v195, v195, 28
    v_and_b32 v31, s81, v31
    v_perm_b32 v28, v29, v193, s70
    v_perm_b32 v29, v29, v193, s71
    v_pk_min_u16 v8, v28, s85
    v_pk_mad_u16 v28, v8, s75, v28
    v_pk_min_u16 v8, v29, s85
    v_pk_mad_u16 v29, v8, s75, v29
    v_perm_b32 v30, v31, v194, s70
    v_perm_b32 v31, v31, v194, s71
    v_pk_min_u16 v8, v30, s85
    v_pk_mad_u16 v30, v8, s75, v30
    v_pk_min_u16 v8, v31, s85
    v_pk_mad_u16 v31, v8, s75, v31
    s_bitcmp1_b64 s[92:93], 3
    s_cbranch_scc1 L_xp_41
L_xpb_42:
    v_mfma_f32_16x16x32_bf16 v[44:47], v[28:31], v[12:15], 0
    v_add_f32_dpp v4, v32, v35 row_ror:12 row_mask:0xf bank_mask:0xf
    v_add_f32_dpp v5, v36, v39 row_ror:12 row_mask:0xf bank_mask:0xf
    v_add_f32_dpp v6, v40, v43 row_ror:12 row_mask:0xf bank_mask:0xf
    v_add_f32_dpp v4, v33, v4 row_ror:8 row_mask:0xf bank_mask:0xf
    v_add_f32_dpp v5, v37, v5 row_ror:8 row_mask:0xf bank_mask:0xf
    v_add_f32_dpp v6, v41, v6 row_ror:8 row_mask:0xf bank_mask:0xf
    v_add_f32_dpp v16, v34, v4 row_ror:4 row_mask:0xf bank_mask:0x8
    v_add_f32_dpp v17, v38, v5 row_ror:4 row_mask:0xf bank_mask:0x8
    v_add_f32_dpp v18, v42, v6 row_ror:4 row_mask:0xf bank_mask:0x8
    v_and_b32 v29, s81, v198
    v_alignbit_b32 v31, v198, v198, 28
    v_and_b32 v31, s81, v31
    v_perm_b32 v28, v29, v196, s70
    v_perm_b32 v29, v29, v196, s71
    v_pk_min_u16 v8, v28, s85
    v_pk_mad_u16 v28, v8, s75, v28
    v_pk_min_u16 v8, v29, s85
    v_pk_mad_u16 v29, v8, s75, v29
    v_perm_b32 v30, v31, v197, s70
    v_perm_b32 v31, v31, v197, s71
    v_pk_min_u16 v8, v30, s85
    v_pk_mad_u16 v30, v8, s75, v30
    v_pk_min_u16 v8, v31, s85
    v_pk_mad_u16 v31, v8, s75, v31
    s_bitcmp1_b64 s[92:93], 4
    s_cbranch_scc1 L_xp_43
L_xpb_44:
    v_mfma_f32_16x16x32_bf16 v[32:35], v[28:31], v[12:15], 0
    v_and_b32 v29, s81, v201
    v_alignbit_b32 v31, v201, v201, 28
    v_and_b32 v31, s81, v31
    v_perm_b32 v28, v29, v199, s70
    v_perm_b32 v29, v29, v199, s71
    v_pk_min_u16 v8, v28, s85
    v_pk_mad_u16 v28, v8, s75, v28
    v_pk_min_u16 v8, v29, s85
    v_pk_mad_u16 v29, v8, s75, v29
    v_perm_b32 v30, v31, v200, s70
    v_perm_b32 v31, v31, v200, s71
    v_pk_min_u16 v8, v30, s85
    v_pk_mad_u16 v30, v8, s75, v30
    v_pk_min_u16 v8, v31, s85
    v_pk_mad_u16 v31, v8, s75, v31
    s_bitcmp1_b64 s[92:93], 5
    s_cbranch_scc1 L_xp_45
L_xpb_46:
    v_mfma_f32_16x16x32_bf16 v[36:39], v[28:31], v[12:15], 0
    v_and_b32 v29, s81, v204
    v_alignbit_b32 v31, v204, v204, 28
    v_and_b32 v31, s81, v31
    v_perm_b32 v28, v29, v202, s70
    v_perm_b32 v29, v29, v202, s71
    v_pk_min_u16 v8, v28, s85
    v_pk_mad_u16 v28, v8, s75, v28
    v_pk_min_u16 v8, v29, s85
    v_pk_mad_u16 v29, v8, s75, v29
    v_perm_b32 v30, v31, v203, s70
    v_perm_b32 v31, v31, v203, s71
    v_pk_min_u16 v8, v30, s85
    v_pk_mad_u16 v30, v8, s75, v30
    v_pk_min_u16 v8, v31, s85
    v_pk_mad_u16 v31, v8, s75, v31
    s_bitcmp1_b64 s[92:93], 6
    s_cbranch_scc1 L_xp_47
L_xpb_48:
    v_mfma_f32_16x16x32_bf16 v[40:43], v[28:31], v[12:15], 0
    v_add_f32_dpp v4, v44, v47 row_ror:12 row_mask:0xf bank_mask:0xf
    v_add_f32_dpp v5, v32, v35 row_ror:12 row_mask:0xf bank_mask:0xf
    v_add_f32_dpp v6, v36, v39 row_ror:12 row_mask:0xf bank_mask:0xf
    v_add_f32_dpp v4, v45, v4 row_ror:8 row_mask:0xf bank_mask:0xf
    v_add_f32_dpp v5, v33, v5 row_ror:8 row_mask:0xf bank_mask:0xf
    v_add_f32_dpp v6, v37, v6 row_ror:8 row_mask:0xf bank_mask:0xf
    v_add_f32_dpp v19, v46, v4 row_ror:4 row_mask:0xf bank_mask:0x8
    v_add_f32_dpp v20, v34, v5 row_ror:4 row_mask:0xf bank_mask:0x8
    v_add_f32_dpp v21, v38, v6 row_ror:4 row_mask:0xf bank_mask:0x8
    v_and_b32 v29, s81, v207
    v_alignbit_b32 v31, v207, v207, 28
    v_and_b32 v31, s81, v31
    v_perm_b32 v28, v29, v205, s70
    v_perm_b32 v29, v29, v205, s71
    v_pk_min_u16 v8, v28, s85
    v_pk_mad_u16 v28, v8, s75, v28
    v_pk_min_u16 v8, v29, s85
    v_pk_mad_u16 v29, v8, s75, v29
    v_perm_b32 v30, v31, v206, s70
    v_perm_b32 v31, v31, v206, s71
    v_pk_min_u16 v8, v30, s85
    v_pk_mad_u16 v30, v8, s75, v30
    v_pk_min_u16 v8, v31, s85
    v_pk_mad_u16 v31, v8, s75, v31
    s_bitcmp1_b64 s[92:93], 7
    s_cbranch_scc1 L_xp_49
L_xpb_50:
    v_mfma_f32_16x16x32_bf16 v[44:47], v[28:31], v[12:15], 0
    v_add_f32_dpp v4, v40, v43 row_ror:12 row_mask:0xf bank_mask:0xf
    s_nop 6
    v_add_f32_dpp v5, v44, v47 row_ror:12 row_mask:0xf bank_mask:0xf
    v_add_f32_dpp v4, v41, v4 row_ror:8 row_mask:0xf bank_mask:0xf
    s_nop 0
    v_add_f32_dpp v5, v45, v5 row_ror:8 row_mask:0xf bank_mask:0xf
    v_add_f32_dpp v22, v42, v4 row_ror:4 row_mask:0xf bank_mask:0x8
    s_nop 0
    v_add_f32_dpp v23, v46, v5 row_ror:4 row_mask:0xf bank_mask:0x8
L_kj3:
    v_max3_f32 v4, v16, v17, v18
    v_max3_f32 v5, v19, v20, v21
    v_max3_f32 v4, v4, v22, v23
    v_max_f32 v4, v4, v5
    s_nop 1
    v_max_f32_dpp v4, v4, v4 row_ror:4 row_mask:0xf bank_mask:0xf
    s_nop 1
    v_max_f32_dpp v4, v4, v4 row_ror:8 row_mask:0xf bank_mask:0xf
    v_mov_b32 v5, v4
    s_nop 1
    v_permlane16_swap_b32 v4, v5
    v_max_f32 v4, v4, v5
    v_mov_b32 v5, v4
    s_nop 1
    v_permlane32_swap_b32 v4, v5
    v_max_f32 v4, v4, v5
    v_mul_f32 v5, s60, v4
    v_mov_b32 v10, v4
    v_fma_f32 v16, v16, s60, -v5
    v_fma_f32 v17, v17, s60, -v5
    v_fma_f32 v18, v18, s60, -v5
    v_fma_f32 v19, v19, s60, -v5
    v_fma_f32 v20, v20, s60, -v5
    v_fma_f32 v21, v21, s60, -v5
    v_fma_f32 v22, v22, s60, -v5
    v_fma_f32 v23, v23, s60, -v5
    v_exp_f32 v16, v16
    v_exp_f32 v17, v17
    v_exp_f32 v18, v18
    v_exp_f32 v19, v19
    v_exp_f32 v20, v20
    v_exp_f32 v21, v21
    v_exp_f32 v22, v22
    v_exp_f32 v23, v23
    v_cvt_pk_bf16_f32 v24, v16, v17
    v_cvt_pk_bf16_f32 v25, v18, v19
    v_cvt_pk_bf16_f32 v26, v20, v21
    v_cvt_pk_bf16_f32 v27, v22, v23
    v_add_f32 v11, v11, v16
    v_add_f32 v11, v11, v17
    v_add_f32 v11, v11, v18
    v_add_f32 v11, v11, v19
    v_add_f32 v11, v11, v20
    v_add_f32 v11, v11, v21
    v_add_f32 v11, v11, v22
    v_add_f32 v11, v11, v23
    s_waitcnt vmcnt(8)
    s_cmp_eq_u32 s54, 0
    s_cbranch_scc1 L_kw4
    s_waitcnt vmcnt(0)
L_kw4:
    v_mfma_f32_16x16x32_bf16 v[32:35], v[80:83], v[12:15], 0
    v_mfma_f32_16x16x32_bf16 v[36:39], v[84:87], v[12:15], 0
    v_mfma_f32_16x16x32_bf16 v[40:43], v[88:91], v[12:15], 0
    v_mfma_f32_16x16x32_bf16 v[44:47], v[92:95], v[12:15], 0
    s_nop 4
    v_add_f32_dpp v4, v33, v32 row_ror:12 row_mask:0xf bank_mask:0xf
    v_add_f32_dpp v5, v37, v36 row_ror:12 row_mask:0xf bank_mask:0xf
    v_add_f32_dpp v6, v41, v40 row_ror:12 row_mask:0xf bank_mask:0xf
    v_add_f32_dpp v7, v45, v44 row_ror:12 row_mask:0xf bank_mask:0xf
    v_add_f32_dpp v4, v34, v4 row_ror:8 row_mask:0xf bank_mask:0xf
    v_add_f32_dpp v5, v38, v5 row_ror:8 row_mask:0xf bank_mask:0xf
    v_add_f32_dpp v6, v42, v6 row_ror:8 row_mask:0xf bank_mask:0xf
    v_add_f32_dpp v7, v46, v7 row_ror:8 row_mask:0xf bank_mask:0xf
    v_add_f32_dpp v16, v35, v4 row_ror:4 row_mask:0xf bank_mask:0x1
    v_add_f32_dpp v17, v39, v5 row_ror:4 row_mask:0xf bank_mask:0x1
    v_add_f32_dpp v18, v43, v6 row_ror:4 row_mask:0xf bank_mask:0x1
    v_add_f32_dpp v19, v47, v7 row_ror:4 row_mask:0xf bank_mask:0x1
    v_mfma_f32_16x16x32_bf16 v[32:35], v[96:99], v[12:15], 0
    v_mfma_f32_16x16x32_bf16 v[36:39], v[100:103], v[12:15], 0
    v_mfma_f32_16x16x32_bf16 v[40:43], v[104:107], v[12:15], 0
    v_mfma_f32_16x16x32_bf16 v[44:47], v[108:111], v[12:15], 0
    s_add_u32 s53, s99, 0xc0000
    s_and_b32 s53, s53, 0x1fffff
    buffer_load_dwordx4 v[80:83], v2, s[8:11], s53 offen offset:0 nt
    buffer_load_dwordx4 v[84:87], v2, s[8:11], s53 offen offset:1024 nt
    buffer_load_dwordx4 v[88:91], v2, s[8:11], s53 offen offset:2048 nt
    buffer_load_dwordx4 v[92:95], v2, s[8:11], s53 offen offset:3072 nt
    s_add_u32 s53, s53, 0x1000
    buffer_load_dwordx4 v[96:99], v2, s[8:11], s53 offen offset:0 nt
    buffer_load_dwordx4 v[100:103], v2, s[8:11], s53 offen offset:1024 nt
    buffer_load_dwordx4 v[104:107], v2, s[8:11], s53 offen offset:2048 nt
    buffer_load_dwordx4 v[108:111], v2, s[8:11], s53 offen offset:3072 nt
    v_add_f32_dpp v4, v33, v32 row_ror:12 row_mask:0xf bank_mask:0xf
    v_add_f32_dpp v5, v37, v36 row_ror:12 row_mask:0xf bank_mask:0xf
    v_add_f32_dpp v6, v41, v40 row_ror:12 row_mask:0xf bank_mask:0xf
    v_add_f32_dpp v7, v45, v44 row_ror:12 row_mask:0xf bank_mask:0xf
    v_add_f32_dpp v4, v34, v4 row_ror:8 row_mask:0xf bank_mask:0xf
    v_add_f32_dpp v5, v38, v5 row_ror:8 row_mask:0xf bank_mask:0xf
    v_add_f32_dpp v6, v42, v6 row_ror:8 row_mask:0xf bank_mask:0xf
    v_add_f32_dpp v7, v46, v7 row_ror:8 row_mask:0xf bank_mask:0xf
    v_add_f32_dpp v20, v35, v4 row_ror:4 row_mask:0xf bank_mask:0x1
    v_add_f32_dpp v21, v39, v5 row_ror:4 row_mask:0xf bank_mask:0x1
    v_add_f32_dpp v22, v43, v6 row_ror:4 row_mask:0xf bank_mask:0x1
    v_add_f32_dpp v23, v47, v7 row_ror:4 row_mask:0xf bank_mask:0x1
    v_accvgpr_read_b32 v4, a2
    v_and_b32 v36, s81, v4
    v_alignbit_b32 v37, v4, v4, 28
    v_and_b32 v37, s81, v37
    v_accvgpr_read_b32 v4, a0
    v_accvgpr_read_b32 v5, a1
    v_perm_b32 v32, v36, v4, s72
    v_perm_b32 v36, v36, v4, s73
    v_pk_min_u16 v8, v32, s85
    v_pk_mad_u16 v32, v8, s74, v32
    v_pk_min_u16 v8, v36, s85
    v_pk_mad_u16 v36, v8, s74, v36
    v_perm_b32 v33, v37, v5, s72
    v_perm_b32 v37, v37, v5, s73
    v_pk_min_u16 v8, v33, s85
    v_pk_mad_u16 v33, v8, s74, v33
    v_pk_min_u16 v8, v37, s85
    v_pk_mad_u16 v37, v8, s74, v37
    v_accvgpr_read_b32 v4, a5
    v_and_b32 v38, s81, v4
    v_alignbit_b32 v39, v4, v4, 28
    v_and_b32 v39, s81, v39
    v_accvgpr_read_b32 v4, a3
    v_accvgpr_read_b32 v5, a4
    v_perm_b32 v34, v38, v4, s72
    v_perm_b32 v38, v38, v4, s73
    v_pk_min_u16 v8, v34, s85
    v_pk_mad_u16 v34, v8, s74, v34
    v_pk_min_u16 v8, v38, s85
    v_pk_mad_u16 v38, v8, s74, v38
    v_perm_b32 v35, v39, v5, s72
    v_perm_b32 v39, v39, v5, s73
    v_pk_min_u16 v8, v35, s85
    v_pk_mad_u16 v35, v8, s74, v35
    v_pk_min_u16 v8, v39, s85
    v_pk_mad_u16 v39, v8, s74, v39
    s_bitcmp1_b64 s[90:91], 0
    s_cbranch_scc1 L_xp_51
L_xpb_52:
    v_mfma_f32_16x16x32_bf16 v[48:51], v[24:27], v[32:35], v[48:51]
    v_mfma_f32_16x16x32_bf16 v[52:55], v[24:27], v[36:39], v[52:55]
    v_accvgpr_read_b32 v4, a8
    v_and_b32 v36, s81, v4
    v_alignbit_b32 v37, v4, v4, 28
    v_and_b32 v37, s81, v37
    v_accvgpr_read_b32 v4, a6
    v_accvgpr_read_b32 v5, a7
    v_perm_b32 v32, v36, v4, s72
    v_perm_b32 v36, v36, v4, s73
    v_pk_min_u16 v8, v32, s85
    v_pk_mad_u16 v32, v8, s74, v32
    v_pk_min_u16 v8, v36, s85
    v_pk_mad_u16 v36, v8, s74, v36
    v_perm_b32 v33, v37, v5, s72
    v_perm_b32 v37, v37, v5, s73
    v_pk_min_u16 v8, v33, s85
    v_pk_mad_u16 v33, v8, s74, v33
    v_pk_min_u16 v8, v37, s85
    v_pk_mad_u16 v37, v8, s74, v37
    v_accvgpr_read_b32 v4, a11
    v_and_b32 v38, s81, v4
    v_alignbit_b32 v39, v4, v4, 28
    v_and_b32 v39, s81, v39
    v_accvgpr_read_b32 v4, a9
    v_accvgpr_read_b32 v5, a10
    v_perm_b32 v34, v38, v4, s72
    v_perm_b32 v38, v38, v4, s73
    v_pk_min_u16 v8, v34, s85
    v_pk_mad_u16 v34, v8, s74, v34
    v_pk_min_u16 v8, v38, s85
    v_pk_mad_u16 v38, v8, s74, v38
    v_perm_b32 v35, v39, v5, s72
    v_perm_b32 v39, v39, v5, s73
    v_pk_min_u16 v8, v35, s85
    v_pk_mad_u16 v35, v8, s74, v35
    v_pk_min_u16 v8, v39, s85
    v_pk_mad_u16 v39, v8, s74, v39
    s_bitcmp1_b64 s[90:91], 1
    s_cbranch_scc1 L_xp_53
L_xpb_54:
    v_mfma_f32_16x16x32_bf16 v[56:59], v[24:27], v[32:35], v[56:59]
    v_mfma_f32_16x16x32_bf16 v[60:63], v[24:27], v[36:39], v[60:63]
    v_accvgpr_read_b32 v4, a14
    v_and_b32 v36, s81, v4
    v_alignbit_b32 v37, v4, v4, 28
    v_and_b32 v37, s81, v37
    v_accvgpr_read_b32 v4, a12
    v_accvgpr_read_b32 v5, a13
    v_perm_b32 v32, v36, v4, s72
    v_perm_b32 v36, v36, v4, s73
    v_pk_min_u16 v8, v32, s85
    v_pk_mad_u16 v32, v8, s74, v32
    v_pk_min_u16 v8, v36, s85
    v_pk_mad_u16 v36, v8, s74, v36
    v_perm_b32 v33, v37, v5, s72
    v_perm_b32 v37, v37, v5, s73
    v_pk_min_u16 v8, v33, s85
    v_pk_mad_u16 v33, v8, s74, v33
    v_pk_min_u16 v8, v37, s85
    v_pk_mad_u16 v37, v8, s74, v37
    v_accvgpr_read_b32 v4, a17
    v_and_b32 v38, s81, v4
    v_alignbit_b32 v39, v4, v4, 28
    v_and_b32 v39, s81, v39
    v_accvgpr_read_b32 v4, a15
    v_accvgpr_read_b32 v5, a16
    v_perm_b32 v34, v38, v4, s72
    v_perm_b32 v38, v38, v4, s73
    v_pk_min_u16 v8, v34, s85
    v_pk_mad_u16 v34, v8, s74, v34
    v_pk_min_u16 v8, v38, s85
    v_pk_mad_u16 v38, v8, s74, v38
    v_perm_b32 v35, v39, v5, s72
    v_perm_b32 v39, v39, v5, s73
    v_pk_min_u16 v8, v35, s85
    v_pk_mad_u16 v35, v8, s74, v35
    v_pk_min_u16 v8, v39, s85
    v_pk_mad_u16 v39, v8, s74, v39
    s_bitcmp1_b64 s[90:91], 2
    s_cbranch_scc1 L_xp_55
L_xpb_56:
    v_mfma_f32_16x16x32_bf16 v[64:67], v[24:27], v[32:35], v[64:67]
    v_mfma_f32_16x16x32_bf16 v[68:71], v[24:27], v[36:39], v[68:71]
    v_accvgpr_read_b32 v4, a20
    v_and_b32 v36, s81, v4
    v_alignbit_b32 v37, v4, v4, 28
    v_and_b32 v37, s81, v37
    v_accvgpr_read_b32 v4, a18
    v_accvgpr_read_b32 v5, a19
    v_perm_b32 v32, v36, v4, s72
    v_perm_b32 v36, v36, v4, s73
    v_pk_min_u16 v8, v32, s85
    v_pk_mad_u16 v32, v8, s74, v32
    v_pk_min_u16 v8, v36, s85
    v_pk_mad_u16 v36, v8, s74, v36
    v_perm_b32 v33, v37, v5, s72
    v_perm_b32 v37, v37, v5, s73
    v_pk_min_u16 v8, v33, s85
    v_pk_mad_u16 v33, v8, s74, v33
    v_pk_min_u16 v8, v37, s85
    v_pk_mad_u16 v37, v8, s74, v37
    v_accvgpr_read_b32 v4, a23
    v_and_b32 v38, s81, v4
    v_alignbit_b32 v39, v4, v4, 28
    v_and_b32 v39, s81, v39
    v_accvgpr_read_b32 v4, a21
    v_accvgpr_read_b32 v5, a22
    v_perm_b32 v34, v38, v4, s72
    v_perm_b32 v38, v38, v4, s73
    v_pk_min_u16 v8, v34, s85
    v_pk_mad_u16 v34, v8, s74, v34
    v_pk_min_u16 v8, v38, s85
    v_pk_mad_u16 v38, v8, s74, v38
    v_perm_b32 v35, v39, v5, s72
    v_perm_b32 v39, v39, v5, s73
    v_pk_min_u16 v8, v35, s85
    v_pk_mad_u16 v35, v8, s74, v35
    v_pk_min_u16 v8, v39, s85
    v_pk_mad_u16 v39, v8, s74, v39
    s_bitcmp1_b64 s[90:91], 3
    s_cbranch_scc1 L_xp_57
L_xpb_58:
    v_mfma_f32_16x16x32_bf16 v[72:75], v[24:27], v[32:35], v[72:75]
    v_mfma_f32_16x16x32_bf16 v[76:79], v[24:27], v[36:39], v[76:79]
    s_waitcnt vmcnt(8)
    v_mfma_f32_16x16x32_bf16 v[32:35], v[112:115], v[12:15], 0
    v_mfma_f32_16x16x32_bf16 v[36:39], v[116:119], v[12:15], 0
    v_mfma_f32_16x16x32_bf16 v[40:43], v[120:123], v[12:15], 0
    v_mfma_f32_16x16x32_bf16 v[44:47], v[124:127], v[12:15], 0
    s_nop 4
    v_add_f32_dpp v4, v32, v33 row_ror:4 row_mask:0xf bank_mask:0xf
    v_add_f32_dpp v5, v36, v37 row_ror:4 row_mask:0xf bank_mask:0xf
    v_add_f32_dpp v6, v40, v41 row_ror:4 row_mask:0xf bank_mask:0xf
    v_add_f32_dpp v7, v44, v45 row_ror:4 row_mask:0xf bank_mask:0xf
    v_add_f32_dpp v4, v34, v4 row_ror:12 row_mask:0xf bank_mask:0xf
    v_add_f32_dpp v5, v38, v5 row_ror:12 row_mask:0xf bank_mask:0xf
    v_add_f32_dpp v6, v42, v6 row_ror:12 row_mask:0xf bank_mask:0xf
    v_add_f32_dpp v7, v46, v7 row_ror:12 row_mask:0xf bank_mask:0xf
    v_add_f32_dpp v16, v35, v4 row_ror:8 row_mask:0xf bank_mask:0x2
    v_add_f32_dpp v17, v39, v5 row_ror:8 row_mask:0xf bank_mask:0x2
    v_add_f32_dpp v18, v43, v6 row_ror:8 row_mask:0xf bank_mask:0x2
    v_add_f32_dpp v19, v47, v7 row_ror:8 row_mask:0xf bank_mask:0x2
    v_mfma_f32_16x16x32_bf16 v[32:35], v[128:131], v[12:15], 0
    v_mfma_f32_16x16x32_bf16 v[36:39], v[132:135], v[12:15], 0
    v_mfma_f32_16x16x32_bf16 v[40:43], v[136:139], v[12:15], 0
    v_mfma_f32_16x16x32_bf16 v[44:47], v[140:143], v[12:15], 0
    s_mul_i32 s66, s54, 0x40000
    s_add_u32 s99, s99, s66
    s_add_u32 s53, s99, 0xe0000
    s_and_b32 s53, s53, 0x1fffff
    buffer_load_dwordx4 v[112:115], v2, s[8:11], s53 offen offset:0 nt
    buffer_load_dwordx4 v[116:119], v2, s[8:11], s53 offen offset:1024 nt
    buffer_load_dwordx4 v[120:123], v2, s[8:11], s53 offen offset:2048 nt
    buffer_load_dwordx4 v[124:127], v2, s[8:11], s53 offen offset:3072 nt
    s_add_u32 s53, s53, 0x1000
    buffer_load_dwordx4 v[128:131], v2, s[8:11], s53 offen offset:0 nt
    buffer_load_dwordx4 v[132:135], v2, s[8:11], s53 offen offset:1024 nt
    buffer_load_dwordx4 v[136:139], v2, s[8:11], s53 offen offset:2048 nt
    buffer_load_dwordx4 v[140:143], v2, s[8:11], s53 offen offset:3072 nt
    s_sub_u32 s99, s99, s66
    v_add_f32_dpp v4, v32, v33 row_ror:4 row_mask:0xf bank_mask:0xf
    v_add_f32_dpp v5, v36, v37 row_ror:4 row_mask:0xf bank_mask:0xf
    v_add_f32_dpp v6, v40, v41 row_ror:4 row_mask:0xf bank_mask:0xf
    v_add_f32_dpp v7, v44, v45 row_ror:4 row_mask:0xf bank_mask:0xf
    v_add_f32_dpp v4, v34, v4 row_ror:12 row_mask:0xf bank_mask:0xf
    v_add_f32_dpp v5, v38, v5 row_ror:12 row_mask:0xf bank_mask:0xf
    v_add_f32_dpp v6, v42, v6 row_ror:12 row_mask:0xf bank_mask:0xf
    v_add_f32_dpp v7, v46, v7 row_ror:12 row_mask:0xf bank_mask:0xf
    v_add_f32_dpp v20, v35, v4 row_ror:8 row_mask:0xf bank_mask:0x2
    v_add_f32_dpp v21, v39, v5 row_ror:8 row_mask:0xf bank_mask:0x2
    v_add_f32_dpp v22, v43, v6 row_ror:8 row_mask:0xf bank_mask:0x2
    v_add_f32_dpp v23, v47, v7 row_ror:8 row_mask:0xf bank_mask:0x2
    v_mov_b32_dpp v28, v24 row_shl:4 row_mask:0xf bank_mask:0xf
    v_mov_b32_dpp v29, v25 row_shl:4 row_mask:0xf bank_mask:0xf
    v_mov_b32_dpp v30, v26 row_shl:4 row_mask:0xf bank_mask:0xf
    v_mov_b32_dpp v31, v27 row_shl:4 row_mask:0xf bank_mask:0xf
    v_accvgpr_read_b32 v4, a26
    v_and_b32 v36, s81, v4
    v_alignbit_b32 v37, v4, v4, 28
    v_and_b32 v37, s81, v37
    v_accvgpr_read_b32 v4, a24
    v_accvgpr_read_b32 v5, a25
    v_perm_b32 v32, v36, v4, s72
    v_perm_b32 v36, v36, v4, s73
    v_pk_min_u16 v8, v32, s85
    v_pk_mad_u16 v32, v8, s74, v32
    v_pk_min_u16 v8, v36, s85
    v_pk_mad_u16 v36, v8, s74, v36
    v_perm_b32 v33, v37, v5, s72
    v_perm_b32 v37, v37, v5, s73
    v_pk_min_u16 v8, v33, s85
    v_pk_mad_u16 v33, v8, s74, v33
    v_pk_min_u16 v8, v37, s85
    v_pk_mad_u16 v37, v8, s74, v37
    v_accvgpr_read_b32 v4, a29
    v_and_b32 v38, s81, v4
    v_alignbit_b32 v39, v4, v4, 28
    v_and_b32 v39, s81, v39
    v_accvgpr_read_b32 v4, a27
    v_accvgpr_read_b32 v5, a28
    v_perm_b32 v34, v38, v4, s72
    v_perm_b32 v38, v38, v4, s73
    v_pk_min_u16 v8, v34, s85
    v_pk_mad_u16 v34, v8, s74, v34
    v_pk_min_u16 v8, v38, s85
    v_pk_mad_u16 v38, v8, s74, v38
    v_perm_b32 v35, v39, v5, s72
    v_perm_b32 v39, v39, v5, s73
    v_pk_min_u16 v8, v35, s85
    v_pk_mad_u16 v35, v8, s74, v35
    v_pk_min_u16 v8, v39, s85
    v_pk_mad_u16 v39, v8, s74, v39
    s_bitcmp1_b64 s[90:91], 4
    s_cbranch_scc1 L_xp_59
L_xpb_60:
    v_mfma_f32_16x16x32_bf16 v[48:51], v[28:31], v[32:35], v[48:51]
    v_mfma_f32_16x16x32_bf16 v[52:55], v[28:31], v[36:39], v[52:55]
    v_and_b32 v36, s81, v144
    v_alignbit_b32 v37, v144, v144, 28
    v_and_b32 v37, s81, v37
    v_accvgpr_read_b32 v4, a30
    v_accvgpr_read_b32 v5, a31
    v_perm_b32 v32, v36, v4, s72
    v_perm_b32 v36, v36, v4, s73
    v_pk_min_u16 v8, v32, s85
    v_pk_mad_u16 v32, v8, s74, v32
    v_pk_min_u16 v8, v36, s85
    v_pk_mad_u16 v36, v8, s74, v36
    v_perm_b32 v33, v37, v5, s72
    v_perm_b32 v37, v37, v5, s73
    v_pk_min_u16 v8, v33, s85
    v_pk_mad_u16 v33, v8, s74, v33
    v_pk_min_u16 v8, v37, s85
    v_pk_mad_u16 v37, v8, s74, v37
    v_and_b32 v38, s81, v147
    v_alignbit_b32 v39, v147, v147, 28
    v_and_b32 v39, s81, v39
    v_perm_b32 v34, v38, v145, s72
    v_perm_b32 v38, v38, v145, s73
    v_pk_min_u16 v8, v34, s85
    v_pk_mad_u16 v34, v8, s74, v34
    v_pk_min_u16 v8, v38, s85
    v_pk_mad_u16 v38, v8, s74, v38
    v_perm_b32 v35, v39, v146, s72
    v_perm_b32 v39, v39, v146, s73
    v_pk_min_u16 v8, v35, s85
    v_pk_mad_u16 v35, v8, s74, v35
    v_pk_min_u16 v8, v39, s85
    v_pk_mad_u16 v39, v8, s74, v39
    s_bitcmp1_b64 s[90:91], 5
    s_cbranch_scc1 L_xp_61
L_xpb_62:
    v_mfma_f32_16x16x32_bf16 v[56:59], v[28:31], v[32:35], v[56:59]
    v_mfma_f32_16x16x32_bf16 v[60:63], v[28:31], v[36:39], v[60:63]
    v_and_b32 v36, s81, v150
    v_alignbit_b32 v37, v150, v150, 28
    v_and_b32 v37, s81, v37
    v_perm_b32 v32, v36, v148, s72
    v_perm_b32 v36, v36, v148, s73
    v_pk_min_u16 v8, v32, s85
    v_pk_mad_u16 v32, v8, s74, v32
    v_pk_min_u16 v8, v36, s85
    v_pk_mad_u16 v36, v8, s74, v36
    v_perm_b32 v33, v37, v149, s72
    v_perm_b32 v37, v37, v149, s73
    v_pk_min_u16 v8, v33, s85
    v_pk_mad_u16 v33, v8, s74, v33
    v_pk_min_u16 v8, v37, s85
    v_pk_mad_u16 v37, v8, s74, v37
    v_and_b32 v38, s81, v153
    v_alignbit_b32 v39, v153, v153, 28
    v_and_b32 v39, s81, v39
    v_perm_b32 v34, v38, v151, s72
    v_perm_b32 v38, v38, v151, s73
    v_pk_min_u16 v8, v34, s85
    v_pk_mad_u16 v34, v8, s74, v34
    v_pk_min_u16 v8, v38, s85
    v_pk_mad_u16 v38, v8, s74, v38
    v_perm_b32 v35, v39, v152, s72
    v_perm_b32 v39, v39, v152, s73
    v_pk_min_u16 v8, v35, s85
    v_pk_mad_u16 v35, v8, s74, v35
    v_pk_min_u16 v8, v39, s85
    v_pk_mad_u16 v39, v8, s74, v39
    s_bitcmp1_b64 s[90:91], 6
    s_cbranch_scc1 L_xp_63
L_xpb_64:
    v_mfma_f32_16x16x32_bf16 v[64:67], v[28:31], v[32:35], v[64:67]
    v_mfma_f32_16x16x32_bf16 v[68:71], v[28:31], v[36:39], v[68:71]
    v_and_b32 v36, s81, v156
    v_alignbit_b32 v37, v156, v156, 28
    v_and_b32 v37, s81, v37
    v_perm_b32 v32, v36, v154, s72
    v_perm_b32 v36, v36, v154, s73
    v_pk_min_u16 v8, v32, s85
    v_pk_mad_u16 v32, v8, s74, v32
    v_pk_min_u16 v8, v36, s85
    v_pk_mad_u16 v36, v8, s74, v36
    v_perm_b32 v33, v37, v155, s72
    v_perm_b32 v37, v37, v155, s73
    v_pk_min_u16 v8, v33, s85
    v_pk_mad_u16 v33, v8, s74, v33
    v_pk_min_u16 v8, v37, s85
    v_pk_mad_u16 v37, v8, s74, v37
    v_and_b32 v38, s81, v159
    v_alignbit_b32 v39, v159, v159, 28
    v_and_b32 v39, s81, v39
    v_perm_b32 v34, v38, v157, s72
    v_perm_b32 v38, v38, v157, s73
    v_pk_min_u16 v8, v34, s85
    v_pk_mad_u16 v34, v8, s74, v34
    v_pk_min_u16 v8, v38, s85
    v_pk_mad_u16 v38, v8, s74, v38
    v_perm_b32 v35, v39, v158, s72
    v_perm_b32 v39, v39, v158, s73
    v_pk_min_u16 v8, v35, s85
    v_pk_mad_u16 v35, v8, s74, v35
    v_pk_min_u16 v8, v39, s85
    v_pk_mad_u16 v39, v8, s74, v39
    s_bitcmp1_b64 s[90:91], 7
    s_cbranch_scc1 L_xp_65
L_xpb_66:
    v_mfma_f32_16x16x32_bf16 v[72:75], v[28:31], v[32:35], v[72:75]
    v_mfma_f32_16x16x32_bf16 v[76:79], v[28:31], v[36:39], v[76:79]
    s_waitcnt vmcnt(8)
    v_mfma_f32_16x16x32_bf16 v[32:35], v[80:83], v[12:15], 0
    v_mfma_f32_16x16x32_bf16 v[36:39], v[84:87], v[12:15], 0
    v_mfma_f32_16x16x32_bf16 v[40:43], v[88:91], v[12:15], 0
    v_mfma_f32_16x16x32_bf16 v[44:47], v[92:95], v[12:15], 0
    s_nop 4
    v_add_f32_dpp v4, v32, v34 row_ror:8 row_mask:0xf bank_mask:0xf
    v_add_f32_dpp v5, v36, v38 row_ror:8 row_mask:0xf bank_mask:0xf
    v_add_f32_dpp v6, v40, v42 row_ror:8 row_mask:0xf bank_mask:0xf
    v_add_f32_dpp v7, v44, v46 row_ror:8 row_mask:0xf bank_mask:0xf
    v_add_f32_dpp v4, v33, v4 row_ror:4 row_mask:0xf bank_mask:0xf
    v_add_f32_dpp v5, v37, v5 row_ror:4 row_mask:0xf bank_mask:0xf
    v_add_f32_dpp v6, v41, v6 row_ror:4 row_mask:0xf bank_mask:0xf
    v_add_f32_dpp v7, v45, v7 row_ror:4 row_mask:0xf bank_mask:0xf
    v_add_f32_dpp v16, v35, v4 row_ror:12 row_mask:0xf bank_mask:0x4
    v_add_f32_dpp v17, v39, v5 row_ror:12 row_mask:0xf bank_mask:0x4
    v_add_f32_dpp v18, v43, v6 row_ror:12 row_mask:0xf bank_mask:0x4
    v_add_f32_dpp v19, v47, v7 row_ror:12 row_mask:0xf bank_mask:0x4
    v_mfma_f32_16x16x32_bf16 v[32:35], v[96:99], v[12:15], 0
    v_mfma_f32_16x16x32_bf16 v[36:39], v[100:103], v[12:15], 0
    v_mfma_f32_16x16x32_bf16 v[40:43], v[104:107], v[12:15], 0
    v_mfma_f32_16x16x32_bf16 v[44:47], v[108:111], v[12:15], 0
    s_add_u32 s53, s99, 0x100000
    s_and_b32 s53, s53, 0x1fffff
    buffer_load_dwordx4 v[80:83], v2, s[8:11], s53 offen offset:0 nt
    buffer_load_dwordx4 v[84:87], v2, s[8:11], s53 offen offset:1024 nt
    buffer_load_dwordx4 v[88:91], v2, s[8:11], s53 offen offset:2048 nt
    buffer_load_dwordx4 v[92:95], v2, s[8:11], s53 offen offset:3072 nt
    s_add_u32 s53, s53, 0x1000
    buffer_load_dwordx4 v[96:99], v2, s[8:11], s53 offen offset:0 nt
    buffer_load_dwordx4 v[100:103], v2, s[8:11], s53 offen offset:1024 nt
    buffer_load_dwordx4 v[104:107], v2, s[8:11], s53 offen offset:2048 nt
    buffer_load_dwordx4 v[108:111], v2, s[8:11], s53 offen offset:3072 nt
    v_add_f32_dpp v4, v32, v34 row_ror:8 row_mask:0xf bank_mask:0xf
    v_add_f32_dpp v5, v36, v38 row_ror:8 row_mask:0xf bank_mask:0xf
    v_add_f32_dpp v6, v40, v42 row_ror:8 row_mask:0xf bank_mask:0xf
    v_add_f32_dpp v7, v44, v46 row_ror:8 row_mask:0xf bank_mask:0xf
    v_add_f32_dpp v4, v33, v4 row_ror:4 row_mask:0xf bank_mask:0xf
    v_add_f32_dpp v5, v37, v5 row_ror:4 row_mask:0xf bank_mask:0xf
    v_add_f32_dpp v6, v41, v6 row_ror:4 row_mask:0xf bank_mask:0xf
    v_add_f32_dpp v7, v45, v7 row_ror:4 row_mask:0xf bank_mask:0xf
    v_add_f32_dpp v20, v35, v4 row_ror:12 row_mask:0xf bank_mask:0x4
    v_add_f32_dpp v21, v39, v5 row_ror:12 row_mask:0xf bank_mask:0x4
    v_add_f32_dpp v22, v43, v6 row_ror:12 row_mask:0xf bank_mask:0x4
    v_add_f32_dpp v23, v47, v7 row_ror:12 row_mask:0xf bank_mask:0x4
    v_mov_b32_dpp v28, v24 row_shl:8 row_mask:0xf bank_mask:0xf
    v_mov_b32_dpp v29, v25 row_shl:8 row_mask:0xf bank_mask:0xf
    v_mov_b32_dpp v30, v26 row_shl:8 row_mask:0xf bank_mask:0xf
    v_mov_b32_dpp v31, v27 row_shl:8 row_mask:0xf bank_mask:0xf
    v_and_b32 v36, s81, v162
    v_alignbit_b32 v37, v162, v162, 28
    v_and_b32 v37, s81, v37
    v_perm_b32 v32, v36, v160, s72
    v_perm_b32 v36, v36, v160, s73
    v_pk_min_u16 v8, v32, s85
    v_pk_mad_u16 v32, v8, s74, v32
    v_pk_min_u16 v8, v36, s85
    v_pk_mad_u16 v36, v8, s74, v36
    v_perm_b32 v33, v37, v161, s72
    v_perm_b32 v37, v37, v161, s73
    v_pk_min_u16 v8, v33, s85
    v_pk_mad_u16 v33, v8, s74, v33
    v_pk_min_u16 v8, v37, s85
    v_pk_mad_u16 v37, v8, s74, v37
    v_and_b32 v38, s81, v165
    v_alignbit_b32 v39, v165, v165, 28
    v_and_b32 v39, s81, v39
    v_perm_b32 v34, v38, v163, s72
    v_perm_b32 v38, v38, v163, s73
    v_pk_min_u16 v8, v34, s85
    v_pk_mad_u16 v34, v8, s74, v34
    v_pk_min_u16 v8, v38, s85
    v_pk_mad_u16 v38, v8, s74, v38
    v_perm_b32 v35, v39, v164, s72
    v_perm_b32 v39, v39, v164, s73
    v_pk_min_u16 v8, v35, s85
    v_pk_mad_u16 v35, v8, s74, v35
    v_pk_min_u16 v8, v39, s85
    v_pk_mad_u16 v39, v8, s74, v39
    s_bitcmp1_b64 s[90:91], 8
    s_cbranch_scc1 L_xp_67
L_xpb_68:
    v_mfma_f32_16x16x32_bf16 v[48:51], v[28:31], v[32:35], v[48:51]
    v_mfma_f32_16x16x32_bf16 v[52:55], v[28:31], v[36:39], v[52:55]
    v_and_b32 v36, s81, v168
    v_alignbit_b32 v37, v168, v168, 28
    v_and_b32 v37, s81, v37
    v_perm_b32 v32, v36, v166, s72
    v_perm_b32 v36, v36, v166, s73
    v_pk_min_u16 v8, v32, s85
    v_pk_mad_u16 v32, v8, s74, v32
    v_pk_min_u16 v8, v36, s85
    v_pk_mad_u16 v36, v8, s74, v36
    v_perm_b32 v33, v37, v167, s72
    v_perm_b32 v37, v37, v167, s73
    v_pk_min_u16 v8, v33, s85
    v_pk_mad_u16 v33, v8, s74, v33
    v_pk_min_u16 v8, v37, s85
    v_pk_mad_u16 v37, v8, s74, v37
    v_and_b32 v38, s81, v171
    v_alignbit_b32 v39, v171, v171, 28
    v_and_b32 v39, s81, v39
    v_perm_b32 v34, v38, v169, s72
    v_perm_b32 v38, v38, v169, s73
    v_pk_min_u16 v8, v34, s85
    v_pk_mad_u16 v34, v8, s74, v34
    v_pk_min_u16 v8, v38, s85
    v_pk_mad_u16 v38, v8, s74, v38
    v_perm_b32 v35, v39, v170, s72
    v_perm_b32 v39, v39, v170, s73
    v_pk_min_u16 v8, v35, s85
    v_pk_mad_u16 v35, v8, s74, v35
    v_pk_min_u16 v8, v39, s85
    v_pk_mad_u16 v39, v8, s74, v39
    s_bitcmp1_b64 s[90:91], 9
    s_cbranch_scc1 L_xp_69
L_xpb_70:
    v_mfma_f32_16x16x32_bf16 v[56:59], v[28:31], v[32:35], v[56:59]
    v_mfma_f32_16x16x32_bf16 v[60:63], v[28:31], v[36:39], v[60:63]
    v_and_b32 v36, s81, v174
    v_alignbit_b32 v37, v174, v174, 28
    v_and_b32 v37, s81, v37
    v_perm_b32 v32, v36, v172, s72
    v_perm_b32 v36, v36, v172, s73
    v_pk_min_u16 v8, v32, s85
    v_pk_mad_u16 v32, v8, s74, v32
    v_pk_min_u16 v8, v36, s85
    v_pk_mad_u16 v36, v8, s74, v36
    v_perm_b32 v33, v37, v173, s72
    v_perm_b32 v37, v37, v173, s73
    v_pk_min_u16 v8, v33, s85
    v_pk_mad_u16 v33, v8, s74, v33
    v_pk_min_u16 v8, v37, s85
    v_pk_mad_u16 v37, v8, s74, v37
    v_and_b32 v38, s81, v177
    v_alignbit_b32 v39, v177, v177, 28
    v_and_b32 v39, s81, v39
    v_perm_b32 v34, v38, v175, s72
    v_perm_b32 v38, v38, v175, s73
    v_pk_min_u16 v8, v34, s85
    v_pk_mad_u16 v34, v8, s74, v34
    v_pk_min_u16 v8, v38, s85
    v_pk_mad_u16 v38, v8, s74, v38
    v_perm_b32 v35, v39, v176, s72
    v_perm_b32 v39, v39, v176, s73
    v_pk_min_u16 v8, v35, s85
    v_pk_mad_u16 v35, v8, s74, v35
    v_pk_min_u16 v8, v39, s85
    v_pk_mad_u16 v39, v8, s74, v39
    s_bitcmp1_b64 s[90:91], 10
    s_cbranch_scc1 L_xp_71
L_xpb_72:
    v_mfma_f32_16x16x32_bf16 v[64:67], v[28:31], v[32:35], v[64:67]
    v_mfma_f32_16x16x32_bf16 v[68:71], v[28:31], v[36:39], v[68:71]
    v_and_b32 v36, s81, v180
    v_alignbit_b32 v37, v180, v180, 28
    v_and_b32 v37, s81, v37
    v_perm_b32 v32, v36, v178, s72
    v_perm_b32 v36, v36, v178, s73
    v_pk_min_u16 v8, v32, s85
    v_pk_mad_u16 v32, v8, s74, v32
    v_pk_min_u16 v8, v36, s85
    v_pk_mad_u16 v36, v8, s74, v36
    v_perm_b32 v33, v37, v179, s72
    v_perm_b32 v37, v37, v179, s73
    v_pk_min_u16 v8, v33, s85
    v_pk_mad_u16 v33, v8, s74, v33
    v_pk_min_u16 v8, v37, s85
    v_pk_mad_u16 v37, v8, s74, v37
    v_and_b32 v38, s81, v183
    v_alignbit_b32 v39, v183, v183, 28
    v_and_b32 v39, s81, v39
    v_perm_b32 v34, v38, v181, s72
    v_perm_b32 v38, v38, v181, s73
    v_pk_min_u16 v8, v34, s85
    v_pk_mad_u16 v34, v8, s74, v34
    v_pk_min_u16 v8, v38, s85
    v_pk_mad_u16 v38, v8, s74, v38
    v_perm_b32 v35, v39, v182, s72
    v_perm_b32 v39, v39, v182, s73
    v_pk_min_u16 v8, v35, s85
    v_pk_mad_u16 v35, v8, s74, v35
    v_pk_min_u16 v8, v39, s85
    v_pk_mad_u16 v39, v8, s74, v39
    s_bitcmp1_b64 s[90:91], 11
    s_cbranch_scc1 L_xp_73
L_xpb_74:
    v_mfma_f32_16x16x32_bf16 v[72:75], v[28:31], v[32:35], v[72:75]
    v_mfma_f32_16x16x32_bf16 v[76:79], v[28:31], v[36:39], v[76:79]
    s_cmp_lg_u32 s54, 0
    s_cbranch_scc1 L_kd7
    s_waitcnt vmcnt(8)
    v_mfma_f32_16x16x32_bf16 v[32:35], v[112:115], v[12:15], 0
    v_mfma_f32_16x16x32_bf16 v[36:39], v[116:119], v[12:15], 0
    v_mfma_f32_16x16x32_bf16 v[40:43], v[120:123], v[12:15], 0
    v_mfma_f32_16x16x32_bf16 v[44:47], v[124:127], v[12:15], 0
    s_nop 4
    v_add_f32_dpp v4, v32, v35 row_ror:12 row_mask:0xf bank_mask:0xf
    v_add_f32_dpp v5, v36, v39 row_ror:12 row_mask:0xf bank_mask:0xf
    v_add_f32_dpp v6, v40, v43 row_ror:12 row_mask:0xf bank_mask:0xf
    v_add_f32_dpp v7, v44, v47 row_ror:12 row_mask:0xf bank_mask:0xf
    v_add_f32_dpp v4, v33, v4 row_ror:8 row_mask:0xf bank_mask:0xf
    v_add_f32_dpp v5, v37, v5 row_ror:8 row_mask:0xf bank_mask:0xf
    v_add_f32_dpp v6, v41, v6 row_ror:8 row_mask:0xf bank_mask:0xf
    v_add_f32_dpp v7, v45, v7 row_ror:8 row_mask:0xf bank_mask:0xf
    v_add_f32_dpp v16, v34, v4 row_ror:4 row_mask:0xf bank_mask:0x8
    v_add_f32_dpp v17, v38, v5 row_ror:4 row_mask:0xf bank_mask:0x8
    v_add_f32_dpp v18, v42, v6 row_ror:4 row_mask:0xf bank_mask:0x8
    v_add_f32_dpp v19, v46, v7 row_ror:4 row_mask:0xf bank_mask:0x8
    v_mfma_f32_16x16x32_bf16 v[32:35], v[128:131], v[12:15], 0
    v_mfma_f32_16x16x32_bf16 v[36:39], v[132:135], v[12:15], 0
    v_mfma_f32_16x16x32_bf16 v[40:43], v[136:139], v[12:15], 0
    v_mfma_f32_16x16x32_bf16 v[44:47], v[140:143], v[12:15], 0
    s_nop 4
    v_add_f32_dpp v4, v32, v35 row_ror:12 row_mask:0xf bank_mask:0xf
    v_add_f32_dpp v5, v36, v39 row_ror:12 row_mask:0xf bank_mask:0xf
    v_add_f32_dpp v6, v40, v43 row_ror:12 row_mask:0xf bank_mask:0xf
    v_add_f32_dpp v7, v44, v47 row_ror:12 row_mask:0xf bank_mask:0xf
    v_add_f32_dpp v4, v33, v4 row_ror:8 row_mask:0xf bank_mask:0xf
    v_add_f32_dpp v5, v37, v5 row_ror:8 row_mask:0xf bank_mask:0xf
    v_add_f32_dpp v6, v41, v6 row_ror:8 row_mask:0xf bank_mask:0xf
    v_add_f32_dpp v7, v45, v7 row_ror:8 row_mask:0xf bank_mask:0xf
    v_add_f32_dpp v20, v34, v4 row_ror:4 row_mask:0xf bank_mask:0x8
    v_add_f32_dpp v21, v38, v5 row_ror:4 row_mask:0xf bank_mask:0x8
    v_add_f32_dpp v22, v42, v6 row_ror:4 row_mask:0xf bank_mask:0x8
    v_add_f32_dpp v23, v46, v7 row_ror:4 row_mask:0xf bank_mask:0x8
    v_pk_sub_u16 v44, v112, s85
    v_pk_sub_u16 v42, v113, s85
    v_pk_min_u16 v44, v44, v42
    v_pk_sub_u16 v42, v114, s85
    v_pk_min_u16 v44, v44, v42
    v_pk_sub_u16 v42, v115, s85
    v_pk_min_u16 v44, v44, v42
    v_pk_sub_u16 v40, v112, s75 clamp
    v_pk_sub_u16 v41, v113, s75 clamp
    v_perm_b32 v208, v41, v40, s70
    v_perm_b32 v40, v41, v40, s71
    v_pk_sub_u16 v41, v114, s75 clamp
    v_pk_sub_u16 v42, v115, s75 clamp
    v_perm_b32 v209, v42, v41, s70
    v_perm_b32 v41, v42, v41, s71
    v_or_b32 v43, v40, v41
    v_alignbit_b32 v41, v41, v41, 4
    v_or_b32 v210, v40, v41
    v_pk_sub_u16 v42, v116, s85
    v_pk_min_u16 v44, v44, v42
    v_pk_sub_u16 v42, v117, s85
    v_pk_min_u16 v44, v44, v42
    v_pk_sub_u16 v42, v118, s85
    v_pk_min_u16 v44, v44, v42
    v_pk_sub_u16 v42, v119, s85
    v_pk_min_u16 v44, v44, v42
    v_pk_sub_u16 v40, v116, s75 clamp
    v_pk_sub_u16 v41, v117, s75 clamp
    v_perm_b32 v211, v41, v40, s70
    v_perm_b32 v40, v41, v40, s71
    v_pk_sub_u16 v41, v118, s75 clamp
    v_pk_sub_u16 v42, v119, s75 clamp
    v_perm_b32 v212, v42, v41, s70
    v_perm_b32 v41, v42, v41, s71
    v_or3_b32 v43, v43, v40, v41
    v_alignbit_b32 v41, v41, v41, 4
    v_or_b32 v213, v40, v41
    v_pk_sub_u16 v42, v120, s85
    v_pk_min_u16 v44, v44, v42
    v_pk_sub_u16 v42, v121, s85
    v_pk_min_u16 v44, v44, v42
    v_pk_sub_u16 v42, v122, s85
    v_pk_min_u16 v44, v44, v42
    v_pk_sub_u16 v42, v123, s85
    v_pk_min_u16 v44, v44, v42
    v_pk_sub_u16 v40, v120, s75 clamp
    v_pk_sub_u16 v41, v121, s75 clamp
    v_perm_b32 v214, v41, v40, s70
    v_perm_b32 v40, v41, v40, s71
    v_pk_sub_u16 v41, v122, s75 clamp
    v_pk_sub_u16 v42, v123, s75 clamp
    v_perm_b32 v215, v42, v41, s70
    v_perm_b32 v41, v42, v41, s71
    v_or3_b32 v43, v43, v40, v41
    v_alignbit_b32 v41, v41, v41, 4
    v_or_b32 v216, v40, v41
    v_pk_sub_u16 v42, v124, s85
    v_pk_min_u16 v44, v44, v42
    v_pk_sub_u16 v42, v125, s85
    v_pk_min_u16 v44, v44, v42
    v_pk_sub_u16 v42, v126, s85
    v_pk_min_u16 v44, v44, v42
    v_pk_sub_u16 v42, v127, s85
    v_pk_min_u16 v44, v44, v42
    v_pk_sub_u16 v40, v124, s75 clamp
    v_pk_sub_u16 v41, v125, s75 clamp
    v_perm_b32 v217, v41, v40, s70
    v_perm_b32 v40, v41, v40, s71
    v_pk_sub_u16 v41, v126, s75 clamp
    v_pk_sub_u16 v42, v127, s75 clamp
    v_perm_b32 v218, v42, v41, s70
    v_perm_b32 v41, v42, v41, s71
    v_or3_b32 v43, v43, v40, v41
    v_alignbit_b32 v41, v41, v41, 4
    v_or_b32 v219, v40, v41
    v_pk_sub_u16 v42, v128, s85
    v_pk_min_u16 v44, v44, v42
    v_pk_sub_u16 v42, v129, s85
    v_pk_min_u16 v44, v44, v42
    v_pk_sub_u16 v42, v130, s85
    v_pk_min_u16 v44, v44, v42
    v_pk_sub_u16 v42, v131, s85
    v_pk_min_u16 v44, v44, v42
    v_pk_sub_u16 v40, v128, s75 clamp
    v_pk_sub_u16 v41, v129, s75 clamp
    v_perm_b32 v220, v41, v40, s70
    v_perm_b32 v40, v41, v40, s71
    v_pk_sub_u16 v41, v130, s75 clamp
    v_pk_sub_u16 v42, v131, s75 clamp
    v_perm_b32 v221, v42, v41, s70
    v_perm_b32 v41, v42, v41, s71
    v_or3_b32 v43, v43, v40, v41
    v_alignbit_b32 v41, v41, v41, 4
    v_or_b32 v222, v40, v41
    v_pk_sub_u16 v42, v132, s85
    v_pk_min_u16 v44, v44, v42
    v_pk_sub_u16 v42, v133, s85
    v_pk_min_u16 v44, v44, v42
    v_pk_sub_u16 v42, v134, s85
    v_pk_min_u16 v44, v44, v42
    v_pk_sub_u16 v42, v135, s85
    v_pk_min_u16 v44, v44, v42
    v_pk_sub_u16 v40, v132, s75 clamp
    v_pk_sub_u16 v41, v133, s75 clamp
    v_perm_b32 v223, v41, v40, s70
    v_perm_b32 v40, v41, v40, s71
    v_pk_sub_u16 v41, v134, s75 clamp
    v_pk_sub_u16 v42, v135, s75 clamp
    v_perm_b32 v224, v42, v41, s70
    v_perm_b32 v41, v42, v41, s71
    v_or3_b32 v43, v43, v40, v41
    v_alignbit_b32 v41, v41, v41, 4
    v_or_b32 v225, v40, v41
    v_pk_sub_u16 v42, v136, s85
    v_pk_min_u16 v44, v44, v42
    v_pk_sub_u16 v42, v137, s85
    v_pk_min_u16 v44, v44, v42
    v_pk_sub_u16 v42, v138, s85
    v_pk_min_u16 v44, v44, v42
    v_pk_sub_u16 v42, v139, s85
    v_pk_min_u16 v44, v44, v42
    v_pk_sub_u16 v40, v136, s75 clamp
    v_pk_sub_u16 v41, v137, s75 clamp
    v_perm_b32 v226, v41, v40, s70
    v_perm_b32 v40, v41, v40, s71
    v_pk_sub_u16 v41, v138, s75 clamp
    v_pk_sub_u16 v42, v139, s75 clamp
    v_perm_b32 v227, v42, v41, s70
    v_perm_b32 v41, v42, v41, s71
    v_or3_b32 v43, v43, v40, v41
    v_alignbit_b32 v41, v41, v41, 4
    v_or_b32 v228, v40, v41
    v_pk_sub_u16 v42, v140, s85
    v_pk_min_u16 v44, v44, v42
    v_pk_sub_u16 v42, v141, s85
    v_pk_min_u16 v44, v44, v42
    v_pk_sub_u16 v42, v142, s85
    v_pk_min_u16 v44, v44, v42
    v_pk_sub_u16 v42, v143, s85
    v_pk_min_u16 v44, v44, v42
    v_pk_sub_u16 v40, v140, s75 clamp
    v_pk_sub_u16 v41, v141, s75 clamp
    v_perm_b32 v229, v41, v40, s70
    v_perm_b32 v40, v41, v40, s71
    v_pk_sub_u16 v41, v142, s75 clamp
    v_pk_sub_u16 v42, v143, s75 clamp
    v_perm_b32 v230, v42, v41, s70
    v_perm_b32 v41, v42, v41, s71
    v_or3_b32 v43, v43, v40, v41
    v_alignbit_b32 v41, v41, v41, 4
    v_or_b32 v231, v40, v41
    v_pk_sub_u16 v44, s75, v44 clamp
    v_and_b32 v43, 0x78787878, v43
    v_or_b32 v43, v43, v44
    v_cmp_ne_u32 vcc, 0, v43
    s_cbranch_vccnz L_xc_75
L_xcb_76:
    s_add_u32 s53, s99, 0x120000
    s_and_b32 s53, s53, 0x1fffff
    buffer_load_dwordx4 v[112:115], v2, s[8:11], s53 offen offset:0 nt
    buffer_load_dwordx4 v[116:119], v2, s[8:11], s53 offen offset:1024 nt
    buffer_load_dwordx4 v[120:123], v2, s[8:11], s53 offen offset:2048 nt
    buffer_load_dwordx4 v[124:127], v2, s[8:11], s53 offen offset:3072 nt
    s_add_u32 s53, s53, 0x1000
    buffer_load_dwordx4 v[128:131], v2, s[8:11], s53 offen offset:0 nt
    buffer_load_dwordx4 v[132:135], v2, s[8:11], s53 offen offset:1024 nt
    buffer_load_dwordx4 v[136:139], v2, s[8:11], s53 offen offset:2048 nt
    buffer_load_dwordx4 v[140:143], v2, s[8:11], s53 offen offset:3072 nt
    s_branch L_kj7
L_kd7:
    v_and_b32 v29, s81, v210
    v_alignbit_b32 v31, v210, v210, 28
    v_and_b32 v31, s81, v31
    v_perm_b32 v28, v29, v208, s70
    v_perm_b32 v29, v29, v208, s71
    v_pk_min_u16 v8, v28, s85
    v_pk_mad_u16 v28, v8, s75, v28
    v_pk_min_u16 v8, v29, s85
    v_pk_mad_u16 v29, v8, s75, v29
    v_perm_b32 v30, v31, v209, s70
    v_perm_b32 v31, v31, v209, s71
    v_pk_min_u16 v8, v30, s85
    v_pk_mad_u16 v30, v8, s75, v30
    v_pk_min_u16 v8, v31, s85
    v_pk_mad_u16 v31, v8, s75, v31
    s_bitcmp1_b64 s[92:93], 8
    s_cbranch_scc1 L_xp_78
L_xpb_79:
    v_mfma_f32_16x16x32_bf16 v[32:35], v[28:31], v[12:15], 0
    v_and_b32 v29, s81, v213
    v_alignbit_b32 v31, v213, v213, 28
    v_and_b32 v31, s81, v31
    v_perm_b32 v28, v29, v211, s70
    v_perm_b32 v29, v29, v211, s71
    v_pk_min_u16 v8, v28, s85
    v_pk_mad_u16 v28, v8, s75, v28
    v_pk_min_u16 v8, v29, s85
    v_pk_mad_u16 v29, v8, s75, v29
    v_perm_b32 v30, v31, v212, s70
    v_perm_b32 v31, v31, v212, s71
    v_pk_min_u16 v8, v30, s85
    v_pk_mad_u16 v30, v8, s75, v30
    v_pk_min_u16 v8, v31, s85
    v_pk_mad_u16 v31, v8, s75, v31
    s_bitcmp1_b64 s[92:93], 9
    s_cbranch_scc1 L_xp_80
L_xpb_81:
    v_mfma_f32_16x16x32_bf16 v[36:39], v[28:31], v[12:15], 0
    v_and_b32 v29, s81, v216
    v_alignbit_b32 v31, v216, v216, 28
    v_and_b32 v31, s81, v31
    v_perm_b32 v28, v29, v214, s70
    v_perm_b32 v29, v29, v214, s71
    v_pk_min_u16 v8, v28, s85
    v_pk_mad_u16 v28, v8, s75, v28
    v_pk_min_u16 v8, v29, s85
    v_pk_mad_u16 v29, v8, s75, v29
    v_perm_b32 v30, v31, v215, s70
    v_perm_b32 v31, v31, v215, s71
    v_pk_min_u16 v8, v30, s85
    v_pk_mad_u16 v30, v8, s75, v30
    v_pk_min_u16 v8, v31, s85
    v_pk_mad_u16 v31, v8, s75, v31
    s_bitcmp1_b64 s[92:93], 10
    s_cbranch_scc1 L_xp_82
L_xpb_83:
    v_mfma_f32_16x16x32_bf16 v[40:43], v[28:31], v[12:15], 0
    v_and_b32 v29, s81, v219
    v_alignbit_b32 v31, v219, v219, 28
    v_and_b32 v31, s81, v31
    v_perm_b32 v28, v29, v217, s70
    v_perm_b32 v29, v29, v217, s71
    v_pk_min_u16 v8, v28, s85
    v_pk_mad_u16 v28, v8, s75, v28
    v_pk_min_u16 v8, v29, s85
    v_pk_mad_u16 v29, v8, s75, v29
    v_perm_b32 v30, v31, v218, s70
    v_perm_b32 v31, v31, v218, s71
    v_pk_min_u16 v8, v30, s85
    v_pk_mad_u16 v30, v8, s75, v30
    v_pk_min_u16 v8, v31, s85
    v_pk_mad_u16 v31, v8, s75, v31
    s_bitcmp1_b64 s[92:93], 11
    s_cbranch_scc1 L_xp_84
L_xpb_85:
    v_mfma_f32_16x16x32_bf16 v[44:47], v[28:31], v[12:15], 0
    v_add_f32_dpp v4, v32, v35 row_ror:12 row_mask:0xf bank_mask:0xf
    v_add_f32_dpp v5, v36, v39 row_ror:12 row_mask:0xf bank_mask:0xf
    v_add_f32_dpp v6, v40, v43 row_ror:12 row_mask:0xf bank_mask:0xf
    v_add_f32_dpp v4, v33, v4 row_ror:8 row_mask:0xf bank_mask:0xf
    v_add_f32_dpp v5, v37, v5 row_ror:8 row_mask:0xf bank_mask:0xf
    v_add_f32_dpp v6, v41, v6 row_ror:8 row_mask:0xf bank_mask:0xf
    v_add_f32_dpp v16, v34, v4 row_ror:4 row_mask:0xf bank_mask:0x8
    v_add_f32_dpp v17, v38, v5 row_ror:4 row_mask:0xf bank_mask:0x8
    v_add_f32_dpp v18, v42, v6 row_ror:4 row_mask:0xf bank_mask:0x8
    v_and_b32 v29, s81, v222
    v_alignbit_b32 v31, v222, v222, 28
    v_and_b32 v31, s81, v31
    v_perm_b32 v28, v29, v220, s70
    v_perm_b32 v29, v29, v220, s71
    v_pk_min_u16 v8, v28, s85
    v_pk_mad_u16 v28, v8, s75, v28
    v_pk_min_u16 v8, v29, s85
    v_pk_mad_u16 v29, v8, s75, v29
    v_perm_b32 v30, v31, v221, s70
    v_perm_b32 v31, v31, v221, s71
    v_pk_min_u16 v8, v30, s85
    v_pk_mad_u16 v30, v8, s75, v30
    v_pk_min_u16 v8, v31, s85
    v_pk_mad_u16 v31, v8, s75, v31
    s_bitcmp1_b64 s[92:93], 12
    s_cbranch_scc1 L_xp_86
L_xpb_87:
    v_mfma_f32_16x16x32_bf16 v[32:35], v[28:31], v[12:15], 0
    v_and_b32 v29, s81, v225
    v_alignbit_b32 v31, v225, v225, 28
    v_and_b32 v31, s81, v31
    v_perm_b32 v28, v29, v223, s70
    v_perm_b32 v29, v29, v223, s71
    v_pk_min_u16 v8, v28, s85
    v_pk_mad_u16 v28, v8, s75, v28
    v_pk_min_u16 v8, v29, s85
    v_pk_mad_u16 v29, v8, s75, v29
    v_perm_b32 v30, v31, v224, s70
    v_perm_b32 v31, v31, v224, s71
    v_pk_min_u16 v8, v30, s85
    v_pk_mad_u16 v30, v8, s75, v30
    v_pk_min_u16 v8, v31, s85
    v_pk_mad_u16 v31, v8, s75, v31
    s_bitcmp1_b64 s[92:93], 13
    s_cbranch_scc1 L_xp_88
L_xpb_89:
    v_mfma_f32_16x16x32_bf16 v[36:39], v[28:31], v[12:15], 0
    v_and_b32 v29, s81, v228
    v_alignbit_b32 v31, v228, v228, 28
    v_and_b32 v31, s81, v31
    v_perm_b32 v28, v29, v226, s70
    v_perm_b32 v29, v29, v226, s71
    v_pk_min_u16 v8, v28, s85
    v_pk_mad_u16 v28, v8, s75, v28
    v_pk_min_u16 v8, v29, s85
    v_pk_mad_u16 v29, v8, s75, v29
    v_perm_b32 v30, v31, v227, s70
    v_perm_b32 v31, v31, v227, s71
    v_pk_min_u16 v8, v30, s85
    v_pk_mad_u16 v30, v8, s75, v30
    v_pk_min_u16 v8, v31, s85
    v_pk_mad_u16 v31, v8, s75, v31
    s_bitcmp1_b64 s[92:93], 14
    s_cbranch_scc1 L_xp_90
L_xpb_91:
    v_mfma_f32_16x16x32_bf16 v[40:43], v[28:31], v[12:15], 0
    v_add_f32_dpp v4, v44, v47 row_ror:12 row_mask:0xf bank_mask:0xf
    v_add_f32_dpp v5, v32, v35 row_ror:12 row_mask:0xf bank_mask:0xf
    v_add_f32_dpp v6, v36, v39 row_ror:12 row_mask:0xf bank_mask:0xf
    v_add_f32_dpp v4, v45, v4 row_ror:8 row_mask:0xf bank_mask:0xf
    v_add_f32_dpp v5, v33, v5 row_ror:8 row_mask:0xf bank_mask:0xf
    v_add_f32_dpp v6, v37, v6 row_ror:8 row_mask:0xf bank_mask:0xf
    v_add_f32_dpp v19, v46, v4 row_ror:4 row_mask:0xf bank_mask:0x8
    v_add_f32_dpp v20, v34, v5 row_ror:4 row_mask:0xf bank_mask:0x8
    v_add_f32_dpp v21, v38, v6 row_ror:4 row_mask:0xf bank_mask:0x8
    v_and_b32 v29, s81, v231
    v_alignbit_b32 v31, v231, v231, 28
    v_and_b32 v31, s81, v31
    v_perm_b32 v28, v29, v229, s70
    v_perm_b32 v29, v29, v229, s71
    v_pk_min_u16 v8, v28, s85
    v_pk_mad_u16 v28, v8, s75, v28
    v_pk_min_u16 v8, v29, s85
    v_pk_mad_u16 v29, v8, s75, v29
    v_perm_b32 v30, v31, v230, s70
    v_perm_b32 v31, v31, v230, s71
    v_pk_min_u16 v8, v30, s85
    v_pk_mad_u16 v30, v8, s75, v30
    v_pk_min_u16 v8, v31, s85
    v_pk_mad_u16 v31, v8, s75, v31
    s_bitcmp1_b64 s[92:93], 15
    s_cbranch_scc1 L_xp_92
L_xpb_93:
    v_mfma_f32_16x16x32_bf16 v[44:47], v[28:31], v[12:15], 0
    v_add_f32_dpp v4, v40, v43 row_ror:12 row_mask:0xf bank_mask:0xf
    s_nop 6
    v_add_f32_dpp v5, v44, v47 row_ror:12 row_mask:0xf bank_mask:0xf
    v_add_f32_dpp v4, v41, v4 row_ror:8 row_mask:0xf bank_mask:0xf
    s_nop 0
    v_add_f32_dpp v5, v45, v5 row_ror:8 row_mask:0xf bank_mask:0xf
    v_add_f32_dpp v22, v42, v4 row_ror:4 row_mask:0xf bank_mask:0x8
    s_nop 0
    v_add_f32_dpp v23, v46, v5 row_ror:4 row_mask:0xf bank_mask:0x8
L_kj7:
    ds_read_b128 v[44:47], v9 offset:4096
    ds_read_b128 v[40:43], v9 offset:0
    ds_read_b128 v[4:7], v9 offset:1024
    v_mov_b32_dpp v28, v24 row_shl:12 row_mask:0xf bank_mask:0xf
    v_mov_b32_dpp v29, v25 row_shl:12 row_mask:0xf bank_mask:0xf
    v_mov_b32_dpp v30, v26 row_shl:12 row_mask:0xf bank_mask:0xf
    v_mov_b32_dpp v31, v27 row_shl:12 row_mask:0xf bank_mask:0xf
    s_waitcnt lgkmcnt(2)
    v_and_b32 v36, s81, v44
    v_alignbit_b32 v37, v44, v44, 28
    v_and_b32 v37, s81, v37
    v_and_b32 v38, s81, v45
    v_alignbit_b32 v39, v45, v45, 28
    v_and_b32 v39, s81, v39
    s_waitcnt lgkmcnt(1)
    v_perm_b32 v32, v36, v40, s72
    v_perm_b32 v36, v36, v40, s73
    v_pk_min_u16 v8, v32, s85
    v_pk_mad_u16 v32, v8, s74, v32
    v_pk_min_u16 v8, v36, s85
    v_pk_mad_u16 v36, v8, s74, v36
    v_perm_b32 v33, v37, v41, s72
    v_perm_b32 v37, v37, v41, s73
    v_pk_min_u16 v8, v33, s85
    v_pk_mad_u16 v33, v8, s74, v33
    v_pk_min_u16 v8, v37, s85
    v_pk_mad_u16 v37, v8, s74, v37
    v_perm_b32 v34, v38, v42, s72
    v_perm_b32 v38, v38, v42, s73
    v_pk_min_u16 v8, v34, s85
    v_pk_mad_u16 v34, v8, s74, v34
    v_pk_min_u16 v8, v38, s85
    v_pk_mad_u16 v38, v8, s74, v38
    v_perm_b32 v35, v39, v43, s72
    v_perm_b32 v39, v39, v43, s73
    v_pk_min_u16 v8, v35, s85
    v_pk_mad_u16 v35, v8, s74, v35
    v_pk_min_u16 v8, v39, s85
    v_pk_mad_u16 v39, v8, s74, v39
    ds_read_b128 v[40:43], v9 offset:2048
    s_bitcmp1_b64 s[90:91], 12
    s_cbranch_scc1 L_xp_94
L_xpb_95:
    v_mfma_f32_16x16x32_bf16 v[48:51], v[28:31], v[32:35], v[48:51]
    v_mfma_f32_16x16x32_bf16 v[52:55], v[28:31], v[36:39], v[52:55]
    s_waitcnt lgkmcnt(1)
    v_and_b32 v36, s81, v46
    v_alignbit_b32 v37, v46, v46, 28
    v_and_b32 v37, s81, v37
    v_and_b32 v38, s81, v47
    v_alignbit_b32 v39, v47, v47, 28
    v_and_b32 v39, s81, v39
    ds_read_b128 v[44:47], v9 offset:5120
    v_perm_b32 v32, v36, v4, s72
    v_perm_b32 v36, v36, v4, s73
    v_pk_min_u16 v8, v32, s85
    v_pk_mad_u16 v32, v8, s74, v32
    v_pk_min_u16 v8, v36, s85
    v_pk_mad_u16 v36, v8, s74, v36
    v_perm_b32 v33, v37, v5, s72
    v_perm_b32 v37, v37, v5, s73
    v_pk_min_u16 v8, v33, s85
    v_pk_mad_u16 v33, v8, s74, v33
    v_pk_min_u16 v8, v37, s85
    v_pk_mad_u16 v37, v8, s74, v37
    v_perm_b32 v34, v38, v6, s72
    v_perm_b32 v38, v38, v6, s73
    v_pk_min_u16 v8, v34, s85
    v_pk_mad_u16 v34, v8, s74, v34
    v_pk_min_u16 v8, v38, s85
    v_pk_mad_u16 v38, v8, s74, v38
    v_perm_b32 v35, v39, v7, s72
    v_perm_b32 v39, v39, v7, s73
    v_pk_min_u16 v8, v35, s85
    v_pk_mad_u16 v35, v8, s74, v35
    v_pk_min_u16 v8, v39, s85
    v_pk_mad_u16 v39, v8, s74, v39
    ds_read_b128 v[4:7], v9 offset:3072
    s_bitcmp1_b64 s[90:91], 13
    s_cbranch_scc1 L_xp_96
L_xpb_97:
    v_mfma_f32_16x16x32_bf16 v[56:59], v[28:31], v[32:35], v[56:59]
    v_mfma_f32_16x16x32_bf16 v[60:63], v[28:31], v[36:39], v[60:63]
    s_waitcnt lgkmcnt(1)
    v_and_b32 v36, s81, v44
    v_alignbit_b32 v37, v44, v44, 28
    v_and_b32 v37, s81, v37
    v_and_b32 v38, s81, v45
    v_alignbit_b32 v39, v45, v45, 28
    v_and_b32 v39, s81, v39
    v_perm_b32 v32, v36, v40, s72
    v_perm_b32 v36, v36, v40, s73
    v_pk_min_u16 v8, v32, s85
    v_pk_mad_u16 v32, v8, s74, v32
    v_pk_min_u16 v8, v36, s85
    v_pk_mad_u16 v36, v8, s74, v36
    v_perm_b32 v33, v37, v41, s72
    v_perm_b32 v37, v37, v41, s73
    v_pk_min_u16 v8, v33, s85
    v_pk_mad_u16 v33, v8, s74, v33
    v_pk_min_u16 v8, v37, s85
    v_pk_mad_u16 v37, v8, s74, v37
    v_perm_b32 v34, v38, v42, s72
    v_perm_b32 v38, v38, v42, s73
    v_pk_min_u16 v8, v34, s85
    v_pk_mad_u16 v34, v8, s74, v34
    v_pk_min_u16 v8, v38, s85
    v_pk_mad_u16 v38, v8, s74, v38
    v_perm_b32 v35, v39, v43, s72
    v_perm_b32 v39, v39, v43, s73
    v_pk_min_u16 v8, v35, s85
    v_pk_mad_u16 v35, v8, s74, v35
    v_pk_min_u16 v8, v39, s85
    v_pk_mad_u16 v39, v8, s74, v39
    s_bitcmp1_b64 s[90:91], 14
    s_cbranch_scc1 L_xp_98
L_xpb_99:
    v_mfma_f32_16x16x32_bf16 v[64:67], v[28:31], v[32:35], v[64:67]
    v_mfma_f32_16x16x32_bf16 v[68:71], v[28:31], v[36:39], v[68:71]
    s_waitcnt lgkmcnt(0)
    v_and_b32 v36, s81, v46
    v_alignbit_b32 v37, v46, v46, 28
    v_and_b32 v37, s81, v37
    v_and_b32 v38, s81, v47
    v_alignbit_b32 v39, v47, v47, 28
    v_and_b32 v39, s81, v39
    v_perm_b32 v32, v36, v4, s72
    v_perm_b32 v36, v36, v4, s73
    v_pk_min_u16 v8, v32, s85
    v_pk_mad_u16 v32, v8, s74, v32
    v_pk_min_u16 v8, v36, s85
    v_pk_mad_u16 v36, v8, s74, v36
    v_perm_b32 v33, v37, v5, s72
    v_perm_b32 v37, v37, v5, s73
    v_pk_min_u16 v8, v33, s85
    v_pk_mad_u16 v33, v8, s74, v33
    v_pk_min_u16 v8, v37, s85
    v_pk_mad_u16 v37, v8, s74, v37
    v_perm_b32 v34, v38, v6, s72
    v_perm_b32 v38, v38, v6, s73
    v_pk_min_u16 v8, v34, s85
    v_pk_mad_u16 v34, v8, s74, v34
    v_pk_min_u16 v8, v38, s85
    v_pk_mad_u16 v38, v8, s74, v38
    v_perm_b32 v35, v39, v7, s72
    v_perm_b32 v39, v39, v7, s73
    v_pk_min_u16 v8, v35, s85
    v_pk_mad_u16 v35, v8, s74, v35
    v_pk_min_u16 v8, v39, s85
    v_pk_mad_u16 v39, v8, s74, v39
    s_bitcmp1_b64 s[90:91], 15
    s_cbranch_scc1 L_xp_100
L_xpb_101:
    v_mfma_f32_16x16x32_bf16 v[72:75], v[28:31], v[32:35], v[72:75]
    v_mfma_f32_16x16x32_bf16 v[76:79], v[28:31], v[36:39], v[76:79]
    v_max3_f32 v4, v16, v17, v18
    v_max3_f32 v5, v19, v20, v21
    v_max3_f32 v4, v4, v22, v23
    v_max3_f32 v4, v4, v5, v10
    s_nop 1
    v_max_f32_dpp v4, v4, v4 row_ror:4 row_mask:0xf bank_mask:0xf
    s_nop 1
    v_max_f32_dpp v4, v4, v4 row_ror:8 row_mask:0xf bank_mask:0xf
    v_mov_b32 v5, v4
    s_nop 1
    v_permlane16_swap_b32 v4, v5
    v_max_f32 v4, v4, v5
    v_mov_b32 v5, v4
    s_nop 1
    v_permlane32_swap_b32 v4, v5
    v_max_f32 v4, v4, v5
    v_sub_f32 v31, v10, v4
    v_mul_f32 v31, s60, v31
    v_exp_f32 v31, v31
    v_mul_f32 v5, s60, v4
    v_mov_b32 v10, v4
    v_fma_f32 v16, v16, s60, -v5
    v_fma_f32 v17, v17, s60, -v5
    v_fma_f32 v18, v18, s60, -v5
    v_fma_f32 v19, v19, s60, -v5
    v_fma_f32 v20, v20, s60, -v5
    v_fma_f32 v21, v21, s60, -v5
    v_fma_f32 v22, v22, s60, -v5
    v_fma_f32 v23, v23, s60, -v5
    v_readlane_b32 s62, v31, 0
    v_readlane_b32 s63, v31, 1
    v_readlane_b32 s64, v31, 2
    v_readlane_b32 s65, v31, 3
    v_exp_f32 v16, v16
    v_exp_f32 v17, v17
    v_exp_f32 v18, v18
    v_exp_f32 v19, v19
    v_exp_f32 v20, v20
    v_exp_f32 v21, v21
    v_exp_f32 v22, v22
    v_exp_f32 v23, v23
    v_cvt_pk_bf16_f32 v24, v16, v17
    v_cvt_pk_bf16_f32 v25, v18, v19
    v_cvt_pk_bf16_f32 v26, v20, v21
    v_cvt_pk_bf16_f32 v27, v22, v23
    v_mul_f32 v11, v11, v31
    v_pk_mul_f32 v[48:49], v[48:49], s[62:63]
    v_pk_mul_f32 v[50:51], v[50:51], s[64:65]
    v_pk_mul_f32 v[52:53], v[52:53], s[62:63]
    v_pk_mul_f32 v[54:55], v[54:55], s[64:65]
    v_pk_mul_f32 v[56:57], v[56:57], s[62:63]
    v_pk_mul_f32 v[58:59], v[58:59], s[64:65]
    v_pk_mul_f32 v[60:61], v[60:61], s[62:63]
    v_pk_mul_f32 v[62:63], v[62:63], s[64:65]
    v_pk_mul_f32 v[64:65], v[64:65], s[62:63]
    v_pk_mul_f32 v[66:67], v[66:67], s[64:65]
    v_pk_mul_f32 v[68:69], v[68:69], s[62:63]
    v_pk_mul_f32 v[70:71], v[70:71], s[64:65]
    v_pk_mul_f32 v[72:73], v[72:73], s[62:63]
    v_pk_mul_f32 v[74:75], v[74:75], s[64:65]
    v_pk_mul_f32 v[76:77], v[76:77], s[62:63]
    v_pk_mul_f32 v[78:79], v[78:79], s[64:65]
    v_add_f32 v11, v11, v16
    v_add_f32 v11, v11, v17
    v_add_f32 v11, v11, v18
    v_add_f32 v11, v11, v19
    v_add_f32 v11, v11, v20
    v_add_f32 v11, v11, v21
    v_add_f32 v11, v11, v22
    v_add_f32 v11, v11, v23
    s_waitcnt vmcnt(8)
    s_cmp_eq_u32 s54, 0
    s_cbranch_scc1 L_kw8
    s_waitcnt vmcnt(0)
L_kw8:
    v_mfma_f32_16x16x32_bf16 v[32:35], v[80:83], v[12:15], 0
    v_mfma_f32_16x16x32_bf16 v[36:39], v[84:87], v[12:15], 0
    v_mfma_f32_16x16x32_bf16 v[40:43], v[88:91], v[12:15], 0
    v_mfma_f32_16x16x32_bf16 v[44:47], v[92:95], v[12:15], 0
    s_nop 4
    v_add_f32_dpp v4, v33, v32 row_ror:12 row_mask:0xf bank_mask:0xf
    v_add_f32_dpp v5, v37, v36 row_ror:12 row_mask:0xf bank_mask:0xf
    v_add_f32_dpp v6, v41, v40 row_ror:12 row_mask:0xf bank_mask:0xf
    v_add_f32_dpp v7, v45, v44 row_ror:12 row_mask:0xf bank_mask:0xf
    v_add_f32_dpp v4, v34, v4 row_ror:8 row_mask:0xf bank_mask:0xf
    v_add_f32_dpp v5, v38, v5 row_ror:8 row_mask:0xf bank_mask:0xf
    v_add_f32_dpp v6, v42, v6 row_ror:8 row_mask:0xf bank_mask:0xf
    v_add_f32_dpp v7, v46, v7 row_ror:8 row_mask:0xf bank_mask:0xf
    v_add_f32_dpp v16, v35, v4 row_ror:4 row_mask:0xf bank_mask:0x1
    v_add_f32_dpp v17, v39, v5 row_ror:4 row_mask:0xf bank_mask:0x1
    v_add_f32_dpp v18, v43, v6 row_ror:4 row_mask:0xf bank_mask:0x1
    v_add_f32_dpp v19, v47, v7 row_ror:4 row_mask:0xf bank_mask:0x1
    v_mfma_f32_16x16x32_bf16 v[32:35], v[96:99], v[12:15], 0
    v_mfma_f32_16x16x32_bf16 v[36:39], v[100:103], v[12:15], 0
    v_mfma_f32_16x16x32_bf16 v[40:43], v[104:107], v[12:15], 0
    v_mfma_f32_16x16x32_bf16 v[44:47], v[108:111], v[12:15], 0
    s_add_u32 s53, s99, 0x140000
    s_and_b32 s53, s53, 0x1fffff
    buffer_load_dwordx4 v[80:83], v2, s[8:11], s53 offen offset:0 nt
    buffer_load_dwordx4 v[84:87], v2, s[8:11], s53 offen offset:1024 nt
    buffer_load_dwordx4 v[88:91], v2, s[8:11], s53 offen offset:2048 nt
    buffer_load_dwordx4 v[92:95], v2, s[8:11], s53 offen offset:3072 nt
    s_add_u32 s53, s53, 0x1000
    buffer_load_dwordx4 v[96:99], v2, s[8:11], s53 offen offset:0 nt
    buffer_load_dwordx4 v[100:103], v2, s[8:11], s53 offen offset:1024 nt
    buffer_load_dwordx4 v[104:107], v2, s[8:11], s53 offen offset:2048 nt
    buffer_load_dwordx4 v[108:111], v2, s[8:11], s53 offen offset:3072 nt
    v_add_f32_dpp v4, v33, v32 row_ror:12 row_mask:0xf bank_mask:0xf
    v_add_f32_dpp v5, v37, v36 row_ror:12 row_mask:0xf bank_mask:0xf
    v_add_f32_dpp v6, v41, v40 row_ror:12 row_mask:0xf bank_mask:0xf
    v_add_f32_dpp v7, v45, v44 row_ror:12 row_mask:0xf bank_mask:0xf
    v_add_f32_dpp v4, v34, v4 row_ror:8 row_mask:0xf bank_mask:0xf
    v_add_f32_dpp v5, v38, v5 row_ror:8 row_mask:0xf bank_mask:0xf
    v_add_f32_dpp v6, v42, v6 row_ror:8 row_mask:0xf bank_mask:0xf
    v_add_f32_dpp v7, v46, v7 row_ror:8 row_mask:0xf bank_mask:0xf
    v_add_f32_dpp v20, v35, v4 row_ror:4 row_mask:0xf bank_mask:0x1
    v_add_f32_dpp v21, v39, v5 row_ror:4 row_mask:0xf bank_mask:0x1
    v_add_f32_dpp v22, v43, v6 row_ror:4 row_mask:0xf bank_mask:0x1
    v_add_f32_dpp v23, v47, v7 row_ror:4 row_mask:0xf bank_mask:0x1
    ds_read_b128 v[44:47], v9 offset:10240
    ds_read_b128 v[40:43], v9 offset:6144
    ds_read_b128 v[4:7], v9 offset:7168
    s_waitcnt lgkmcnt(2)
    v_and_b32 v36, s81, v44
    v_alignbit_b32 v37, v44, v44, 28
    v_and_b32 v37, s81, v37
    v_and_b32 v38, s81, v45
    v_alignbit_b32 v39, v45, v45, 28
    v_and_b32 v39, s81, v39
    s_waitcnt lgkmcnt(1)
    v_perm_b32 v32, v36, v40, s72
    v_perm_b32 v36, v36, v40, s73
    v_pk_min_u16 v8, v32, s85
    v_pk_mad_u16 v32, v8, s74, v32
    v_pk_min_u16 v8, v36, s85
    v_pk_mad_u16 v36, v8, s74, v36
    v_perm_b32 v33, v37, v41, s72
    v_perm_b32 v37, v37, v41, s73
    v_pk_min_u16 v8, v33, s85
    v_pk_mad_u16 v33, v8, s74, v33
    v_pk_min_u16 v8, v37, s85
    v_pk_mad_u16 v37, v8, s74, v37
    v_perm_b32 v34, v38, v42, s72
    v_perm_b32 v38, v38, v42, s73
    v_pk_min_u16 v8, v34, s85
    v_pk_mad_u16 v34, v8, s74, v34
    v_pk_min_u16 v8, v38, s85
    v_pk_mad_u16 v38, v8, s74, v38
    v_perm_b32 v35, v39, v43, s72
    v_perm_b32 v39, v39, v43, s73
    v_pk_min_u16 v8, v35, s85
    v_pk_mad_u16 v35, v8, s74, v35
    v_pk_min_u16 v8, v39, s85
    v_pk_mad_u16 v39, v8, s74, v39
    ds_read_b128 v[40:43], v9 offset:8192
    s_bitcmp1_b64 s[90:91], 16
    s_cbranch_scc1 L_xp_102
L_xpb_103:
    v_mfma_f32_16x16x32_bf16 v[48:51], v[24:27], v[32:35], v[48:51]
    v_mfma_f32_16x16x32_bf16 v[52:55], v[24:27], v[36:39], v[52:55]
    s_waitcnt lgkmcnt(1)
    v_and_b32 v36, s81, v46
    v_alignbit_b32 v37, v46, v46, 28
    v_and_b32 v37, s81, v37
    v_and_b32 v38, s81, v47
    v_alignbit_b32 v39, v47, v47, 28
    v_and_b32 v39, s81, v39
    ds_read_b128 v[44:47], v9 offset:11264
    v_perm_b32 v32, v36, v4, s72
    v_perm_b32 v36, v36, v4, s73
    v_pk_min_u16 v8, v32, s85
    v_pk_mad_u16 v32, v8, s74, v32
    v_pk_min_u16 v8, v36, s85
    v_pk_mad_u16 v36, v8, s74, v36
    v_perm_b32 v33, v37, v5, s72
    v_perm_b32 v37, v37, v5, s73
    v_pk_min_u16 v8, v33, s85
    v_pk_mad_u16 v33, v8, s74, v33
    v_pk_min_u16 v8, v37, s85
    v_pk_mad_u16 v37, v8, s74, v37
    v_perm_b32 v34, v38, v6, s72
    v_perm_b32 v38, v38, v6, s73
    v_pk_min_u16 v8, v34, s85
    v_pk_mad_u16 v34, v8, s74, v34
    v_pk_min_u16 v8, v38, s85
    v_pk_mad_u16 v38, v8, s74, v38
    v_perm_b32 v35, v39, v7, s72
    v_perm_b32 v39, v39, v7, s73
    v_pk_min_u16 v8, v35, s85
    v_pk_mad_u16 v35, v8, s74, v35
    v_pk_min_u16 v8, v39, s85
    v_pk_mad_u16 v39, v8, s74, v39
    ds_read_b128 v[4:7], v9 offset:9216
    s_bitcmp1_b64 s[90:91], 17
    s_cbranch_scc1 L_xp_104
L_xpb_105:
    v_mfma_f32_16x16x32_bf16 v[56:59], v[24:27], v[32:35], v[56:59]
    v_mfma_f32_16x16x32_bf16 v[60:63], v[24:27], v[36:39], v[60:63]
    s_waitcnt lgkmcnt(1)
    v_and_b32 v36, s81, v44
    v_alignbit_b32 v37, v44, v44, 28
    v_and_b32 v37, s81, v37
    v_and_b32 v38, s81, v45
    v_alignbit_b32 v39, v45, v45, 28
    v_and_b32 v39, s81, v39
    v_perm_b32 v32, v36, v40, s72
    v_perm_b32 v36, v36, v40, s73
    v_pk_min_u16 v8, v32, s85
    v_pk_mad_u16 v32, v8, s74, v32
    v_pk_min_u16 v8, v36, s85
    v_pk_mad_u16 v36, v8, s74, v36
    v_perm_b32 v33, v37, v41, s72
    v_perm_b32 v37, v37, v41, s73
    v_pk_min_u16 v8, v33, s85
    v_pk_mad_u16 v33, v8, s74, v33
    v_pk_min_u16 v8, v37, s85
    v_pk_mad_u16 v37, v8, s74, v37
    v_perm_b32 v34, v38, v42, s72
    v_perm_b32 v38, v38, v42, s73
    v_pk_min_u16 v8, v34, s85
    v_pk_mad_u16 v34, v8, s74, v34
    v_pk_min_u16 v8, v38, s85
    v_pk_mad_u16 v38, v8, s74, v38
    v_perm_b32 v35, v39, v43, s72
    v_perm_b32 v39, v39, v43, s73
    v_pk_min_u16 v8, v35, s85
    v_pk_mad_u16 v35, v8, s74, v35
    v_pk_min_u16 v8, v39, s85
    v_pk_mad_u16 v39, v8, s74, v39
    s_bitcmp1_b64 s[90:91], 18
    s_cbranch_scc1 L_xp_106
L_xpb_107:
    v_mfma_f32_16x16x32_bf16 v[64:67], v[24:27], v[32:35], v[64:67]
    v_mfma_f32_16x16x32_bf16 v[68:71], v[24:27], v[36:39], v[68:71]
    s_waitcnt lgkmcnt(0)
    v_and_b32 v36, s81, v46
    v_alignbit_b32 v37, v46, v46, 28
    v_and_b32 v37, s81, v37
    v_and_b32 v38, s81, v47
    v_alignbit_b32 v39, v47, v47, 28
    v_and_b32 v39, s81, v39
    v_perm_b32 v32, v36, v4, s72
    v_perm_b32 v36, v36, v4, s73
    v_pk_min_u16 v8, v32, s85
    v_pk_mad_u16 v32, v8, s74, v32
    v_pk_min_u16 v8, v36, s85
    v_pk_mad_u16 v36, v8, s74, v36
    v_perm_b32 v33, v37, v5, s72
    v_perm_b32 v37, v37, v5, s73
    v_pk_min_u16 v8, v33, s85
    v_pk_mad_u16 v33, v8, s74, v33
    v_pk_min_u16 v8, v37, s85
    v_pk_mad_u16 v37, v8, s74, v37
    v_perm_b32 v34, v38, v6, s72
    v_perm_b32 v38, v38, v6, s73
    v_pk_min_u16 v8, v34, s85
    v_pk_mad_u16 v34, v8, s74, v34
    v_pk_min_u16 v8, v38, s85
    v_pk_mad_u16 v38, v8, s74, v38
    v_perm_b32 v35, v39, v7, s72
    v_perm_b32 v39, v39, v7, s73
    v_pk_min_u16 v8, v35, s85
    v_pk_mad_u16 v35, v8, s74, v35
    v_pk_min_u16 v8, v39, s85
    v_pk_mad_u16 v39, v8, s74, v39
    s_bitcmp1_b64 s[90:91], 19
    s_cbranch_scc1 L_xp_108
L_xpb_109:
    v_mfma_f32_16x16x32_bf16 v[72:75], v[24:27], v[32:35], v[72:75]
    v_mfma_f32_16x16x32_bf16 v[76:79], v[24:27], v[36:39], v[76:79]
    s_waitcnt vmcnt(8)
    v_mfma_f32_16x16x32_bf16 v[32:35], v[112:115], v[12:15], 0
    v_mfma_f32_16x16x32_bf16 v[36:39], v[116:119], v[12:15], 0
    v_mfma_f32_16x16x32_bf16 v[40:43], v[120:123], v[12:15], 0
    v_mfma_f32_16x16x32_bf16 v[44:47], v[124:127], v[12:15], 0
    s_nop 4
    v_add_f32_dpp v4, v32, v33 row_ror:4 row_mask:0xf bank_mask:0xf
    v_add_f32_dpp v5, v36, v37 row_ror:4 row_mask:0xf bank_mask:0xf
    v_add_f32_dpp v6, v40, v41 row_ror:4 row_mask:0xf bank_mask:0xf
    v_add_f32_dpp v7, v44, v45 row_ror:4 row_mask:0xf bank_mask:0xf
    v_add_f32_dpp v4, v34, v4 row_ror:12 row_mask:0xf bank_mask:0xf
    v_add_f32_dpp v5, v38, v5 row_ror:12 row_mask:0xf bank_mask:0xf
    v_add_f32_dpp v6, v42, v6 row_ror:12 row_mask:0xf bank_mask:0xf
    v_add_f32_dpp v7, v46, v7 row_ror:12 row_mask:0xf bank_mask:0xf
    v_add_f32_dpp v16, v35, v4 row_ror:8 row_mask:0xf bank_mask:0x2
    v_add_f32_dpp v17, v39, v5 row_ror:8 row_mask:0xf bank_mask:0x2
    v_add_f32_dpp v18, v43, v6 row_ror:8 row_mask:0xf bank_mask:0x2
    v_add_f32_dpp v19, v47, v7 row_ror:8 row_mask:0xf bank_mask:0x2
    v_mfma_f32_16x16x32_bf16 v[32:35], v[128:131], v[12:15], 0
    v_mfma_f32_16x16x32_bf16 v[36:39], v[132:135], v[12:15], 0
    v_mfma_f32_16x16x32_bf16 v[40:43], v[136:139], v[12:15], 0
    v_mfma_f32_16x16x32_bf16 v[44:47], v[140:143], v[12:15], 0
    s_mul_i32 s66, s54, 0x40000
    s_add_u32 s99, s99, s66
    s_add_u32 s53, s99, 0x160000
    s_and_b32 s53, s53, 0x1fffff
    buffer_load_dwordx4 v[112:115], v2, s[8:11], s53 offen offset:0 nt
    buffer_load_dwordx4 v[116:119], v2, s[8:11], s53 offen offset:1024 nt
    buffer_load_dwordx4 v[120:123], v2, s[8:11], s53 offen offset:2048 nt
    buffer_load_dwordx4 v[124:127], v2, s[8:11], s53 offen offset:3072 nt
    s_add_u32 s53, s53, 0x1000
    buffer_load_dwordx4 v[128:131], v2, s[8:11], s53 offen offset:0 nt
    buffer_load_dwordx4 v[132:135], v2, s[8:11], s53 offen offset:1024 nt
    buffer_load_dwordx4 v[136:139], v2, s[8:11], s53 offen offset:2048 nt
    buffer_load_dwordx4 v[140:143], v2, s[8:11], s53 offen offset:3072 nt
    s_sub_u32 s99, s99, s66
    v_add_f32_dpp v4, v32, v33 row_ror:4 row_mask:0xf bank_mask:0xf
    v_add_f32_dpp v5, v36, v37 row_ror:4 row_mask:0xf bank_mask:0xf
    v_add_f32_dpp v6, v40, v41 row_ror:4 row_mask:0xf bank_mask:0xf
    v_add_f32_dpp v7, v44, v45 row_ror:4 row_mask:0xf bank_mask:0xf
    v_add_f32_dpp v4, v34, v4 row_ror:12 row_mask:0xf bank_mask:0xf
    v_add_f32_dpp v5, v38, v5 row_ror:12 row_mask:0xf bank_mask:0xf
    v_add_f32_dpp v6, v42, v6 row_ror:12 row_mask:0xf bank_mask:0xf
    v_add_f32_dpp v7, v46, v7 row_ror:12 row_mask:0xf bank_mask:0xf
    v_add_f32_dpp v20, v35, v4 row_ror:8 row_mask:0xf bank_mask:0x2
    v_add_f32_dpp v21, v39, v5 row_ror:8 row_mask:0xf bank_mask:0x2
    v_add_f32_dpp v22, v43, v6 row_ror:8 row_mask:0xf bank_mask:0x2
    v_add_f32_dpp v23, v47, v7 row_ror:8 row_mask:0xf bank_mask:0x2
    ds_read_b128 v[44:47], v9 offset:16384
    ds_read_b128 v[40:43], v9 offset:12288
    ds_read_b128 v[4:7], v9 offset:13312
    v_mov_b32_dpp v28, v24 row_shl:4 row_mask:0xf bank_mask:0xf
    v_mov_b32_dpp v29, v25 row_shl:4 row_mask:0xf bank_mask:0xf
    v_mov_b32_dpp v30, v26 row_shl:4 row_mask:0xf bank_mask:0xf
    v_mov_b32_dpp v31, v27 row_shl:4 row_mask:0xf bank_mask:0xf
    s_waitcnt lgkmcnt(2)
    v_and_b32 v36, s81, v44
    v_alignbit_b32 v37, v44, v44, 28
    v_and_b32 v37, s81, v37
    v_and_b32 v38, s81, v45
    v_alignbit_b32 v39, v45, v45, 28
    v_and_b32 v39, s81, v39
    s_waitcnt lgkmcnt(1)
    v_perm_b32 v32, v36, v40, s72
    v_perm_b32 v36, v36, v40, s73
    v_pk_min_u16 v8, v32, s85
    v_pk_mad_u16 v32, v8, s74, v32
    v_pk_min_u16 v8, v36, s85
    v_pk_mad_u16 v36, v8, s74, v36
    v_perm_b32 v33, v37, v41, s72
    v_perm_b32 v37, v37, v41, s73
    v_pk_min_u16 v8, v33, s85
    v_pk_mad_u16 v33, v8, s74, v33
    v_pk_min_u16 v8, v37, s85
    v_pk_mad_u16 v37, v8, s74, v37
    v_perm_b32 v34, v38, v42, s72
    v_perm_b32 v38, v38, v42, s73
    v_pk_min_u16 v8, v34, s85
    v_pk_mad_u16 v34, v8, s74, v34
    v_pk_min_u16 v8, v38, s85
    v_pk_mad_u16 v38, v8, s74, v38
    v_perm_b32 v35, v39, v43, s72
    v_perm_b32 v39, v39, v43, s73
    v_pk_min_u16 v8, v35, s85
    v_pk_mad_u16 v35, v8, s74, v35
    v_pk_min_u16 v8, v39, s85
    v_pk_mad_u16 v39, v8, s74, v39
    ds_read_b128 v[40:43], v9 offset:14336
    s_bitcmp1_b64 s[90:91], 20
    s_cbranch_scc1 L_xp_110
L_xpb_111:
    v_mfma_f32_16x16x32_bf16 v[48:51], v[28:31], v[32:35], v[48:51]
    v_mfma_f32_16x16x32_bf16 v[52:55], v[28:31], v[36:39], v[52:55]
    s_waitcnt lgkmcnt(1)
    v_and_b32 v36, s81, v46
    v_alignbit_b32 v37, v46, v46, 28
    v_and_b32 v37, s81, v37
    v_and_b32 v38, s81, v47
    v_alignbit_b32 v39, v47, v47, 28
    v_and_b32 v39, s81, v39
    ds_read_b128 v[44:47], v9 offset:17408
    v_perm_b32 v32, v36, v4, s72
    v_perm_b32 v36, v36, v4, s73
    v_pk_min_u16 v8, v32, s85
    v_pk_mad_u16 v32, v8, s74, v32
    v_pk_min_u16 v8, v36, s85
    v_pk_mad_u16 v36, v8, s74, v36
    v_perm_b32 v33, v37, v5, s72
    v_perm_b32 v37, v37, v5, s73
    v_pk_min_u16 v8, v33, s85
    v_pk_mad_u16 v33, v8, s74, v33
    v_pk_min_u16 v8, v37, s85
    v_pk_mad_u16 v37, v8, s74, v37
    v_perm_b32 v34, v38, v6, s72
    v_perm_b32 v38, v38, v6, s73
    v_pk_min_u16 v8, v34, s85
    v_pk_mad_u16 v34, v8, s74, v34
    v_pk_min_u16 v8, v38, s85
    v_pk_mad_u16 v38, v8, s74, v38
    v_perm_b32 v35, v39, v7, s72
    v_perm_b32 v39, v39, v7, s73
    v_pk_min_u16 v8, v35, s85
    v_pk_mad_u16 v35, v8, s74, v35
    v_pk_min_u16 v8, v39, s85
    v_pk_mad_u16 v39, v8, s74, v39
    ds_read_b128 v[4:7], v9 offset:15360
    s_bitcmp1_b64 s[90:91], 21
    s_cbranch_scc1 L_xp_112
L_xpb_113:
    v_mfma_f32_16x16x32_bf16 v[56:59], v[28:31], v[32:35], v[56:59]
    v_mfma_f32_16x16x32_bf16 v[60:63], v[28:31], v[36:39], v[60:63]
    s_waitcnt lgkmcnt(1)
    v_and_b32 v36, s81, v44
    v_alignbit_b32 v37, v44, v44, 28
    v_and_b32 v37, s81, v37
    v_and_b32 v38, s81, v45
    v_alignbit_b32 v39, v45, v45, 28
    v_and_b32 v39, s81, v39
    v_perm_b32 v32, v36, v40, s72
    v_perm_b32 v36, v36, v40, s73
    v_pk_min_u16 v8, v32, s85
    v_pk_mad_u16 v32, v8, s74, v32
    v_pk_min_u16 v8, v36, s85
    v_pk_mad_u16 v36, v8, s74, v36
    v_perm_b32 v33, v37, v41, s72
    v_perm_b32 v37, v37, v41, s73
    v_pk_min_u16 v8, v33, s85
    v_pk_mad_u16 v33, v8, s74, v33
    v_pk_min_u16 v8, v37, s85
    v_pk_mad_u16 v37, v8, s74, v37
    v_perm_b32 v34, v38, v42, s72
    v_perm_b32 v38, v38, v42, s73
    v_pk_min_u16 v8, v34, s85
    v_pk_mad_u16 v34, v8, s74, v34
    v_pk_min_u16 v8, v38, s85
    v_pk_mad_u16 v38, v8, s74, v38
    v_perm_b32 v35, v39, v43, s72
    v_perm_b32 v39, v39, v43, s73
    v_pk_min_u16 v8, v35, s85
    v_pk_mad_u16 v35, v8, s74, v35
    v_pk_min_u16 v8, v39, s85
    v_pk_mad_u16 v39, v8, s74, v39
    s_bitcmp1_b64 s[90:91], 22
    s_cbranch_scc1 L_xp_114
L_xpb_115:
    v_mfma_f32_16x16x32_bf16 v[64:67], v[28:31], v[32:35], v[64:67]
    v_mfma_f32_16x16x32_bf16 v[68:71], v[28:31], v[36:39], v[68:71]
    s_waitcnt lgkmcnt(0)
    v_and_b32 v36, s81, v46
    v_alignbit_b32 v37, v46, v46, 28
    v_and_b32 v37, s81, v37
    v_and_b32 v38, s81, v47
    v_alignbit_b32 v39, v47, v47, 28
    v_and_b32 v39, s81, v39
    v_perm_b32 v32, v36, v4, s72
    v_perm_b32 v36, v36, v4, s73
    v_pk_min_u16 v8, v32, s85
    v_pk_mad_u16 v32, v8, s74, v32
    v_pk_min_u16 v8, v36, s85
    v_pk_mad_u16 v36, v8, s74, v36
    v_perm_b32 v33, v37, v5, s72
    v_perm_b32 v37, v37, v5, s73
    v_pk_min_u16 v8, v33, s85
    v_pk_mad_u16 v33, v8, s74, v33
    v_pk_min_u16 v8, v37, s85
    v_pk_mad_u16 v37, v8, s74, v37
    v_perm_b32 v34, v38, v6, s72
    v_perm_b32 v38, v38, v6, s73
    v_pk_min_u16 v8, v34, s85
    v_pk_mad_u16 v34, v8, s74, v34
    v_pk_min_u16 v8, v38, s85
    v_pk_mad_u16 v38, v8, s74, v38
    v_perm_b32 v35, v39, v7, s72
    v_perm_b32 v39, v39, v7, s73
    v_pk_min_u16 v8, v35, s85
    v_pk_mad_u16 v35, v8, s74, v35
    v_pk_min_u16 v8, v39, s85
    v_pk_mad_u16 v39, v8, s74, v39
    s_bitcmp1_b64 s[90:91], 23
    s_cbranch_scc1 L_xp_116
L_xpb_117:
    v_mfma_f32_16x16x32_bf16 v[72:75], v[28:31], v[32:35], v[72:75]
    v_mfma_f32_16x16x32_bf16 v[76:79], v[28:31], v[36:39], v[76:79]
    s_waitcnt vmcnt(8)
    v_mfma_f32_16x16x32_bf16 v[32:35], v[80:83], v[12:15], 0
    v_mfma_f32_16x16x32_bf16 v[36:39], v[84:87], v[12:15], 0
    v_mfma_f32_16x16x32_bf16 v[40:43], v[88:91], v[12:15], 0
    v_mfma_f32_16x16x32_bf16 v[44:47], v[92:95], v[12:15], 0
    s_nop 4
    v_add_f32_dpp v4, v32, v34 row_ror:8 row_mask:0xf bank_mask:0xf
    v_add_f32_dpp v5, v36, v38 row_ror:8 row_mask:0xf bank_mask:0xf
    v_add_f32_dpp v6, v40, v42 row_ror:8 row_mask:0xf bank_mask:0xf
    v_add_f32_dpp v7, v44, v46 row_ror:8 row_mask:0xf bank_mask:0xf
    v_add_f32_dpp v4, v33, v4 row_ror:4 row_mask:0xf bank_mask:0xf
    v_add_f32_dpp v5, v37, v5 row_ror:4 row_mask:0xf bank_mask:0xf
    v_add_f32_dpp v6, v41, v6 row_ror:4 row_mask:0xf bank_mask:0xf
    v_add_f32_dpp v7, v45, v7 row_ror:4 row_mask:0xf bank_mask:0xf
    v_add_f32_dpp v16, v35, v4 row_ror:12 row_mask:0xf bank_mask:0x4
    v_add_f32_dpp v17, v39, v5 row_ror:12 row_mask:0xf bank_mask:0x4
    v_add_f32_dpp v18, v43, v6 row_ror:12 row_mask:0xf bank_mask:0x4
    v_add_f32_dpp v19, v47, v7 row_ror:12 row_mask:0xf bank_mask:0x4
    v_mfma_f32_16x16x32_bf16 v[32:35], v[96:99], v[12:15], 0
    v_mfma_f32_16x16x32_bf16 v[36:39], v[100:103], v[12:15], 0
    v_mfma_f32_16x16x32_bf16 v[40:43], v[104:107], v[12:15], 0
    v_mfma_f32_16x16x32_bf16 v[44:47], v[108:111], v[12:15], 0
    s_add_u32 s53, s99, 0x180000
    s_and_b32 s53, s53, 0x1fffff
    buffer_load_dwordx4 v[80:83], v2, s[8:11], s53 offen offset:0 nt
    buffer_load_dwordx4 v[84:87], v2, s[8:11], s53 offen offset:1024 nt
    buffer_load_dwordx4 v[88:91], v2, s[8:11], s53 offen offset:2048 nt
    buffer_load_dwordx4 v[92:95], v2, s[8:11], s53 offen offset:3072 nt
    s_add_u32 s53, s53, 0x1000
    buffer_load_dwordx4 v[96:99], v2, s[8:11], s53 offen offset:0 nt
    buffer_load_dwordx4 v[100:103], v2, s[8:11], s53 offen offset:1024 nt
    buffer_load_dwordx4 v[104:107], v2, s[8:11], s53 offen offset:2048 nt
    buffer_load_dwordx4 v[108:111], v2, s[8:11], s53 offen offset:3072 nt
    v_add_f32_dpp v4, v32, v34 row_ror:8 row_mask:0xf bank_mask:0xf
    v_add_f32_dpp v5, v36, v38 row_ror:8 row_mask:0xf bank_mask:0xf
    v_add_f32_dpp v6, v40, v42 row_ror:8 row_mask:0xf bank_mask:0xf
    v_add_f32_dpp v7, v44, v46 row_ror:8 row_mask:0xf bank_mask:0xf
    v_add_f32_dpp v4, v33, v4 row_ror:4 row_mask:0xf bank_mask:0xf
    v_add_f32_dpp v5, v37, v5 row_ror:4 row_mask:0xf bank_mask:0xf
    v_add_f32_dpp v6, v41, v6 row_ror:4 row_mask:0xf bank_mask:0xf
    v_add_f32_dpp v7, v45, v7 row_ror:4 row_mask:0xf bank_mask:0xf
    v_add_f32_dpp v20, v35, v4 row_ror:12 row_mask:0xf bank_mask:0x4
    v_add_f32_dpp v21, v39, v5 row_ror:12 row_mask:0xf bank_mask:0x4
    v_add_f32_dpp v22, v43, v6 row_ror:12 row_mask:0xf bank_mask:0x4
    v_add_f32_dpp v23, v47, v7 row_ror:12 row_mask:0xf bank_mask:0x4
    ds_read_b128 v[44:47], v9 offset:22528
    ds_read_b128 v[40:43], v9 offset:18432
    ds_read_b128 v[4:7], v9 offset:19456
    v_mov_b32_dpp v28, v24 row_shl:8 row_mask:0xf bank_mask:0xf
    v_mov_b32_dpp v29, v25 row_shl:8 row_mask:0xf bank_mask:0xf
    v_mov_b32_dpp v30, v26 row_shl:8 row_mask:0xf bank_mask:0xf
    v_mov_b32_dpp v31, v27 row_shl:8 row_mask:0xf bank_mask:0xf
    s_waitcnt lgkmcnt(2)
    v_and_b32 v36, s81, v44
    v_alignbit_b32 v37, v44, v44, 28
    v_and_b32 v37, s81, v37
    v_and_b32 v38, s81, v45
    v_alignbit_b32 v39, v45, v45, 28
    v_and_b32 v39, s81, v39
    s_waitcnt lgkmcnt(1)
    v_perm_b32 v32, v36, v40, s72
    v_perm_b32 v36, v36, v40, s73
    v_pk_min_u16 v8, v32, s85
    v_pk_mad_u16 v32, v8, s74, v32
    v_pk_min_u16 v8, v36, s85
    v_pk_mad_u16 v36, v8, s74, v36
    v_perm_b32 v33, v37, v41, s72
    v_perm_b32 v37, v37, v41, s73
    v_pk_min_u16 v8, v33, s85
    v_pk_mad_u16 v33, v8, s74, v33
    v_pk_min_u16 v8, v37, s85
    v_pk_mad_u16 v37, v8, s74, v37
    v_perm_b32 v34, v38, v42, s72
    v_perm_b32 v38, v38, v42, s73
    v_pk_min_u16 v8, v34, s85
    v_pk_mad_u16 v34, v8, s74, v34
    v_pk_min_u16 v8, v38, s85
    v_pk_mad_u16 v38, v8, s74, v38
    v_perm_b32 v35, v39, v43, s72
    v_perm_b32 v39, v39, v43, s73
    v_pk_min_u16 v8, v35, s85
    v_pk_mad_u16 v35, v8, s74, v35
    v_pk_min_u16 v8, v39, s85
    v_pk_mad_u16 v39, v8, s74, v39
    ds_read_b128 v[40:43], v9 offset:20480
    s_bitcmp1_b64 s[90:91], 24
    s_cbranch_scc1 L_xp_118
L_xpb_119:
    v_mfma_f32_16x16x32_bf16 v[48:51], v[28:31], v[32:35], v[48:51]
    v_mfma_f32_16x16x32_bf16 v[52:55], v[28:31], v[36:39], v[52:55]
    s_waitcnt lgkmcnt(1)
    v_and_b32 v36, s81, v46
    v_alignbit_b32 v37, v46, v46, 28
    v_and_b32 v37, s81, v37
    v_and_b32 v38, s81, v47
    v_alignbit_b32 v39, v47, v47, 28
    v_and_b32 v39, s81, v39
    ds_read_b128 v[44:47], v9 offset:23552
    v_perm_b32 v32, v36, v4, s72
    v_perm_b32 v36, v36, v4, s73
    v_pk_min_u16 v8, v32, s85
    v_pk_mad_u16 v32, v8, s74, v32
    v_pk_min_u16 v8, v36, s85
    v_pk_mad_u16 v36, v8, s74, v36
    v_perm_b32 v33, v37, v5, s72
    v_perm_b32 v37, v37, v5, s73
    v_pk_min_u16 v8, v33, s85
    v_pk_mad_u16 v33, v8, s74, v33
    v_pk_min_u16 v8, v37, s85
    v_pk_mad_u16 v37, v8, s74, v37
    v_perm_b32 v34, v38, v6, s72
    v_perm_b32 v38, v38, v6, s73
    v_pk_min_u16 v8, v34, s85
    v_pk_mad_u16 v34, v8, s74, v34
    v_pk_min_u16 v8, v38, s85
    v_pk_mad_u16 v38, v8, s74, v38
    v_perm_b32 v35, v39, v7, s72
    v_perm_b32 v39, v39, v7, s73
    v_pk_min_u16 v8, v35, s85
    v_pk_mad_u16 v35, v8, s74, v35
    v_pk_min_u16 v8, v39, s85
    v_pk_mad_u16 v39, v8, s74, v39
    ds_read_b128 v[4:7], v9 offset:21504
    s_bitcmp1_b64 s[90:91], 25
    s_cbranch_scc1 L_xp_120
L_xpb_121:
    v_mfma_f32_16x16x32_bf16 v[56:59], v[28:31], v[32:35], v[56:59]
    v_mfma_f32_16x16x32_bf16 v[60:63], v[28:31], v[36:39], v[60:63]
    s_waitcnt lgkmcnt(1)
    v_and_b32 v36, s81, v44
    v_alignbit_b32 v37, v44, v44, 28
    v_and_b32 v37, s81, v37
    v_and_b32 v38, s81, v45
    v_alignbit_b32 v39, v45, v45, 28
    v_and_b32 v39, s81, v39
    v_perm_b32 v32, v36, v40, s72
    v_perm_b32 v36, v36, v40, s73
    v_pk_min_u16 v8, v32, s85
    v_pk_mad_u16 v32, v8, s74, v32
    v_pk_min_u16 v8, v36, s85
    v_pk_mad_u16 v36, v8, s74, v36
    v_perm_b32 v33, v37, v41, s72
    v_perm_b32 v37, v37, v41, s73
    v_pk_min_u16 v8, v33, s85
    v_pk_mad_u16 v33, v8, s74, v33
    v_pk_min_u16 v8, v37, s85
    v_pk_mad_u16 v37, v8, s74, v37
    v_perm_b32 v34, v38, v42, s72
    v_perm_b32 v38, v38, v42, s73
    v_pk_min_u16 v8, v34, s85
    v_pk_mad_u16 v34, v8, s74, v34
    v_pk_min_u16 v8, v38, s85
    v_pk_mad_u16 v38, v8, s74, v38
    v_perm_b32 v35, v39, v43, s72
    v_perm_b32 v39, v39, v43, s73
    v_pk_min_u16 v8, v35, s85
    v_pk_mad_u16 v35, v8, s74, v35
    v_pk_min_u16 v8, v39, s85
    v_pk_mad_u16 v39, v8, s74, v39
    s_bitcmp1_b64 s[90:91], 26
    s_cbranch_scc1 L_xp_122
L_xpb_123:
    v_mfma_f32_16x16x32_bf16 v[64:67], v[28:31], v[32:35], v[64:67]
    v_mfma_f32_16x16x32_bf16 v[68:71], v[28:31], v[36:39], v[68:71]
    s_waitcnt lgkmcnt(0)
    v_and_b32 v36, s81, v46
    v_alignbit_b32 v37, v46, v46, 28
    v_and_b32 v37, s81, v37
    v_and_b32 v38, s81, v47
    v_alignbit_b32 v39, v47, v47, 28
    v_and_b32 v39, s81, v39
    v_perm_b32 v32, v36, v4, s72
    v_perm_b32 v36, v36, v4, s73
    v_pk_min_u16 v8, v32, s85
    v_pk_mad_u16 v32, v8, s74, v32
    v_pk_min_u16 v8, v36, s85
    v_pk_mad_u16 v36, v8, s74, v36
    v_perm_b32 v33, v37, v5, s72
    v_perm_b32 v37, v37, v5, s73
    v_pk_min_u16 v8, v33, s85
    v_pk_mad_u16 v33, v8, s74, v33
    v_pk_min_u16 v8, v37, s85
    v_pk_mad_u16 v37, v8, s74, v37
    v_perm_b32 v34, v38, v6, s72
    v_perm_b32 v38, v38, v6, s73
    v_pk_min_u16 v8, v34, s85
    v_pk_mad_u16 v34, v8, s74, v34
    v_pk_min_u16 v8, v38, s85
    v_pk_mad_u16 v38, v8, s74, v38
    v_perm_b32 v35, v39, v7, s72
    v_perm_b32 v39, v39, v7, s73
    v_pk_min_u16 v8, v35, s85
    v_pk_mad_u16 v35, v8, s74, v35
    v_pk_min_u16 v8, v39, s85
    v_pk_mad_u16 v39, v8, s74, v39
    s_bitcmp1_b64 s[90:91], 27
    s_cbranch_scc1 L_xp_124
L_xpb_125:
    v_mfma_f32_16x16x32_bf16 v[72:75], v[28:31], v[32:35], v[72:75]
    v_mfma_f32_16x16x32_bf16 v[76:79], v[28:31], v[36:39], v[76:79]
    s_cmp_lg_u32 s54, 0
    s_cbranch_scc1 L_kd11
    s_waitcnt vmcnt(8)
    v_mfma_f32_16x16x32_bf16 v[32:35], v[112:115], v[12:15], 0
    v_mfma_f32_16x16x32_bf16 v[36:39], v[116:119], v[12:15], 0
    v_mfma_f32_16x16x32_bf16 v[40:43], v[120:123], v[12:15], 0
    v_mfma_f32_16x16x32_bf16 v[44:47], v[124:127], v[12:15], 0
    s_nop 4
    v_add_f32_dpp v4, v32, v35 row_ror:12 row_mask:0xf bank_mask:0xf
    v_add_f32_dpp v5, v36, v39 row_ror:12 row_mask:0xf bank_mask:0xf
    v_add_f32_dpp v6, v40, v43 row_ror:12 row_mask:0xf bank_mask:0xf
    v_add_f32_dpp v7, v44, v47 row_ror:12 row_mask:0xf bank_mask:0xf
    v_add_f32_dpp v4, v33, v4 row_ror:8 row_mask:0xf bank_mask:0xf
    v_add_f32_dpp v5, v37, v5 row_ror:8 row_mask:0xf bank_mask:0xf
    v_add_f32_dpp v6, v41, v6 row_ror:8 row_mask:0xf bank_mask:0xf
    v_add_f32_dpp v7, v45, v7 row_ror:8 row_mask:0xf bank_mask:0xf
    v_add_f32_dpp v16, v34, v4 row_ror:4 row_mask:0xf bank_mask:0x8
    v_add_f32_dpp v17, v38, v5 row_ror:4 row_mask:0xf bank_mask:0x8
    v_add_f32_dpp v18, v42, v6 row_ror:4 row_mask:0xf bank_mask:0x8
    v_add_f32_dpp v19, v46, v7 row_ror:4 row_mask:0xf bank_mask:0x8
    v_mfma_f32_16x16x32_bf16 v[32:35], v[128:131], v[12:15], 0
    v_mfma_f32_16x16x32_bf16 v[36:39], v[132:135], v[12:15], 0
    v_mfma_f32_16x16x32_bf16 v[40:43], v[136:139], v[12:15], 0
    v_mfma_f32_16x16x32_bf16 v[44:47], v[140:143], v[12:15], 0
    s_nop 4
    v_add_f32_dpp v4, v32, v35 row_ror:12 row_mask:0xf bank_mask:0xf
    v_add_f32_dpp v5, v36, v39 row_ror:12 row_mask:0xf bank_mask:0xf
    v_add_f32_dpp v6, v40, v43 row_ror:12 row_mask:0xf bank_mask:0xf
    v_add_f32_dpp v7, v44, v47 row_ror:12 row_mask:0xf bank_mask:0xf
    v_add_f32_dpp v4, v33, v4 row_ror:8 row_mask:0xf bank_mask:0xf
    v_add_f32_dpp v5, v37, v5 row_ror:8 row_mask:0xf bank_mask:0xf
    v_add_f32_dpp v6, v41, v6 row_ror:8 row_mask:0xf bank_mask:0xf
    v_add_f32_dpp v7, v45, v7 row_ror:8 row_mask:0xf bank_mask:0xf
    v_add_f32_dpp v20, v34, v4 row_ror:4 row_mask:0xf bank_mask:0x8
    v_add_f32_dpp v21, v38, v5 row_ror:4 row_mask:0xf bank_mask:0x8
    v_add_f32_dpp v22, v42, v6 row_ror:4 row_mask:0xf bank_mask:0x8
    v_add_f32_dpp v23, v46, v7 row_ror:4 row_mask:0xf bank_mask:0x8
    v_pk_sub_u16 v44, v112, s85
    v_pk_sub_u16 v42, v113, s85
    v_pk_min_u16 v44, v44, v42
    v_pk_sub_u16 v42, v114, s85
    v_pk_min_u16 v44, v44, v42
    v_pk_sub_u16 v42, v115, s85
    v_pk_min_u16 v44, v44, v42
    v_pk_sub_u16 v40, v112, s75 clamp
    v_pk_sub_u16 v41, v113, s75 clamp
    v_perm_b32 v232, v41, v40, s70
    v_perm_b32 v40, v41, v40, s71
    v_pk_sub_u16 v41, v114, s75 clamp
    v_pk_sub_u16 v42, v115, s75 clamp
    v_perm_b32 v233, v42, v41, s70
    v_perm_b32 v41, v42, v41, s71
    v_or_b32 v43, v40, v41
    v_alignbit_b32 v41, v41, v41, 4
    v_or_b32 v234, v40, v41
    v_pk_sub_u16 v42, v116, s85
    v_pk_min_u16 v44, v44, v42
    v_pk_sub_u16 v42, v117, s85
    v_pk_min_u16 v44, v44, v42
    v_pk_sub_u16 v42, v118, s85
    v_pk_min_u16 v44, v44, v42
    v_pk_sub_u16 v42, v119, s85
    v_pk_min_u16 v44, v44, v42
    v_pk_sub_u16 v40, v116, s75 clamp
    v_pk_sub_u16 v41, v117, s75 clamp
    v_perm_b32 v235, v41, v40, s70
    v_perm_b32 v40, v41, v40, s71
    v_pk_sub_u16 v41, v118, s75 clamp
    v_pk_sub_u16 v42, v119, s75 clamp
    v_perm_b32 v236, v42, v41, s70
    v_perm_b32 v41, v42, v41, s71
    v_or3_b32 v43, v43, v40, v41
    v_alignbit_b32 v41, v41, v41, 4
    v_or_b32 v237, v40, v41
    v_pk_sub_u16 v42, v120, s85
    v_pk_min_u16 v44, v44, v42
    v_pk_sub_u16 v42, v121, s85
    v_pk_min_u16 v44, v44, v42
    v_pk_sub_u16 v42, v122, s85
    v_pk_min_u16 v44, v44, v42
    v_pk_sub_u16 v42, v123, s85
    v_pk_min_u16 v44, v44, v42
    v_pk_sub_u16 v40, v120, s75 clamp
    v_pk_sub_u16 v41, v121, s75 clamp
    v_perm_b32 v238, v41, v40, s70
    v_perm_b32 v40, v41, v40, s71
    v_pk_sub_u16 v41, v122, s75 clamp
    v_pk_sub_u16 v42, v123, s75 clamp
    v_perm_b32 v239, v42, v41, s70
    v_perm_b32 v41, v42, v41, s71
    v_or3_b32 v43, v43, v40, v41
    v_alignbit_b32 v41, v41, v41, 4
    v_or_b32 v240, v40, v41
    v_pk_sub_u16 v42, v124, s85
    v_pk_min_u16 v44, v44, v42
    v_pk_sub_u16 v42, v125, s85
    v_pk_min_u16 v44, v44, v42
    v_pk_sub_u16 v42, v126, s85
    v_pk_min_u16 v44, v44, v42
    v_pk_sub_u16 v42, v127, s85
    v_pk_min_u16 v44, v44, v42
    v_pk_sub_u16 v40, v124, s75 clamp
    v_pk_sub_u16 v41, v125, s75 clamp
    v_perm_b32 v241, v41, v40, s70
    v_perm_b32 v40, v41, v40, s71
    v_pk_sub_u16 v41, v126, s75 clamp
    v_pk_sub_u16 v42, v127, s75 clamp
    v_perm_b32 v242, v42, v41, s70
    v_perm_b32 v41, v42, v41, s71
    v_or3_b32 v43, v43, v40, v41
    v_alignbit_b32 v41, v41, v41, 4
    v_or_b32 v243, v40, v41
    v_pk_sub_u16 v42, v128, s85
    v_pk_min_u16 v44, v44, v42
    v_pk_sub_u16 v42, v129, s85
    v_pk_min_u16 v44, v44, v42
    v_pk_sub_u16 v42, v130, s85
    v_pk_min_u16 v44, v44, v42
    v_pk_sub_u16 v42, v131, s85
    v_pk_min_u16 v44, v44, v42
    v_pk_sub_u16 v40, v128, s75 clamp
    v_pk_sub_u16 v41, v129, s75 clamp
    v_perm_b32 v244, v41, v40, s70
    v_perm_b32 v40, v41, v40, s71
    v_pk_sub_u16 v41, v130, s75 clamp
    v_pk_sub_u16 v42, v131, s75 clamp
    v_perm_b32 v245, v42, v41, s70
    v_perm_b32 v41, v42, v41, s71
    v_or3_b32 v43, v43, v40, v41
    v_alignbit_b32 v41, v41, v41, 4
    v_or_b32 v246, v40, v41
    v_pk_sub_u16 v42, v132, s85
    v_pk_min_u16 v44, v44, v42
    v_pk_sub_u16 v42, v133, s85
    v_pk_min_u16 v44, v44, v42
    v_pk_sub_u16 v42, v134, s85
    v_pk_min_u16 v44, v44, v42
    v_pk_sub_u16 v42, v135, s85
    v_pk_min_u16 v44, v44, v42
    v_pk_sub_u16 v40, v132, s75 clamp
    v_pk_sub_u16 v41, v133, s75 clamp
    v_perm_b32 v247, v41, v40, s70
    v_perm_b32 v40, v41, v40, s71
    v_pk_sub_u16 v41, v134, s75 clamp
    v_pk_sub_u16 v42, v135, s75 clamp
    v_perm_b32 v248, v42, v41, s70
    v_perm_b32 v41, v42, v41, s71
    v_or3_b32 v43, v43, v40, v41
    v_alignbit_b32 v41, v41, v41, 4
    v_or_b32 v249, v40, v41
    v_pk_sub_u16 v42, v136, s85
    v_pk_min_u16 v44, v44, v42
    v_pk_sub_u16 v42, v137, s85
    v_pk_min_u16 v44, v44, v42
    v_pk_sub_u16 v42, v138, s85
    v_pk_min_u16 v44, v44, v42
    v_pk_sub_u16 v42, v139, s85
    v_pk_min_u16 v44, v44, v42
    v_pk_sub_u16 v40, v136, s75 clamp
    v_pk_sub_u16 v41, v137, s75 clamp
    v_perm_b32 v250, v41, v40, s70
    v_perm_b32 v40, v41, v40, s71
    v_pk_sub_u16 v41, v138, s75 clamp
    v_pk_sub_u16 v42, v139, s75 clamp
    v_perm_b32 v251, v42, v41, s70
    v_perm_b32 v41, v42, v41, s71
    v_or3_b32 v43, v43, v40, v41
    v_alignbit_b32 v41, v41, v41, 4
    v_or_b32 v252, v40, v41
    v_pk_sub_u16 v42, v140, s85
    v_pk_min_u16 v44, v44, v42
    v_pk_sub_u16 v42, v141, s85
    v_pk_min_u16 v44, v44, v42
    v_pk_sub_u16 v42, v142, s85
    v_pk_min_u16 v44, v44, v42
    v_pk_sub_u16 v42, v143, s85
    v_pk_min_u16 v44, v44, v42
    v_pk_sub_u16 v40, v140, s75 clamp
    v_pk_sub_u16 v41, v141, s75 clamp
    v_perm_b32 v253, v41, v40, s70
    v_perm_b32 v40, v41, v40, s71
    v_pk_sub_u16 v41, v142, s75 clamp
    v_pk_sub_u16 v42, v143, s75 clamp
    v_perm_b32 v254, v42, v41, s70
    v_perm_b32 v41, v42, v41, s71
    v_or3_b32 v43, v43, v40, v41
    v_alignbit_b32 v41, v41, v41, 4
    v_or_b32 v255, v40, v41
    v_pk_sub_u16 v44, s75, v44 clamp
    v_and_b32 v43, 0x78787878, v43
    v_or_b32 v43, v43, v44
    v_cmp_ne_u32 vcc, 0, v43
    s_cbranch_vccnz L_xc_126
L_xcb_127:
    s_add_u32 s53, s99, 0x1a0000
    s_and_b32 s53, s53, 0x1fffff
    buffer_load_dwordx4 v[112:115], v2, s[8:11], s53 offen offset:0
    buffer_load_dwordx4 v[116:119], v2, s[8:11], s53 offen offset:1024
    buffer_load_dwordx4 v[120:123], v2, s[8:11], s53 offen offset:2048
    buffer_load_dwordx4 v[124:127], v2, s[8:11], s53 offen offset:3072
    s_add_u32 s53, s53, 0x1000
    buffer_load_dwordx4 v[128:131], v2, s[8:11], s53 offen offset:0
    buffer_load_dwordx4 v[132:135], v2, s[8:11], s53 offen offset:1024
    buffer_load_dwordx4 v[136:139], v2, s[8:11], s53 offen offset:2048
    buffer_load_dwordx4 v[140:143], v2, s[8:11], s53 offen offset:3072
    s_branch L_kj11
L_kd11:
    v_and_b32 v29, s81, v234
    v_alignbit_b32 v31, v234, v234, 28
    v_and_b32 v31, s81, v31
    v_perm_b32 v28, v29, v232, s70
    v_perm_b32 v29, v29, v232, s71
    v_pk_min_u16 v8, v28, s85
    v_pk_mad_u16 v28, v8, s75, v28
    v_pk_min_u16 v8, v29, s85
    v_pk_mad_u16 v29, v8, s75, v29
    v_perm_b32 v30, v31, v233, s70
    v_perm_b32 v31, v31, v233, s71
    v_pk_min_u16 v8, v30, s85
    v_pk_mad_u16 v30, v8, s75, v30
    v_pk_min_u16 v8, v31, s85
    v_pk_mad_u16 v31, v8, s75, v31
    s_bitcmp1_b64 s[92:93], 16
    s_cbranch_scc1 L_xp_129
L_xpb_130:
    v_mfma_f32_16x16x32_bf16 v[32:35], v[28:31], v[12:15], 0
    v_and_b32 v29, s81, v237
    v_alignbit_b32 v31, v237, v237, 28
    v_and_b32 v31, s81, v31
    v_perm_b32 v28, v29, v235, s70
    v_perm_b32 v29, v29, v235, s71
    v_pk_min_u16 v8, v28, s85
    v_pk_mad_u16 v28, v8, s75, v28
    v_pk_min_u16 v8, v29, s85
    v_pk_mad_u16 v29, v8, s75, v29
    v_perm_b32 v30, v31, v236, s70
    v_perm_b32 v31, v31, v236, s71
    v_pk_min_u16 v8, v30, s85
    v_pk_mad_u16 v30, v8, s75, v30
    v_pk_min_u16 v8, v31, s85
    v_pk_mad_u16 v31, v8, s75, v31
    s_bitcmp1_b64 s[92:93], 17
    s_cbranch_scc1 L_xp_131
L_xpb_132:
    v_mfma_f32_16x16x32_bf16 v[36:39], v[28:31], v[12:15], 0
    v_and_b32 v29, s81, v240
    v_alignbit_b32 v31, v240, v240, 28
    v_and_b32 v31, s81, v31
    v_perm_b32 v28, v29, v238, s70
    v_perm_b32 v29, v29, v238, s71
    v_pk_min_u16 v8, v28, s85
    v_pk_mad_u16 v28, v8, s75, v28
    v_pk_min_u16 v8, v29, s85
    v_pk_mad_u16 v29, v8, s75, v29
    v_perm_b32 v30, v31, v239, s70
    v_perm_b32 v31, v31, v239, s71
    v_pk_min_u16 v8, v30, s85
    v_pk_mad_u16 v30, v8, s75, v30
    v_pk_min_u16 v8, v31, s85
    v_pk_mad_u16 v31, v8, s75, v31
    s_bitcmp1_b64 s[92:93], 18
    s_cbranch_scc1 L_xp_133
L_xpb_134:
    v_mfma_f32_16x16x32_bf16 v[40:43], v[28:31], v[12:15], 0
    v_and_b32 v29, s81, v243
    v_alignbit_b32 v31, v243, v243, 28
    v_and_b32 v31, s81, v31
    v_perm_b32 v28, v29, v241, s70
    v_perm_b32 v29, v29, v241, s71
    v_pk_min_u16 v8, v28, s85
    v_pk_mad_u16 v28, v8, s75, v28
    v_pk_min_u16 v8, v29, s85
    v_pk_mad_u16 v29, v8, s75, v29
    v_perm_b32 v30, v31, v242, s70
    v_perm_b32 v31, v31, v242, s71
    v_pk_min_u16 v8, v30, s85
    v_pk_mad_u16 v30, v8, s75, v30
    v_pk_min_u16 v8, v31, s85
    v_pk_mad_u16 v31, v8, s75, v31
    s_bitcmp1_b64 s[92:93], 19
    s_cbranch_scc1 L_xp_135
L_xpb_136:
    v_mfma_f32_16x16x32_bf16 v[44:47], v[28:31], v[12:15], 0
    v_add_f32_dpp v4, v32, v35 row_ror:12 row_mask:0xf bank_mask:0xf
    v_add_f32_dpp v5, v36, v39 row_ror:12 row_mask:0xf bank_mask:0xf
    v_add_f32_dpp v6, v40, v43 row_ror:12 row_mask:0xf bank_mask:0xf
    v_add_f32_dpp v4, v33, v4 row_ror:8 row_mask:0xf bank_mask:0xf
    v_add_f32_dpp v5, v37, v5 row_ror:8 row_mask:0xf bank_mask:0xf
    v_add_f32_dpp v6, v41, v6 row_ror:8 row_mask:0xf bank_mask:0xf
    v_add_f32_dpp v16, v34, v4 row_ror:4 row_mask:0xf bank_mask:0x8
    v_add_f32_dpp v17, v38, v5 row_ror:4 row_mask:0xf bank_mask:0x8
    v_add_f32_dpp v18, v42, v6 row_ror:4 row_mask:0xf bank_mask:0x8
    v_and_b32 v29, s81, v246
    v_alignbit_b32 v31, v246, v246, 28
    v_and_b32 v31, s81, v31
    v_perm_b32 v28, v29, v244, s70
    v_perm_b32 v29, v29, v244, s71
    v_pk_min_u16 v8, v28, s85
    v_pk_mad_u16 v28, v8, s75, v28
    v_pk_min_u16 v8, v29, s85
    v_pk_mad_u16 v29, v8, s75, v29
    v_perm_b32 v30, v31, v245, s70
    v_perm_b32 v31, v31, v245, s71
    v_pk_min_u16 v8, v30, s85
    v_pk_mad_u16 v30, v8, s75, v30
    v_pk_min_u16 v8, v31, s85
    v_pk_mad_u16 v31, v8, s75, v31
    s_bitcmp1_b64 s[92:93], 20
    s_cbranch_scc1 L_xp_137
L_xpb_138:
    v_mfma_f32_16x16x32_bf16 v[32:35], v[28:31], v[12:15], 0
    v_and_b32 v29, s81, v249
    v_alignbit_b32 v31, v249, v249, 28
    v_and_b32 v31, s81, v31
    v_perm_b32 v28, v29, v247, s70
    v_perm_b32 v29, v29, v247, s71
    v_pk_min_u16 v8, v28, s85
    v_pk_mad_u16 v28, v8, s75, v28
    v_pk_min_u16 v8, v29, s85
    v_pk_mad_u16 v29, v8, s75, v29
    v_perm_b32 v30, v31, v248, s70
    v_perm_b32 v31, v31, v248, s71
    v_pk_min_u16 v8, v30, s85
    v_pk_mad_u16 v30, v8, s75, v30
    v_pk_min_u16 v8, v31, s85
    v_pk_mad_u16 v31, v8, s75, v31
    s_bitcmp1_b64 s[92:93], 21
    s_cbranch_scc1 L_xp_139
L_xpb_140:
    v_mfma_f32_16x16x32_bf16 v[36:39], v[28:31], v[12:15], 0
    v_and_b32 v29, s81, v252
    v_alignbit_b32 v31, v252, v252, 28
    v_and_b32 v31, s81, v31
    v_perm_b32 v28, v29, v250, s70
    v_perm_b32 v29, v29, v250, s71
    v_pk_min_u16 v8, v28, s85
    v_pk_mad_u16 v28, v8, s75, v28
    v_pk_min_u16 v8, v29, s85
    v_pk_mad_u16 v29, v8, s75, v29
    v_perm_b32 v30, v31, v251, s70
    v_perm_b32 v31, v31, v251, s71
    v_pk_min_u16 v8, v30, s85
    v_pk_mad_u16 v30, v8, s75, v30
    v_pk_min_u16 v8, v31, s85
    v_pk_mad_u16 v31, v8, s75, v31
    s_bitcmp1_b64 s[92:93], 22
    s_cbranch_scc1 L_xp_141
L_xpb_142:
    v_mfma_f32_16x16x32_bf16 v[40:43], v[28:31], v[12:15], 0
    v_add_f32_dpp v4, v44, v47 row_ror:12 row_mask:0xf bank_mask:0xf
    v_add_f32_dpp v5, v32, v35 row_ror:12 row_mask:0xf bank_mask:0xf
    v_add_f32_dpp v6, v36, v39 row_ror:12 row_mask:0xf bank_mask:0xf
    v_add_f32_dpp v4, v45, v4 row_ror:8 row_mask:0xf bank_mask:0xf
    v_add_f32_dpp v5, v33, v5 row_ror:8 row_mask:0xf bank_mask:0xf
    v_add_f32_dpp v6, v37, v6 row_ror:8 row_mask:0xf bank_mask:0xf
    v_add_f32_dpp v19, v46, v4 row_ror:4 row_mask:0xf bank_mask:0x8
    v_add_f32_dpp v20, v34, v5 row_ror:4 row_mask:0xf bank_mask:0x8
    v_add_f32_dpp v21, v38, v6 row_ror:4 row_mask:0xf bank_mask:0x8
    v_and_b32 v29, s81, v255
    v_alignbit_b32 v31, v255, v255, 28
    v_and_b32 v31, s81, v31
    v_perm_b32 v28, v29, v253, s70
    v_perm_b32 v29, v29, v253, s71
    v_pk_min_u16 v8, v28, s85
    v_pk_mad_u16 v28, v8, s75, v28
    v_pk_min_u16 v8, v29, s85
    v_pk_mad_u16 v29, v8, s75, v29
    v_perm_b32 v30, v31, v254, s70
    v_perm_b32 v31, v31, v254, s71
    v_pk_min_u16 v8, v30, s85
    v_pk_mad_u16 v30, v8, s75, v30
    v_pk_min_u16 v8, v31, s85
    v_pk_mad_u16 v31, v8, s75, v31
    s_bitcmp1_b64 s[92:93], 23
    s_cbranch_scc1 L_xp_143
L_xpb_144:
    v_mfma_f32_16x16x32_bf16 v[44:47], v[28:31], v[12:15], 0
    v_add_f32_dpp v4, v40, v43 row_ror:12 row_mask:0xf bank_mask:0xf
    s_nop 6
    v_add_f32_dpp v5, v44, v47 row_ror:12 row_mask:0xf bank_mask:0xf
    v_add_f32_dpp v4, v41, v4 row_ror:8 row_mask:0xf bank_mask:0xf
    s_nop 0
    v_add_f32_dpp v5, v45, v5 row_ror:8 row_mask:0xf bank_mask:0xf
    v_add_f32_dpp v22, v42, v4 row_ror:4 row_mask:0xf bank_mask:0x8
    s_nop 0
    v_add_f32_dpp v23, v46, v5 row_ror:4 row_mask:0xf bank_mask:0x8
L_kj11:
    ds_read_b128 v[44:47], v9 offset:28672
    ds_read_b128 v[40:43], v9 offset:24576
    ds_read_b128 v[4:7], v9 offset:25600
    v_mov_b32_dpp v28, v24 row_shl:12 row_mask:0xf bank_mask:0xf
    v_mov_b32_dpp v29, v25 row_shl:12 row_mask:0xf bank_mask:0xf
    v_mov_b32_dpp v30, v26 row_shl:12 row_mask:0xf bank_mask:0xf
    v_mov_b32_dpp v31, v27 row_shl:12 row_mask:0xf bank_mask:0xf
    s_waitcnt lgkmcnt(2)
    v_and_b32 v36, s81, v44
    v_alignbit_b32 v37, v44, v44, 28
    v_and_b32 v37, s81, v37
    v_and_b32 v38, s81, v45
    v_alignbit_b32 v39, v45, v45, 28
    v_and_b32 v39, s81, v39
    s_waitcnt lgkmcnt(1)
    v_perm_b32 v32, v36, v40, s72
    v_perm_b32 v36, v36, v40, s73
    v_pk_min_u16 v8, v32, s85
    v_pk_mad_u16 v32, v8, s74, v32
    v_pk_min_u16 v8, v36, s85
    v_pk_mad_u16 v36, v8, s74, v36
    v_perm_b32 v33, v37, v41, s72
    v_perm_b32 v37, v37, v41, s73
    v_pk_min_u16 v8, v33, s85
    v_pk_mad_u16 v33, v8, s74, v33
    v_pk_min_u16 v8, v37, s85
    v_pk_mad_u16 v37, v8, s74, v37
    v_perm_b32 v34, v38, v42, s72
    v_perm_b32 v38, v38, v42, s73
    v_pk_min_u16 v8, v34, s85
    v_pk_mad_u16 v34, v8, s74, v34
    v_pk_min_u16 v8, v38, s85
    v_pk_mad_u16 v38, v8, s74, v38
    v_perm_b32 v35, v39, v43, s72
    v_perm_b32 v39, v39, v43, s73
    v_pk_min_u16 v8, v35, s85
    v_pk_mad_u16 v35, v8, s74, v35
    v_pk_min_u16 v8, v39, s85
    v_pk_mad_u16 v39, v8, s74, v39
    ds_read_b128 v[40:43], v9 offset:26624
    s_bitcmp1_b64 s[90:91], 28
    s_cbranch_scc1 L_xp_145
L_xpb_146:
    v_mfma_f32_16x16x32_bf16 v[48:51], v[28:31], v[32:35], v[48:51]
    v_mfma_f32_16x16x32_bf16 v[52:55], v[28:31], v[36:39], v[52:55]
    s_waitcnt lgkmcnt(1)
    v_and_b32 v36, s81, v46
    v_alignbit_b32 v37, v46, v46, 28
    v_and_b32 v37, s81, v37
    v_and_b32 v38, s81, v47
    v_alignbit_b32 v39, v47, v47, 28
    v_and_b32 v39, s81, v39
    ds_read_b128 v[44:47], v9 offset:29696
    v_perm_b32 v32, v36, v4, s72
    v_perm_b32 v36, v36, v4, s73
    v_pk_min_u16 v8, v32, s85
    v_pk_mad_u16 v32, v8, s74, v32
    v_pk_min_u16 v8, v36, s85
    v_pk_mad_u16 v36, v8, s74, v36
    v_perm_b32 v33, v37, v5, s72
    v_perm_b32 v37, v37, v5, s73
    v_pk_min_u16 v8, v33, s85
    v_pk_mad_u16 v33, v8, s74, v33
    v_pk_min_u16 v8, v37, s85
    v_pk_mad_u16 v37, v8, s74, v37
    v_perm_b32 v34, v38, v6, s72
    v_perm_b32 v38, v38, v6, s73
    v_pk_min_u16 v8, v34, s85
    v_pk_mad_u16 v34, v8, s74, v34
    v_pk_min_u16 v8, v38, s85
    v_pk_mad_u16 v38, v8, s74, v38
    v_perm_b32 v35, v39, v7, s72
    v_perm_b32 v39, v39, v7, s73
    v_pk_min_u16 v8, v35, s85
    v_pk_mad_u16 v35, v8, s74, v35
    v_pk_min_u16 v8, v39, s85
    v_pk_mad_u16 v39, v8, s74, v39
    ds_read_b128 v[4:7], v9 offset:27648
    s_bitcmp1_b64 s[90:91], 29
    s_cbranch_scc1 L_xp_147
L_xpb_148:
    v_mfma_f32_16x16x32_bf16 v[56:59], v[28:31], v[32:35], v[56:59]
    v_mfma_f32_16x16x32_bf16 v[60:63], v[28:31], v[36:39], v[60:63]
    s_waitcnt lgkmcnt(1)
    v_and_b32 v36, s81, v44
    v_alignbit_b32 v37, v44, v44, 28
    v_and_b32 v37, s81, v37
    v_and_b32 v38, s81, v45
    v_alignbit_b32 v39, v45, v45, 28
    v_and_b32 v39, s81, v39
    v_perm_b32 v32, v36, v40, s72
    v_perm_b32 v36, v36, v40, s73
    v_pk_min_u16 v8, v32, s85
    v_pk_mad_u16 v32, v8, s74, v32
    v_pk_min_u16 v8, v36, s85
    v_pk_mad_u16 v36, v8, s74, v36
    v_perm_b32 v33, v37, v41, s72
    v_perm_b32 v37, v37, v41, s73
    v_pk_min_u16 v8, v33, s85
    v_pk_mad_u16 v33, v8, s74, v33
    v_pk_min_u16 v8, v37, s85
    v_pk_mad_u16 v37, v8, s74, v37
    v_perm_b32 v34, v38, v42, s72
    v_perm_b32 v38, v38, v42, s73
    v_pk_min_u16 v8, v34, s85
    v_pk_mad_u16 v34, v8, s74, v34
    v_pk_min_u16 v8, v38, s85
    v_pk_mad_u16 v38, v8, s74, v38
    v_perm_b32 v35, v39, v43, s72
    v_perm_b32 v39, v39, v43, s73
    v_pk_min_u16 v8, v35, s85
    v_pk_mad_u16 v35, v8, s74, v35
    v_pk_min_u16 v8, v39, s85
    v_pk_mad_u16 v39, v8, s74, v39
    s_bitcmp1_b64 s[90:91], 30
    s_cbranch_scc1 L_xp_149
L_xpb_150:
    v_mfma_f32_16x16x32_bf16 v[64:67], v[28:31], v[32:35], v[64:67]
    v_mfma_f32_16x16x32_bf16 v[68:71], v[28:31], v[36:39], v[68:71]
    s_waitcnt lgkmcnt(0)
    v_and_b32 v36, s81, v46
    v_alignbit_b32 v37, v46, v46, 28
    v_and_b32 v37, s81, v37
    v_and_b32 v38, s81, v47
    v_alignbit_b32 v39, v47, v47, 28
    v_and_b32 v39, s81, v39
    v_perm_b32 v32, v36, v4, s72
    v_perm_b32 v36, v36, v4, s73
    v_pk_min_u16 v8, v32, s85
    v_pk_mad_u16 v32, v8, s74, v32
    v_pk_min_u16 v8, v36, s85
    v_pk_mad_u16 v36, v8, s74, v36
    v_perm_b32 v33, v37, v5, s72
    v_perm_b32 v37, v37, v5, s73
    v_pk_min_u16 v8, v33, s85
    v_pk_mad_u16 v33, v8, s74, v33
    v_pk_min_u16 v8, v37, s85
    v_pk_mad_u16 v37, v8, s74, v37
    v_perm_b32 v34, v38, v6, s72
    v_perm_b32 v38, v38, v6, s73
    v_pk_min_u16 v8, v34, s85
    v_pk_mad_u16 v34, v8, s74, v34
    v_pk_min_u16 v8, v38, s85
    v_pk_mad_u16 v38, v8, s74, v38
    v_perm_b32 v35, v39, v7, s72
    v_perm_b32 v39, v39, v7, s73
    v_pk_min_u16 v8, v35, s85
    v_pk_mad_u16 v35, v8, s74, v35
    v_pk_min_u16 v8, v39, s85
    v_pk_mad_u16 v39, v8, s74, v39
    s_bitcmp1_b64 s[90:91], 31
    s_cbranch_scc1 L_xp_151
L_xpb_152:
    v_mfma_f32_16x16x32_bf16 v[72:75], v[28:31], v[32:35], v[72:75]
    v_mfma_f32_16x16x32_bf16 v[76:79], v[28:31], v[36:39], v[76:79]
    v_max3_f32 v4, v16, v17, v18
    v_max3_f32 v5, v19, v20, v21
    v_max3_f32 v4, v4, v22, v23
    v_max3_f32 v4, v4, v5, v10
    s_nop 1
    v_max_f32_dpp v4, v4, v4 row_ror:4 row_mask:0xf bank_mask:0xf
    s_nop 1
    v_max_f32_dpp v4, v4, v4 row_ror:8 row_mask:0xf bank_mask:0xf
    v_mov_b32 v5, v4
    s_nop 1
    v_permlane16_swap_b32 v4, v5
    v_max_f32 v4, v4, v5
    v_mov_b32 v5, v4
    s_nop 1
    v_permlane32_swap_b32 v4, v5
    v_max_f32 v4, v4, v5
    v_sub_f32 v31, v10, v4
    v_mul_f32 v31, s60, v31
    v_exp_f32 v31, v31
    v_mul_f32 v5, s60, v4
    v_mov_b32 v10, v4
    v_fma_f32 v16, v16, s60, -v5
    v_fma_f32 v17, v17, s60, -v5
    v_fma_f32 v18, v18, s60, -v5
    v_fma_f32 v19, v19, s60, -v5
    v_fma_f32 v20, v20, s60, -v5
    v_fma_f32 v21, v21, s60, -v5
    v_fma_f32 v22, v22, s60, -v5
    v_fma_f32 v23, v23, s60, -v5
    v_readlane_b32 s62, v31, 0
    v_readlane_b32 s63, v31, 1
    v_readlane_b32 s64, v31, 2
    v_readlane_b32 s65, v31, 3
    v_exp_f32 v16, v16
    v_exp_f32 v17, v17
    v_exp_f32 v18, v18
    v_exp_f32 v19, v19
    v_exp_f32 v20, v20
    v_exp_f32 v21, v21
    v_exp_f32 v22, v22
    v_exp_f32 v23, v23
    v_cvt_pk_bf16_f32 v24, v16, v17
    v_cvt_pk_bf16_f32 v25, v18, v19
    v_cvt_pk_bf16_f32 v26, v20, v21
    v_cvt_pk_bf16_f32 v27, v22, v23
    v_mul_f32 v11, v11, v31
    v_pk_mul_f32 v[48:49], v[48:49], s[62:63]
    v_pk_mul_f32 v[50:51], v[50:51], s[64:65]
    v_pk_mul_f32 v[52:53], v[52:53], s[62:63]
    v_pk_mul_f32 v[54:55], v[54:55], s[64:65]
    v_pk_mul_f32 v[56:57], v[56:57], s[62:63]
    v_pk_mul_f32 v[58:59], v[58:59], s[64:65]
    v_pk_mul_f32 v[60:61], v[60:61], s[62:63]
    v_pk_mul_f32 v[62:63], v[62:63], s[64:65]
    v_pk_mul_f32 v[64:65], v[64:65], s[62:63]
    v_pk_mul_f32 v[66:67], v[66:67], s[64:65]
    v_pk_mul_f32 v[68:69], v[68:69], s[62:63]
    v_pk_mul_f32 v[70:71], v[70:71], s[64:65]
    v_pk_mul_f32 v[72:73], v[72:73], s[62:63]
    v_pk_mul_f32 v[74:75], v[74:75], s[64:65]
    v_pk_mul_f32 v[76:77], v[76:77], s[62:63]
    v_pk_mul_f32 v[78:79], v[78:79], s[64:65]
    v_add_f32 v11, v11, v16
    v_add_f32 v11, v11, v17
    v_add_f32 v11, v11, v18
    v_add_f32 v11, v11, v19
    v_add_f32 v11, v11, v20
    v_add_f32 v11, v11, v21
    v_add_f32 v11, v11, v22
    v_add_f32 v11, v11, v23
    v_mov_b32 v5, 0xff800000
    s_nop 1
    v_mov_b32_dpp v16, v5 quad_perm:[0,1,2,3] row_mask:0xf bank_mask:0x8
    v_mov_b32_dpp v17, v5 quad_perm:[0,1,2,3] row_mask:0xf bank_mask:0x8
    v_mov_b32_dpp v18, v5 quad_perm:[0,1,2,3] row_mask:0xf bank_mask:0x8
    v_mov_b32_dpp v19, v5 quad_perm:[0,1,2,3] row_mask:0xf bank_mask:0x8
    v_mov_b32_dpp v20, v5 quad_perm:[0,1,2,3] row_mask:0xf bank_mask:0x8
    v_mov_b32_dpp v21, v5 quad_perm:[0,1,2,3] row_mask:0xf bank_mask:0x8
    v_mov_b32_dpp v22, v5 quad_perm:[0,1,2,3] row_mask:0xf bank_mask:0x8
    v_mov_b32_dpp v23, v5 quad_perm:[0,1,2,3] row_mask:0xf bank_mask:0x8
    s_waitcnt vmcnt(8)
    s_cmp_eq_u32 s54, 0
    s_cbranch_scc1 L_kw12
    s_waitcnt vmcnt(0)
L_kw12:
    v_mfma_f32_16x16x32_bf16 v[32:35], v[80:83], v[12:15], 0
    v_mfma_f32_16x16x32_bf16 v[36:39], v[84:87], v[12:15], 0
    v_mfma_f32_16x16x32_bf16 v[40:43], v[88:91], v[12:15], 0
    v_mfma_f32_16x16x32_bf16 v[44:47], v[92:95], v[12:15], 0
    s_nop 4
    v_add_f32_dpp v4, v33, v32 row_ror:12 row_mask:0xf bank_mask:0xf
    v_add_f32_dpp v5, v37, v36 row_ror:12 row_mask:0xf bank_mask:0xf
    v_add_f32_dpp v6, v41, v40 row_ror:12 row_mask:0xf bank_mask:0xf
    v_add_f32_dpp v7, v45, v44 row_ror:12 row_mask:0xf bank_mask:0xf
    v_add_f32_dpp v4, v34, v4 row_ror:8 row_mask:0xf bank_mask:0xf
    v_add_f32_dpp v5, v38, v5 row_ror:8 row_mask:0xf bank_mask:0xf
    v_add_f32_dpp v6, v42, v6 row_ror:8 row_mask:0xf bank_mask:0xf
    v_add_f32_dpp v7, v46, v7 row_ror:8 row_mask:0xf bank_mask:0xf
    v_add_f32_dpp v16, v35, v4 row_ror:4 row_mask:0xf bank_mask:0x1
    v_add_f32_dpp v17, v39, v5 row_ror:4 row_mask:0xf bank_mask:0x1
    v_add_f32_dpp v18, v43, v6 row_ror:4 row_mask:0xf bank_mask:0x1
    v_add_f32_dpp v19, v47, v7 row_ror:4 row_mask:0xf bank_mask:0x1
    v_mfma_f32_16x16x32_bf16 v[32:35], v[96:99], v[12:15], 0
    v_mfma_f32_16x16x32_bf16 v[36:39], v[100:103], v[12:15], 0
    v_mfma_f32_16x16x32_bf16 v[40:43], v[104:107], v[12:15], 0
    v_mfma_f32_16x16x32_bf16 v[44:47], v[108:111], v[12:15], 0
    s_add_u32 s53, s99, 0x1c0000
    s_and_b32 s53, s53, 0x1fffff
    buffer_load_dwordx4 v[80:83], v2, s[8:11], s53 offen offset:0
    buffer_load_dwordx4 v[84:87], v2, s[8:11], s53 offen offset:1024
    buffer_load_dwordx4 v[88:91], v2, s[8:11], s53 offen offset:2048
    buffer_load_dwordx4 v[92:95], v2, s[8:11], s53 offen offset:3072
    s_add_u32 s53, s53, 0x1000
    buffer_load_dwordx4 v[96:99], v2, s[8:11], s53 offen offset:0
    buffer_load_dwordx4 v[100:103], v2, s[8:11], s53 offen offset:1024
    buffer_load_dwordx4 v[104:107], v2, s[8:11], s53 offen offset:2048
    buffer_load_dwordx4 v[108:111], v2, s[8:11], s53 offen offset:3072
    v_add_f32_dpp v4, v33, v32 row_ror:12 row_mask:0xf bank_mask:0xf
    v_add_f32_dpp v5, v37, v36 row_ror:12 row_mask:0xf bank_mask:0xf
    v_add_f32_dpp v6, v41, v40 row_ror:12 row_mask:0xf bank_mask:0xf
    v_add_f32_dpp v7, v45, v44 row_ror:12 row_mask:0xf bank_mask:0xf
    v_add_f32_dpp v4, v34, v4 row_ror:8 row_mask:0xf bank_mask:0xf
    v_add_f32_dpp v5, v38, v5 row_ror:8 row_mask:0xf bank_mask:0xf
    v_add_f32_dpp v6, v42, v6 row_ror:8 row_mask:0xf bank_mask:0xf
    v_add_f32_dpp v7, v46, v7 row_ror:8 row_mask:0xf bank_mask:0xf
    v_add_f32_dpp v20, v35, v4 row_ror:4 row_mask:0xf bank_mask:0x1
    v_add_f32_dpp v21, v39, v5 row_ror:4 row_mask:0xf bank_mask:0x1
    v_add_f32_dpp v22, v43, v6 row_ror:4 row_mask:0xf bank_mask:0x1
    v_add_f32_dpp v23, v47, v7 row_ror:4 row_mask:0xf bank_mask:0x1
    ds_read_b128 v[44:47], v9 offset:34816
    ds_read_b128 v[40:43], v9 offset:30720
    ds_read_b128 v[4:7], v9 offset:31744
    s_waitcnt lgkmcnt(2)
    v_and_b32 v36, s81, v44
    v_alignbit_b32 v37, v44, v44, 28
    v_and_b32 v37, s81, v37
    v_and_b32 v38, s81, v45
    v_alignbit_b32 v39, v45, v45, 28
    v_and_b32 v39, s81, v39
    s_waitcnt lgkmcnt(1)
    v_perm_b32 v32, v36, v40, s72
    v_perm_b32 v36, v36, v40, s73
    v_pk_min_u16 v8, v32, s85
    v_pk_mad_u16 v32, v8, s74, v32
    v_pk_min_u16 v8, v36, s85
    v_pk_mad_u16 v36, v8, s74, v36
    v_perm_b32 v33, v37, v41, s72
    v_perm_b32 v37, v37, v41, s73
    v_pk_min_u16 v8, v33, s85
    v_pk_mad_u16 v33, v8, s74, v33
    v_pk_min_u16 v8, v37, s85
    v_pk_mad_u16 v37, v8, s74, v37
    v_perm_b32 v34, v38, v42, s72
    v_perm_b32 v38, v38, v42, s73
    v_pk_min_u16 v8, v34, s85
    v_pk_mad_u16 v34, v8, s74, v34
    v_pk_min_u16 v8, v38, s85
    v_pk_mad_u16 v38, v8, s74, v38
    v_perm_b32 v35, v39, v43, s72
    v_perm_b32 v39, v39, v43, s73
    v_pk_min_u16 v8, v35, s85
    v_pk_mad_u16 v35, v8, s74, v35
    v_pk_min_u16 v8, v39, s85
    v_pk_mad_u16 v39, v8, s74, v39
    ds_read_b128 v[40:43], v9 offset:32768
    s_bitcmp1_b64 s[90:91], 32
    s_cbranch_scc1 L_xp_153
L_xpb_154:
    v_mfma_f32_16x16x32_bf16 v[48:51], v[24:27], v[32:35], v[48:51]
    v_mfma_f32_16x16x32_bf16 v[52:55], v[24:27], v[36:39], v[52:55]
    s_waitcnt lgkmcnt(1)
    v_and_b32 v36, s81, v46
    v_alignbit_b32 v37, v46, v46, 28
    v_and_b32 v37, s81, v37
    v_and_b32 v38, s81, v47
    v_alignbit_b32 v39, v47, v47, 28
    v_and_b32 v39, s81, v39
    ds_read_b128 v[44:47], v9 offset:35840
    v_perm_b32 v32, v36, v4, s72
    v_perm_b32 v36, v36, v4, s73
    v_pk_min_u16 v8, v32, s85
    v_pk_mad_u16 v32, v8, s74, v32
    v_pk_min_u16 v8, v36, s85
    v_pk_mad_u16 v36, v8, s74, v36
    v_perm_b32 v33, v37, v5, s72
    v_perm_b32 v37, v37, v5, s73
    v_pk_min_u16 v8, v33, s85
    v_pk_mad_u16 v33, v8, s74, v33
    v_pk_min_u16 v8, v37, s85
    v_pk_mad_u16 v37, v8, s74, v37
    v_perm_b32 v34, v38, v6, s72
    v_perm_b32 v38, v38, v6, s73
    v_pk_min_u16 v8, v34, s85
    v_pk_mad_u16 v34, v8, s74, v34
    v_pk_min_u16 v8, v38, s85
    v_pk_mad_u16 v38, v8, s74, v38
    v_perm_b32 v35, v39, v7, s72
    v_perm_b32 v39, v39, v7, s73
    v_pk_min_u16 v8, v35, s85
    v_pk_mad_u16 v35, v8, s74, v35
    v_pk_min_u16 v8, v39, s85
    v_pk_mad_u16 v39, v8, s74, v39
    ds_read_b128 v[4:7], v9 offset:33792
    s_bitcmp1_b64 s[90:91], 33
    s_cbranch_scc1 L_xp_155
L_xpb_156:
    v_mfma_f32_16x16x32_bf16 v[56:59], v[24:27], v[32:35], v[56:59]
    v_mfma_f32_16x16x32_bf16 v[60:63], v[24:27], v[36:39], v[60:63]
    s_waitcnt lgkmcnt(1)
    v_and_b32 v36, s81, v44
    v_alignbit_b32 v37, v44, v44, 28
    v_and_b32 v37, s81, v37
    v_and_b32 v38, s81, v45
    v_alignbit_b32 v39, v45, v45, 28
    v_and_b32 v39, s81, v39
    v_perm_b32 v32, v36, v40, s72
    v_perm_b32 v36, v36, v40, s73
    v_pk_min_u16 v8, v32, s85
    v_pk_mad_u16 v32, v8, s74, v32
    v_pk_min_u16 v8, v36, s85
    v_pk_mad_u16 v36, v8, s74, v36
    v_perm_b32 v33, v37, v41, s72
    v_perm_b32 v37, v37, v41, s73
    v_pk_min_u16 v8, v33, s85
    v_pk_mad_u16 v33, v8, s74, v33
    v_pk_min_u16 v8, v37, s85
    v_pk_mad_u16 v37, v8, s74, v37
    v_perm_b32 v34, v38, v42, s72
    v_perm_b32 v38, v38, v42, s73
    v_pk_min_u16 v8, v34, s85
    v_pk_mad_u16 v34, v8, s74, v34
    v_pk_min_u16 v8, v38, s85
    v_pk_mad_u16 v38, v8, s74, v38
    v_perm_b32 v35, v39, v43, s72
    v_perm_b32 v39, v39, v43, s73
    v_pk_min_u16 v8, v35, s85
    v_pk_mad_u16 v35, v8, s74, v35
    v_pk_min_u16 v8, v39, s85
    v_pk_mad_u16 v39, v8, s74, v39
    s_bitcmp1_b64 s[90:91], 34
    s_cbranch_scc1 L_xp_157
L_xpb_158:
    v_mfma_f32_16x16x32_bf16 v[64:67], v[24:27], v[32:35], v[64:67]
    v_mfma_f32_16x16x32_bf16 v[68:71], v[24:27], v[36:39], v[68:71]
    s_waitcnt lgkmcnt(0)
    v_and_b32 v36, s81, v46
    v_alignbit_b32 v37, v46, v46, 28
    v_and_b32 v37, s81, v37
    v_and_b32 v38, s81, v47
    v_alignbit_b32 v39, v47, v47, 28
    v_and_b32 v39, s81, v39
    v_perm_b32 v32, v36, v4, s72
    v_perm_b32 v36, v36, v4, s73
    v_pk_min_u16 v8, v32, s85
    v_pk_mad_u16 v32, v8, s74, v32
    v_pk_min_u16 v8, v36, s85
    v_pk_mad_u16 v36, v8, s74, v36
    v_perm_b32 v33, v37, v5, s72
    v_perm_b32 v37, v37, v5, s73
    v_pk_min_u16 v8, v33, s85
    v_pk_mad_u16 v33, v8, s74, v33
    v_pk_min_u16 v8, v37, s85
    v_pk_mad_u16 v37, v8, s74, v37
    v_perm_b32 v34, v38, v6, s72
    v_perm_b32 v38, v38, v6, s73
    v_pk_min_u16 v8, v34, s85
    v_pk_mad_u16 v34, v8, s74, v34
    v_pk_min_u16 v8, v38, s85
    v_pk_mad_u16 v38, v8, s74, v38
    v_perm_b32 v35, v39, v7, s72
    v_perm_b32 v39, v39, v7, s73
    v_pk_min_u16 v8, v35, s85
    v_pk_mad_u16 v35, v8, s74, v35
    v_pk_min_u16 v8, v39, s85
    v_pk_mad_u16 v39, v8, s74, v39
    s_bitcmp1_b64 s[90:91], 35
    s_cbranch_scc1 L_xp_159
L_xpb_160:
    v_mfma_f32_16x16x32_bf16 v[72:75], v[24:27], v[32:35], v[72:75]
    v_mfma_f32_16x16x32_bf16 v[76:79], v[24:27], v[36:39], v[76:79]
    s_waitcnt vmcnt(8)
    v_mfma_f32_16x16x32_bf16 v[32:35], v[112:115], v[12:15], 0
    v_mfma_f32_16x16x32_bf16 v[36:39], v[116:119], v[12:15], 0
    v_mfma_f32_16x16x32_bf16 v[40:43], v[120:123], v[12:15], 0
    v_mfma_f32_16x16x32_bf16 v[44:47], v[124:127], v[12:15], 0
    s_nop 4
    v_add_f32_dpp v4, v32, v33 row_ror:4 row_mask:0xf bank_mask:0xf
    v_add_f32_dpp v5, v36, v37 row_ror:4 row_mask:0xf bank_mask:0xf
    v_add_f32_dpp v6, v40, v41 row_ror:4 row_mask:0xf bank_mask:0xf
    v_add_f32_dpp v7, v44, v45 row_ror:4 row_mask:0xf bank_mask:0xf
    v_add_f32_dpp v4, v34, v4 row_ror:12 row_mask:0xf bank_mask:0xf
    v_add_f32_dpp v5, v38, v5 row_ror:12 row_mask:0xf bank_mask:0xf
    v_add_f32_dpp v6, v42, v6 row_ror:12 row_mask:0xf bank_mask:0xf
    v_add_f32_dpp v7, v46, v7 row_ror:12 row_mask:0xf bank_mask:0xf
    v_add_f32_dpp v16, v35, v4 row_ror:8 row_mask:0xf bank_mask:0x2
    v_add_f32_dpp v17, v39, v5 row_ror:8 row_mask:0xf bank_mask:0x2
    v_add_f32_dpp v18, v43, v6 row_ror:8 row_mask:0xf bank_mask:0x2
    v_add_f32_dpp v19, v47, v7 row_ror:8 row_mask:0xf bank_mask:0x2
    v_mfma_f32_16x16x32_bf16 v[32:35], v[128:131], v[12:15], 0
    v_mfma_f32_16x16x32_bf16 v[36:39], v[132:135], v[12:15], 0
    v_mfma_f32_16x16x32_bf16 v[40:43], v[136:139], v[12:15], 0
    v_mfma_f32_16x16x32_bf16 v[44:47], v[140:143], v[12:15], 0
    s_add_u32 s53, s99, 0x1e0000
    s_and_b32 s53, s53, 0x1fffff
    buffer_load_dwordx4 v[112:115], v2, s[8:11], s53 offen offset:0
    buffer_load_dwordx4 v[116:119], v2, s[8:11], s53 offen offset:1024
    buffer_load_dwordx4 v[120:123], v2, s[8:11], s53 offen offset:2048
    buffer_load_dwordx4 v[124:127], v2, s[8:11], s53 offen offset:3072
    s_add_u32 s53, s53, 0x1000
    buffer_load_dwordx4 v[128:131], v2, s[8:11], s53 offen offset:0
    buffer_load_dwordx4 v[132:135], v2, s[8:11], s53 offen offset:1024
    buffer_load_dwordx4 v[136:139], v2, s[8:11], s53 offen offset:2048
    buffer_load_dwordx4 v[140:143], v2, s[8:11], s53 offen offset:3072
    v_add_f32_dpp v4, v32, v33 row_ror:4 row_mask:0xf bank_mask:0xf
    v_add_f32_dpp v5, v36, v37 row_ror:4 row_mask:0xf bank_mask:0xf
    v_add_f32_dpp v6, v40, v41 row_ror:4 row_mask:0xf bank_mask:0xf
    v_add_f32_dpp v7, v44, v45 row_ror:4 row_mask:0xf bank_mask:0xf
    v_add_f32_dpp v4, v34, v4 row_ror:12 row_mask:0xf bank_mask:0xf
    v_add_f32_dpp v5, v38, v5 row_ror:12 row_mask:0xf bank_mask:0xf
    v_add_f32_dpp v6, v42, v6 row_ror:12 row_mask:0xf bank_mask:0xf
    v_add_f32_dpp v7, v46, v7 row_ror:12 row_mask:0xf bank_mask:0xf
    v_add_f32_dpp v20, v35, v4 row_ror:8 row_mask:0xf bank_mask:0x2
    v_add_f32_dpp v21, v39, v5 row_ror:8 row_mask:0xf bank_mask:0x2
    v_add_f32_dpp v22, v43, v6 row_ror:8 row_mask:0xf bank_mask:0x2
    v_add_f32_dpp v23, v47, v7 row_ror:8 row_mask:0xf bank_mask:0x2
    v_mov_b32_dpp v28, v24 row_shl:4 row_mask:0xf bank_mask:0xf
    v_mov_b32_dpp v29, v25 row_shl:4 row_mask:0xf bank_mask:0xf
    v_mov_b32_dpp v30, v26 row_shl:4 row_mask:0xf bank_mask:0xf
    v_mov_b32_dpp v31, v27 row_shl:4 row_mask:0xf bank_mask:0xf
    s_nop 1
    v_mfma_f32_16x16x32_bf16 v[48:51], v[28:31], a[60:63], v[48:51]
    v_mfma_f32_16x16x32_bf16 v[52:55], v[28:31], a[56:59], v[52:55]
    v_mfma_f32_16x16x32_bf16 v[56:59], v[28:31], a[52:55], v[56:59]
    v_mfma_f32_16x16x32_bf16 v[60:63], v[28:31], a[48:51], v[60:63]
    v_mfma_f32_16x16x32_bf16 v[64:67], v[28:31], a[44:47], v[64:67]
    v_mfma_f32_16x16x32_bf16 v[68:71], v[28:31], a[40:43], v[68:71]
    v_mfma_f32_16x16x32_bf16 v[72:75], v[28:31], a[36:39], v[72:75]
    v_mfma_f32_16x16x32_bf16 v[76:79], v[28:31], a[32:35], v[76:79]
    s_waitcnt vmcnt(8)
    v_mfma_f32_16x16x32_bf16 v[32:35], v[80:83], v[12:15], 0
    v_mfma_f32_16x16x32_bf16 v[36:39], v[84:87], v[12:15], 0
    v_mfma_f32_16x16x32_bf16 v[40:43], v[88:91], v[12:15], 0
    v_mfma_f32_16x16x32_bf16 v[44:47], v[92:95], v[12:15], 0
    s_nop 4
    v_add_f32_dpp v4, v32, v34 row_ror:8 row_mask:0xf bank_mask:0xf
    v_add_f32_dpp v5, v36, v38 row_ror:8 row_mask:0xf bank_mask:0xf
    v_add_f32_dpp v6, v40, v42 row_ror:8 row_mask:0xf bank_mask:0xf
    v_add_f32_dpp v7, v44, v46 row_ror:8 row_mask:0xf bank_mask:0xf
    v_add_f32_dpp v4, v33, v4 row_ror:4 row_mask:0xf bank_mask:0xf
    v_add_f32_dpp v5, v37, v5 row_ror:4 row_mask:0xf bank_mask:0xf
    v_add_f32_dpp v6, v41, v6 row_ror:4 row_mask:0xf bank_mask:0xf
    v_add_f32_dpp v7, v45, v7 row_ror:4 row_mask:0xf bank_mask:0xf
    v_add_f32_dpp v16, v35, v4 row_ror:12 row_mask:0xf bank_mask:0x4
    v_add_f32_dpp v17, v39, v5 row_ror:12 row_mask:0xf bank_mask:0x4
    v_add_f32_dpp v18, v43, v6 row_ror:12 row_mask:0xf bank_mask:0x4
    v_add_f32_dpp v19, v47, v7 row_ror:12 row_mask:0xf bank_mask:0x4
    v_mfma_f32_16x16x32_bf16 v[32:35], v[96:99], v[12:15], 0
    v_mfma_f32_16x16x32_bf16 v[36:39], v[100:103], v[12:15], 0
    v_mfma_f32_16x16x32_bf16 v[40:43], v[104:107], v[12:15], 0
    v_mfma_f32_16x16x32_bf16 v[44:47], v[108:111], v[12:15], 0
    s_lshr_b32 s66, s3, 4
    s_lshl_b32 s66, s66, 18
    s_and_b32 s67, s3, 15
    s_lshl_b32 s67, s67, 6
    s_add_u32 s66, s66, s67
    s_lshl_b32 s67, s52, 16
    s_add_u32 s66, s66, s67
    v_and_b32 v5, 15, v1
    v_lshlrev_b32 v5, 12, v5
    v_lshrrev_b32 v6, 4, v1
    v_lshl_add_u32 v5, v6, 4, v5
    buffer_load_dwordx4 v[80:83], v5, s[24:27], s66 offen offset:0
    buffer_load_dwordx4 v[84:87], v5, s[24:27], s66 offen offset:1024
    buffer_load_dwordx4 v[88:91], v5, s[24:27], s66 offen offset:2048
    buffer_load_dwordx4 v[92:95], v5, s[24:27], s66 offen offset:3072
    s_lshr_b32 s66, s6, 4
    s_mul_i32 s66, s66, 229376
    s_and_b32 s67, s6, 15
    s_lshl_b32 s67, s67, 6
    s_add_u32 s66, s66, s67
    s_mul_i32 s67, s52, 14
    v_and_b32 v6, 15, v1
    v_min_u32 v5, 13, v6
    v_add_u32 v5, s67, v5
    v_cmp_lt_u32 vcc, 13, v6
    v_lshrrev_b32 v6, 3, v5
    v_lshlrev_b32 v6, 5, v6
    v_and_b32 v7, 1, v5
    v_lshl_add_u32 v6, v7, 4, v6
    v_and_b32 v7, 6, v5
    v_add_u32 v6, v7, v6
    v_lshrrev_b32 v7, 4, v1
    v_lshlrev_b32 v7, 4, v7
    v_lshl_add_u32 v5, v6, 10, v7
    v_bfrev_b32 v6, 2
    v_cndmask_b32 v5, v5, v6, vcc
    s_add_u32 s67, s66, 0x2000
    buffer_load_dwordx4 v[96:99], v5, s[36:39], s66 offen offset:0
    buffer_load_dwordx4 v[100:103], v5, s[36:39], s66 offen offset:1024
    buffer_load_dwordx4 v[104:107], v5, s[36:39], s67 offen offset:0
    buffer_load_dwordx4 v[108:111], v5, s[36:39], s67 offen offset:1024
    v_add_f32_dpp v4, v32, v34 row_ror:8 row_mask:0xf bank_mask:0xf
    v_add_f32_dpp v5, v36, v38 row_ror:8 row_mask:0xf bank_mask:0xf
    v_add_f32_dpp v6, v40, v42 row_ror:8 row_mask:0xf bank_mask:0xf
    v_add_f32_dpp v7, v44, v46 row_ror:8 row_mask:0xf bank_mask:0xf
    v_add_f32_dpp v4, v33, v4 row_ror:4 row_mask:0xf bank_mask:0xf
    v_add_f32_dpp v5, v37, v5 row_ror:4 row_mask:0xf bank_mask:0xf
    v_add_f32_dpp v6, v41, v6 row_ror:4 row_mask:0xf bank_mask:0xf
    v_add_f32_dpp v7, v45, v7 row_ror:4 row_mask:0xf bank_mask:0xf
    v_add_f32_dpp v20, v35, v4 row_ror:12 row_mask:0xf bank_mask:0x4
    v_add_f32_dpp v21, v39, v5 row_ror:12 row_mask:0xf bank_mask:0x4
    v_add_f32_dpp v22, v43, v6 row_ror:12 row_mask:0xf bank_mask:0x4
    v_add_f32_dpp v23, v47, v7 row_ror:12 row_mask:0xf bank_mask:0x4
    v_mov_b32_dpp v28, v24 row_shl:8 row_mask:0xf bank_mask:0xf
    v_mov_b32_dpp v29, v25 row_shl:8 row_mask:0xf bank_mask:0xf
    v_mov_b32_dpp v30, v26 row_shl:8 row_mask:0xf bank_mask:0xf
    v_mov_b32_dpp v31, v27 row_shl:8 row_mask:0xf bank_mask:0xf
    s_nop 1
    v_mfma_f32_16x16x32_bf16 v[48:51], v[28:31], a[92:95], v[48:51]
    v_mfma_f32_16x16x32_bf16 v[52:55], v[28:31], a[88:91], v[52:55]
    v_mfma_f32_16x16x32_bf16 v[56:59], v[28:31], a[84:87], v[56:59]
    v_mfma_f32_16x16x32_bf16 v[60:63], v[28:31], a[80:83], v[60:63]
    v_mfma_f32_16x16x32_bf16 v[64:67], v[28:31], a[76:79], v[64:67]
    v_mfma_f32_16x16x32_bf16 v[68:71], v[28:31], a[72:75], v[68:71]
    v_mfma_f32_16x16x32_bf16 v[72:75], v[28:31], a[68:71], v[72:75]
    v_mfma_f32_16x16x32_bf16 v[76:79], v[28:31], a[64:67], v[76:79]
    v_mov_b32_dpp v28, v24 row_shl:12 row_mask:0xf bank_mask:0xf
    v_mov_b32_dpp v29, v25 row_shl:12 row_mask:0xf bank_mask:0xf
    v_mov_b32_dpp v30, v26 row_shl:12 row_mask:0xf bank_mask:0xf
    v_mov_b32_dpp v31, v27 row_shl:12 row_mask:0xf bank_mask:0xf
    s_nop 1
    v_mfma_f32_16x16x32_bf16 v[48:51], v[28:31], a[124:127], v[48:51]
    v_mfma_f32_16x16x32_bf16 v[52:55], v[28:31], a[120:123], v[52:55]
    v_mfma_f32_16x16x32_bf16 v[56:59], v[28:31], a[116:119], v[56:59]
    v_mfma_f32_16x16x32_bf16 v[60:63], v[28:31], a[112:115], v[60:63]
    v_mfma_f32_16x16x32_bf16 v[64:67], v[28:31], a[108:111], v[64:67]
    v_mfma_f32_16x16x32_bf16 v[68:71], v[28:31], a[104:107], v[68:71]
    v_mfma_f32_16x16x32_bf16 v[72:75], v[28:31], a[100:103], v[72:75]
    v_mfma_f32_16x16x32_bf16 v[76:79], v[28:31], a[96:99], v[76:79]
    v_max3_f32 v4, v16, v17, v18
    v_max3_f32 v5, v19, v20, v21
    v_max3_f32 v4, v4, v22, v23
    v_max3_f32 v4, v4, v5, v10
    s_nop 1
    v_max_f32_dpp v4, v4, v4 row_ror:4 row_mask:0xf bank_mask:0xf
    s_nop 1
    v_max_f32_dpp v4, v4, v4 row_ror:8 row_mask:0xf bank_mask:0xf
    v_mov_b32 v5, v4
    s_nop 1
    v_permlane16_swap_b32 v4, v5
    v_max_f32 v4, v4, v5
    v_mov_b32 v5, v4
    s_nop 1
    v_permlane32_swap_b32 v4, v5
    v_max_f32 v4, v4, v5
    v_sub_f32 v31, v10, v4
    v_mul_f32 v31, s60, v31
    v_exp_f32 v31, v31
    v_mul_f32 v5, s60, v4
    v_mov_b32 v10, v4
    v_fma_f32 v16, v16, s60, -v5
    v_fma_f32 v17, v17, s60, -v5
    v_fma_f32 v18, v18, s60, -v5
    v_fma_f32 v19, v19, s60, -v5
    v_fma_f32 v20, v20, s60, -v5
    v_fma_f32 v21, v21, s60, -v5
    v_fma_f32 v22, v22, s60, -v5
    v_fma_f32 v23, v23, s60, -v5
    v_readlane_b32 s62, v31, 0
    v_readlane_b32 s63, v31, 1
    v_readlane_b32 s64, v31, 2
    v_readlane_b32 s65, v31, 3
    v_exp_f32 v16, v16
    v_exp_f32 v17, v17
    v_exp_f32 v18, v18
    v_exp_f32 v19, v19
    v_exp_f32 v20, v20
    v_exp_f32 v21, v21
    v_exp_f32 v22, v22
    v_exp_f32 v23, v23
    v_cvt_pk_bf16_f32 v24, v16, v17
    v_cvt_pk_bf16_f32 v25, v18, v19
    v_cvt_pk_bf16_f32 v26, v20, v21
    v_cvt_pk_bf16_f32 v27, v22, v23
    v_mul_f32 v11, v11, v31
    v_pk_mul_f32 v[48:49], v[48:49], s[62:63]
    v_pk_mul_f32 v[50:51], v[50:51], s[64:65]
    v_pk_mul_f32 v[52:53], v[52:53], s[62:63]
    v_pk_mul_f32 v[54:55], v[54:55], s[64:65]
    v_pk_mul_f32 v[56:57], v[56:57], s[62:63]
    v_pk_mul_f32 v[58:59], v[58:59], s[64:65]
    v_pk_mul_f32 v[60:61], v[60:61], s[62:63]
    v_pk_mul_f32 v[62:63], v[62:63], s[64:65]
    v_pk_mul_f32 v[64:65], v[64:65], s[62:63]
    v_pk_mul_f32 v[66:67], v[66:67], s[64:65]
    v_pk_mul_f32 v[68:69], v[68:69], s[62:63]
    v_pk_mul_f32 v[70:71], v[70:71], s[64:65]
    v_pk_mul_f32 v[72:73], v[72:73], s[62:63]
    v_pk_mul_f32 v[74:75], v[74:75], s[64:65]
    v_pk_mul_f32 v[76:77], v[76:77], s[62:63]
    v_pk_mul_f32 v[78:79], v[78:79], s[64:65]
    v_add_f32 v11, v11, v16
    v_add_f32 v11, v11, v17
    v_add_f32 v11, v11, v18
    v_add_f32 v11, v11, v19
    v_add_f32 v11, v11, v20
    v_add_f32 v11, v11, v21
    v_add_f32 v11, v11, v22
    v_add_f32 v11, v11, v23
    v_mfma_f32_16x16x32_bf16 v[48:51], v[24:27], a[156:159], v[48:51]
    v_mfma_f32_16x16x32_bf16 v[52:55], v[24:27], a[152:155], v[52:55]
    v_mfma_f32_16x16x32_bf16 v[56:59], v[24:27], a[148:151], v[56:59]
    v_mfma_f32_16x16x32_bf16 v[60:63], v[24:27], a[144:147], v[60:63]
    v_mfma_f32_16x16x32_bf16 v[64:67], v[24:27], a[140:143], v[64:67]
    v_mfma_f32_16x16x32_bf16 v[68:71], v[24:27], a[136:139], v[68:71]
    v_mfma_f32_16x16x32_bf16 v[72:75], v[24:27], a[132:135], v[72:75]
    v_mfma_f32_16x16x32_bf16 v[76:79], v[24:27], a[128:131], v[76:79]
    v_mov_b32_dpp v28, v24 row_shl:4 row_mask:0xf bank_mask:0xf
    v_mov_b32_dpp v29, v25 row_shl:4 row_mask:0xf bank_mask:0xf
    v_mov_b32_dpp v30, v26 row_shl:4 row_mask:0xf bank_mask:0xf
    v_mov_b32_dpp v31, v27 row_shl:4 row_mask:0xf bank_mask:0xf
    s_nop 1
    v_mfma_f32_16x16x32_bf16 v[48:51], v[28:31], a[188:191], v[48:51]
    v_mfma_f32_16x16x32_bf16 v[52:55], v[28:31], a[184:187], v[52:55]
    v_mfma_f32_16x16x32_bf16 v[56:59], v[28:31], a[180:183], v[56:59]
    v_mfma_f32_16x16x32_bf16 v[60:63], v[28:31], a[176:179], v[60:63]
    v_mfma_f32_16x16x32_bf16 v[64:67], v[28:31], a[172:175], v[64:67]
    v_mfma_f32_16x16x32_bf16 v[68:71], v[28:31], a[168:171], v[68:71]
    v_mfma_f32_16x16x32_bf16 v[72:75], v[28:31], a[164:167], v[72:75]
    v_mfma_f32_16x16x32_bf16 v[76:79], v[28:31], a[160:163], v[76:79]
    v_mov_b32_dpp v28, v24 row_shl:8 row_mask:0xf bank_mask:0xf
    v_mov_b32_dpp v29, v25 row_shl:8 row_mask:0xf bank_mask:0xf
    v_mov_b32_dpp v30, v26 row_shl:8 row_mask:0xf bank_mask:0xf
    v_mov_b32_dpp v31, v27 row_shl:8 row_mask:0xf bank_mask:0xf
    s_nop 1
    v_mfma_f32_16x16x32_bf16 v[48:51], v[28:31], a[220:223], v[48:51]
    v_mfma_f32_16x16x32_bf16 v[52:55], v[28:31], a[216:219], v[52:55]
    v_mfma_f32_16x16x32_bf16 v[56:59], v[28:31], a[212:215], v[56:59]
    v_mfma_f32_16x16x32_bf16 v[60:63], v[28:31], a[208:211], v[60:63]
    v_mfma_f32_16x16x32_bf16 v[64:67], v[28:31], a[204:207], v[64:67]
    v_mfma_f32_16x16x32_bf16 v[68:71], v[28:31], a[200:203], v[68:71]
    v_mfma_f32_16x16x32_bf16 v[72:75], v[28:31], a[196:199], v[72:75]
    v_mfma_f32_16x16x32_bf16 v[76:79], v[28:31], a[192:195], v[76:79]
    v_mov_b32 v5, 0xff800000
    s_nop 1
    v_mov_b32_dpp v16, v5 quad_perm:[0,1,2,3] row_mask:0xf bank_mask:0xe
    v_mov_b32_dpp v17, v5 quad_perm:[0,1,2,3] row_mask:0xf bank_mask:0xe
    v_mov_b32_dpp v18, v5 quad_perm:[0,1,2,3] row_mask:0xf bank_mask:0xe
    v_mov_b32_dpp v19, v5 quad_perm:[0,1,2,3] row_mask:0xf bank_mask:0xe
    v_mov_b32_dpp v20, v5 quad_perm:[0,1,2,3] row_mask:0xf bank_mask:0xe
    v_mov_b32_dpp v21, v5 quad_perm:[0,1,2,3] row_mask:0xf bank_mask:0xe
    v_mov_b32_dpp v22, v5 quad_perm:[0,1,2,3] row_mask:0xf bank_mask:0xe
    v_mov_b32_dpp v23, v5 quad_perm:[0,1,2,3] row_mask:0xf bank_mask:0xe
    v_add_f32_dpp v11, v11, v11 row_ror:4 row_mask:0xf bank_mask:0xf
    s_nop 1
    v_add_f32_dpp v11, v11, v11 row_ror:8 row_mask:0xf bank_mask:0xf
    v_mov_b32 v5, v11
    s_nop 1
    v_permlane16_swap_b32 v11, v5
    v_add_f32 v11, v11, v5
    v_mov_b32 v5, v11
    s_nop 1
    v_permlane32_swap_b32 v11, v5
    v_add_f32 v11, v11, v5
    s_lshl_b32 s66, s52, 11
    v_lshlrev_b32 v6, 4, v1
    v_add_u32 v6, s66, v6
    s_lshl_b32 s66, s52, 3
    v_lshlrev_b32 v7, 5, v1
    v_add_u32 v7, s66, v7
    v_and_b32 v8, 3, v1
    v_lshlrev_b32 v8, 9, v8
    v_lshrrev_b32 v5, 2, v1
    v_lshl_add_u32 v8, v5, 4, v8
    s_lshl_b32 s66, s52, 2
    v_add_u32 v8, s66, v8
    s_mul_i32 s66, s3, 2560
    s_lshl_b32 s67, s52, 9
    s_add_u32 s66, s66, s67
    v_lshlrev_b32 v3, 3, v1
    v_add_u32 v3, s66, v3
    s_movk_i32 s66, 3584
    s_cmp_lt_u32 s52, 2
    s_cselect_b32 s66, s66, 0x2000
    v_lshrrev_b32 v28, 2, v1
    v_mul_lo_u32 v28, s66, v28
    v_and_b32 v5, 3, v1
    v_lshl_add_u32 v28, v5, 4, v28
    s_mul_i32 s7, s52, 384
    s_sub_u32 s7, s55, s7
    s_add_u32 s7, s7, 2048
    s_lshl_b32 s69, s52, 5
    s_waitcnt vmcnt(8)
    v_mfma_f32_16x16x32_bf16 v[32:35], v[112:115], v[12:15], 0
    v_mfma_f32_16x16x32_bf16 v[36:39], v[116:119], v[12:15], 0
    v_mfma_f32_16x16x32_bf16 v[40:43], v[120:123], v[12:15], 0
    v_mfma_f32_16x16x32_bf16 v[44:47], v[124:127], v[12:15], 0
    s_nop 4
    v_add_f32_dpp v4, v33, v32 row_ror:12 row_mask:0xf bank_mask:0xf
    s_nop 1
    v_add_f32_dpp v4, v34, v4 row_ror:8 row_mask:0xf bank_mask:0xf
    s_nop 1
    v_add_f32_dpp v16, v35, v4 row_ror:4 row_mask:0xf bank_mask:0x1
    v_mfma_f32_16x16x32_bf16 v[32:35], v[128:131], v[12:15], 0
    v_add_f32_dpp v4, v37, v36 row_ror:12 row_mask:0xf bank_mask:0xf
    s_nop 1
    v_add_f32_dpp v4, v38, v4 row_ror:8 row_mask:0xf bank_mask:0xf
    s_nop 1
    v_add_f32_dpp v17, v39, v4 row_ror:4 row_mask:0xf bank_mask:0x1
    v_mfma_f32_16x16x32_bf16 v[36:39], v[132:135], v[12:15], 0
    v_add_f32_dpp v4, v41, v40 row_ror:12 row_mask:0xf bank_mask:0xf
    s_nop 1
    v_add_f32_dpp v4, v42, v4 row_ror:8 row_mask:0xf bank_mask:0xf
    s_nop 1
    v_add_f32_dpp v18, v43, v4 row_ror:4 row_mask:0xf bank_mask:0x1
    v_mfma_f32_16x16x32_bf16 v[40:43], v[136:139], v[12:15], 0
    v_add_f32_dpp v4, v45, v44 row_ror:12 row_mask:0xf bank_mask:0xf
    s_nop 1
    v_add_f32_dpp v4, v46, v4 row_ror:8 row_mask:0xf bank_mask:0xf
    s_nop 1
    v_add_f32_dpp v19, v47, v4 row_ror:4 row_mask:0xf bank_mask:0x1
    v_mfma_f32_16x16x32_bf16 v[44:47], v[140:143], v[12:15], 0
    buffer_load_dwordx4 v[112:115], v28, s[40:43], s28 offen
    buffer_load_dwordx4 v[116:119], v28, s[40:43], s29 offen
    buffer_load_dwordx4 v[120:123], v28, s[40:43], s30 offen
    buffer_load_dwordx4 v[124:127], v28, s[40:43], s31 offen
    buffer_load_dwordx4 v[128:131], v28, s[40:43], s32 offen
    buffer_load_dwordx4 v[132:135], v28, s[40:43], s33 offen
    buffer_load_dwordx4 v[136:139], v28, s[40:43], s34 offen
    buffer_load_dwordx4 v[140:143], v28, s[40:43], s35 offen
    v_add_f32_dpp v4, v33, v32 row_ror:12 row_mask:0xf bank_mask:0xf
    s_nop 1
    v_add_f32_dpp v4, v34, v4 row_ror:8 row_mask:0xf bank_mask:0xf
    s_nop 1
    v_add_f32_dpp v20, v35, v4 row_ror:4 row_mask:0xf bank_mask:0x1
    v_add_f32_dpp v4, v37, v36 row_ror:12 row_mask:0xf bank_mask:0xf
    s_nop 1
    v_add_f32_dpp v4, v38, v4 row_ror:8 row_mask:0xf bank_mask:0xf
    s_nop 1
    v_add_f32_dpp v21, v39, v4 row_ror:4 row_mask:0xf bank_mask:0x1
    v_add_f32_dpp v4, v41, v40 row_ror:12 row_mask:0xf bank_mask:0xf
    s_nop 1
    v_add_f32_dpp v4, v42, v4 row_ror:8 row_mask:0xf bank_mask:0xf
    s_nop 1
    v_add_f32_dpp v22, v43, v4 row_ror:4 row_mask:0xf bank_mask:0x1
    v_add_f32_dpp v4, v45, v44 row_ror:12 row_mask:0xf bank_mask:0xf
    s_nop 1
    v_add_f32_dpp v4, v46, v4 row_ror:8 row_mask:0xf bank_mask:0xf
    s_nop 1
    v_add_f32_dpp v23, v47, v4 row_ror:4 row_mask:0xf bank_mask:0x1
    v_max3_f32 v4, v16, v17, v18
    v_max3_f32 v5, v19, v20, v21
    v_max3_f32 v4, v4, v22, v23
    v_max3_f32 v4, v4, v5, v10
    s_nop 1
    v_max_f32_dpp v4, v4, v4 row_ror:4 row_mask:0xf bank_mask:0xf
    s_nop 1
    v_max_f32_dpp v4, v4, v4 row_ror:8 row_mask:0xf bank_mask:0xf
    v_mov_b32 v5, v4
    s_nop 1
    v_permlane16_swap_b32 v4, v5
    v_max_f32 v4, v4, v5
    v_mov_b32 v5, v4
    s_nop 1
    v_permlane32_swap_b32 v4, v5
    v_max_f32 v4, v4, v5
    v_sub_f32 v31, v10, v4
    v_mul_f32 v31, s60, v31
    v_exp_f32 v31, v31
    v_mul_f32 v5, s60, v4
    v_mov_b32 v10, v4
    v_fma_f32 v16, v16, s60, -v5
    v_fma_f32 v17, v17, s60, -v5
    v_fma_f32 v18, v18, s60, -v5
    v_fma_f32 v19, v19, s60, -v5
    v_fma_f32 v20, v20, s60, -v5
    v_fma_f32 v21, v21, s60, -v5
    v_fma_f32 v22, v22, s60, -v5
    v_fma_f32 v23, v23, s60, -v5
    v_readlane_b32 s62, v31, 0
    v_readlane_b32 s63, v31, 1
    v_readlane_b32 s64, v31, 2
    v_readlane_b32 s65, v31, 3
    v_exp_f32 v16, v16
    v_exp_f32 v17, v17
    v_exp_f32 v18, v18
    v_exp_f32 v19, v19
    v_exp_f32 v20, v20
    v_exp_f32 v21, v21
    v_exp_f32 v22, v22
    v_exp_f32 v23, v23
    v_pk_mul_f32 v[48:49], v[48:49], s[62:63]
    v_pk_mul_f32 v[50:51], v[50:51], s[64:65]
    v_pk_mul_f32 v[52:53], v[52:53], s[62:63]
    v_pk_mul_f32 v[54:55], v[54:55], s[64:65]
    v_cvt_pk_bf16_f32 v24, v16, v17
    v_cvt_pk_bf16_f32 v25, v18, v19
    v_cvt_pk_bf16_f32 v26, v20, v21
    v_cvt_pk_bf16_f32 v27, v22, v23
    s_nop 1
    v_mfma_f32_16x16x32_bf16 v[48:51], v[24:27], a[252:255], v[48:51]
    v_pk_mul_f32 v[56:57], v[56:57], s[62:63]
    v_pk_mul_f32 v[58:59], v[58:59], s[64:65]
    v_mfma_f32_16x16x32_bf16 v[52:55], v[24:27], a[248:251], v[52:55]
    v_pk_mul_f32 v[60:61], v[60:61], s[62:63]
    v_pk_mul_f32 v[62:63], v[62:63], s[64:65]
    v_mfma_f32_16x16x32_bf16 v[56:59], v[24:27], a[244:247], v[56:59]
    v_pk_mul_f32 v[64:65], v[64:65], s[62:63]
    v_pk_mul_f32 v[66:67], v[66:67], s[64:65]
    v_mfma_f32_16x16x32_bf16 v[60:63], v[24:27], a[240:243], v[60:63]
    v_pk_mul_f32 v[68:69], v[68:69], s[62:63]
    v_pk_mul_f32 v[70:71], v[70:71], s[64:65]
    v_mfma_f32_16x16x32_bf16 v[64:67], v[24:27], a[236:239], v[64:67]
    v_pk_mul_f32 v[72:73], v[72:73], s[62:63]
    v_pk_mul_f32 v[74:75], v[74:75], s[64:65]
    v_mfma_f32_16x16x32_bf16 v[68:71], v[24:27], a[232:235], v[68:71]
    v_pk_mul_f32 v[76:77], v[76:77], s[62:63]
    v_pk_mul_f32 v[78:79], v[78:79], s[64:65]
    v_mfma_f32_16x16x32_bf16 v[72:75], v[24:27], a[228:231], v[72:75]
    s_nop 0
    v_mfma_f32_16x16x32_bf16 v[76:79], v[24:27], a[224:227], v[76:79]
    v_pk_add_f32 v[16:17], v[16:17], v[18:19]
    v_pk_add_f32 v[20:21], v[20:21], v[22:23]
    v_pk_add_f32 v[16:17], v[16:17], v[20:21]
    v_add_f32 v4, v16, v17
    v_mov_b32 v5, v4
    s_nop 1
    v_permlane16_swap_b32 v4, v5
    v_add_f32 v4, v4, v5
    v_mov_b32 v5, v4
    s_nop 1
    v_permlane32_swap_b32 v4, v5
    v_add_f32 v4, v4, v5
    v_fma_f32 v11, v11, v31, v4
L_main:
    s_mov_b64 exec, 0xffff
    ds_write_b128 v6, v[48:51] offset:0
    ds_write_b128 v6, v[52:55] offset:256
    ds_write_b128 v6, v[56:59] offset:512
    ds_write_b128 v6, v[60:63] offset:768
    ds_write_b128 v6, v[64:67] offset:1024
    ds_write_b128 v6, v[68:71] offset:1280
    ds_write_b128 v6, v[72:75] offset:1536
    ds_write_b128 v6, v[76:79] offset:1792
    s_mov_b64 exec, 0xf
    ds_write_b64 v7, v[10:11] offset:8192
    s_mov_b64 exec, -1
    v_mov_b32 v7, s69
    s_waitcnt lgkmcnt(0)
    s_barrier
    ds_read_b128 v[16:19], v7 offset:8192
    ds_read_b128 v[20:23], v7 offset:8208
    ds_read2st64_b32 v[32:33], v8 offset0:0 offset1:1
    ds_read2st64_b32 v[34:35], v8 offset0:8 offset1:9
    ds_read2st64_b32 v[36:37], v8 offset0:16 offset1:17
    ds_read2st64_b32 v[38:39], v8 offset0:24 offset1:25
    s_waitcnt lgkmcnt(4)
    v_max3_f32 v4, v16, v18, v20
    v_max_f32 v40, v4, v22
    v_mul_f32 v5, s60, v40
    v_fma_f32 v16, v16, s60, -v5
    v_fma_f32 v18, v18, s60, -v5
    v_fma_f32 v20, v20, s60, -v5
    v_fma_f32 v22, v22, s60, -v5
    v_exp_f32 v16, v16
    v_exp_f32 v18, v18
    v_exp_f32 v20, v20
    v_exp_f32 v22, v22
    v_mov_b32 v42, v40
    s_waitcnt lgkmcnt(0)
    v_pk_mul_f32 v[44:45], v[32:33], v[16:17] op_sel:[0,0] op_sel_hi:[1,0]
    v_pk_fma_f32 v[44:45], v[34:35], v[18:19], v[44:45] op_sel:[0,0,0] op_sel_hi:[1,0,1]
    v_pk_fma_f32 v[44:45], v[36:37], v[20:21], v[44:45] op_sel:[0,0,0] op_sel_hi:[1,0,1]
    v_pk_fma_f32 v[44:45], v[38:39], v[22:23], v[44:45] op_sel:[0,0,0] op_sel_hi:[1,0,1]
    v_mul_f32 v41, v16, v17
    v_fmac_f32 v41, v18, v19
    v_mov_b32_dpp v46, v44 quad_perm:[1,1,3,3] row_mask:0xf bank_mask:0xf
    v_mov_b32_dpp v47, v45 quad_perm:[1,1,3,3] row_mask:0xf bank_mask:0xf
    s_mov_b32 exec_lo, 0x55555555
    s_mov_b32 exec_hi, 0x55555555
    s_cmp_lg_u32 s88, 0
    s_cbranch_scc0 L_far_161
    buffer_store_dwordx4 v[44:47], v3, s[16:19], s55 offen
L_near_162:
    v_fmac_f32 v41, v20, v21
    v_fma_f32 v43, v22, v23, v41
    v_fmac_f32 v41, v22, v23
    s_mov_b64 exec, 0x5555
    s_cmp_lg_u32 s88, 0
    s_cbranch_scc0 L_far_163
    buffer_store_dwordx4 v[40:43], v3, s[16:19], s7 offen
L_near_164:
    s_mov_b64 exec, -1
    s_lshr_b32 s66, s3, 5
    s_mul_i32 s66, s66, 81920
    s_bfe_u32 s67, s3, 0x10004
    s_lshl_b32 s67, s67, 2
    s_add_u32 s67, s67, s52
    s_lshl_b32 s68, s67, 8
    s_add_u32 s68, s68, s66
    s_lshr_b32 s67, s67, 1
    s_lshl_b32 s67, s67, 7
    s_add_u32 s67, s67, s66
    s_add_u32 s67, s67, 2048
    v_lshrrev_b32 v6, 4, v1
    v_mul_u32_u24 v6, 2560, v6
    v_and_b32 v7, 15, v1
    v_lshl_add_u32 v4, v7, 4, v6
    v_add_u32 v4, s68, v4
    v_and_b32 v7, 7, v1
    v_mul_u32_u24 v7, 10240, v7
    v_add3_u32 v5, s67, v6, v7
    buffer_load_dwordx2 v[32:33], v5, s[16:19], s55 offen sc1
    s_add_u32 s53, s55, 0x0
    buffer_load_dwordx4 v[48:51], v4, s[16:19], s53 offen sc1
    s_add_u32 s53, s55, 0x2800
    buffer_load_dwordx4 v[52:55], v4, s[16:19], s53 offen sc1
    s_add_u32 s53, s55, 0x5000
    buffer_load_dwordx4 v[56:59], v4, s[16:19], s53 offen sc1
    s_add_u32 s53, s55, 0x7800
    buffer_load_dwordx4 v[60:63], v4, s[16:19], s53 offen sc1
    s_add_u32 s53, s55, 0xa000
    buffer_load_dwordx4 v[64:67], v4, s[16:19], s53 offen sc1
    s_add_u32 s53, s55, 0xc800
    buffer_load_dwordx4 v[68:71], v4, s[16:19], s53 offen sc1
    s_add_u32 s53, s55, 0xf000
    buffer_load_dwordx4 v[72:75], v4, s[16:19], s53 offen sc1
    s_add_u32 s53, s55, 0x11800
    buffer_load_dwordx4 v[76:79], v4, s[16:19], s53 offen sc1
    s_lshl_b32 s66, s52, 7
    v_lshlrev_b32 v28, 1, v1
    v_add_u32 v28, s66, v28
    s_lshl_b32 s66, s3, 7
    s_add_u32 s66, s66, 0x400000
    v_and_b32 v29, 7, v1
    v_lshlrev_b32 v29, 4, v29
    v_lshrrev_b32 v30, 3, v1
    v_mul_u32_u24 v30, 0x8100, v30
    v_add3_u32 v30, s66, v30, v29
    s_movk_i32 s5, 64
    s_waitcnt vmcnt(11)
    v_perm_b32 v11, v84, v80, s57
    v_perm_b32 v84, v84, v80, s58
    v_perm_b32 v80, v85, v81, s57
    v_perm_b32 v85, v85, v81, s58
    v_perm_b32 v81, v86, v82, s57
    v_perm_b32 v86, v86, v82, s58
    v_perm_b32 v82, v87, v83, s57
    v_perm_b32 v87, v87, v83, s58
    v_perm_b32 v83, v92, v88, s57
    v_perm_b32 v92, v92, v88, s58
    v_perm_b32 v88, v93, v89, s57
    v_perm_b32 v93, v93, v89, s58
    v_perm_b32 v89, v94, v90, s57
    v_perm_b32 v94, v94, v90, s58
    v_perm_b32 v90, v95, v91, s57
    v_perm_b32 v95, v95, v91, s58
    v_perm_b32 v10, v116, v112, s57
    v_perm_b32 v116, v116, v112, s58
    v_perm_b32 v112, v117, v113, s57
    v_perm_b32 v117, v117, v113, s58
    v_perm_b32 v113, v118, v114, s57
    v_perm_b32 v118, v118, v114, s58
    v_perm_b32 v114, v119, v115, s57
    v_perm_b32 v119, v119, v115, s58
    v_perm_b32 v115, v124, v120, s57
    v_perm_b32 v124, v124, v120, s58
    v_perm_b32 v120, v125, v121, s57
    v_perm_b32 v125, v125, v121, s58
    v_perm_b32 v121, v126, v122, s57
    v_perm_b32 v126, v126, v122, s58
    v_perm_b32 v122, v127, v123, s57
    v_perm_b32 v127, v127, v123, s58
    v_perm_b32 v123, v132, v128, s57
    v_perm_b32 v132, v132, v128, s58
    v_perm_b32 v128, v133, v129, s57
    v_perm_b32 v133, v133, v129, s58
    v_perm_b32 v129, v134, v130, s57
    v_perm_b32 v134, v134, v130, s58
    v_perm_b32 v130, v135, v131, s57
    v_perm_b32 v135, v135, v131, s58
    v_perm_b32 v131, v140, v136, s57
    v_perm_b32 v140, v140, v136, s58
    v_perm_b32 v136, v141, v137, s57
    v_perm_b32 v141, v141, v137, s58
    v_perm_b32 v137, v142, v138, s57
    v_perm_b32 v142, v142, v138, s58
    v_perm_b32 v138, v143, v139, s57
    v_perm_b32 v143, v143, v139, s58
    v_perm_b32 v3, v100, v96, s57
    v_perm_b32 v100, v100, v96, s58
    v_perm_b32 v96, v101, v97, s57
    v_perm_b32 v101, v101, v97, s58
    v_perm_b32 v97, v102, v98, s57
    v_perm_b32 v102, v102, v98, s58
    v_perm_b32 v98, v103, v99, s57
    v_perm_b32 v103, v103, v99, s58
    v_perm_b32 v99, v108, v104, s57
    v_perm_b32 v108, v108, v104, s58
    v_perm_b32 v104, v109, v105, s57
    v_perm_b32 v109, v109, v105, s58
    v_perm_b32 v105, v110, v106, s57
    v_perm_b32 v110, v110, v106, s58
    v_perm_b32 v106, v111, v107, s57
    v_perm_b32 v111, v111, v107, s58
    s_waitcnt vmcnt(0)
L_pc_165:
    v_max_f32_dpp v6, v32, v32 quad_perm:[1,0,3,2] row_mask:0xf bank_mask:0xf
    s_nop 1
    v_max_f32_dpp v6, v6, v6 quad_perm:[2,3,0,1] row_mask:0xf bank_mask:0xf
    s_nop 1
    v_max_f32_dpp v6, v6, v6 row_half_mirror row_mask:0xf bank_mask:0xf
    v_mov_b32 v7, v6
    s_nop 1
    v_permlane16_swap_b32 v6, v7
    v_max_f32 v6, v6, v7
    v_mov_b32 v7, v6
    s_nop 1
    v_permlane32_swap_b32 v6, v7
    v_max_f32 v6, v6, v7
    v_mul_f32 v6, s60, v6
    v_fma_f32 v6, v32, s60, -v6
    v_exp_f32 v6, v6
    s_nop 0
    v_mul_f32 v8, v6, v33
    v_mov_b32_dpp v16, v6 row_newbcast:0 row_mask:0xf bank_mask:0xf
    v_mov_b32_dpp v17, v6 row_newbcast:1 row_mask:0xf bank_mask:0xf
    v_add_f32_dpp v8, v8, v8 quad_perm:[1,0,3,2] row_mask:0xf bank_mask:0xf
    v_mov_b32_dpp v18, v6 row_newbcast:2 row_mask:0xf bank_mask:0xf
    v_mov_b32_dpp v19, v6 row_newbcast:3 row_mask:0xf bank_mask:0xf
    v_add_f32_dpp v8, v8, v8 quad_perm:[2,3,0,1] row_mask:0xf bank_mask:0xf
    v_mov_b32_dpp v20, v6 row_newbcast:4 row_mask:0xf bank_mask:0xf
    v_mov_b32_dpp v21, v6 row_newbcast:5 row_mask:0xf bank_mask:0xf
    v_add_f32_dpp v8, v8, v8 row_half_mirror row_mask:0xf bank_mask:0xf
    v_mov_b32_dpp v22, v6 row_newbcast:6 row_mask:0xf bank_mask:0xf
    v_mov_b32_dpp v23, v6 row_newbcast:7 row_mask:0xf bank_mask:0xf
    v_mov_b32 v7, v8
    v_pk_mul_f32 v[24:25], v[48:49], v[16:17] op_sel:[0,0] op_sel_hi:[1,0]
    v_pk_mul_f32 v[26:27], v[50:51], v[16:17] op_sel:[0,0] op_sel_hi:[1,0]
    v_permlane16_swap_b32 v8, v7
    v_pk_fma_f32 v[24:25], v[52:53], v[16:17], v[24:25] op_sel:[0,1,0] op_sel_hi:[1,1,1]
    v_pk_fma_f32 v[26:27], v[54:55], v[16:17], v[26:27] op_sel:[0,1,0] op_sel_hi:[1,1,1]
    v_add_f32 v8, v8, v7
    v_pk_fma_f32 v[24:25], v[56:57], v[18:19], v[24:25] op_sel:[0,0,0] op_sel_hi:[1,0,1]
    v_pk_fma_f32 v[26:27], v[58:59], v[18:19], v[26:27] op_sel:[0,0,0] op_sel_hi:[1,0,1]
    v_mov_b32 v7, v8
    v_pk_fma_f32 v[24:25], v[60:61], v[18:19], v[24:25] op_sel:[0,1,0] op_sel_hi:[1,1,1]
    v_pk_fma_f32 v[26:27], v[62:63], v[18:19], v[26:27] op_sel:[0,1,0] op_sel_hi:[1,1,1]
    v_permlane32_swap_b32 v8, v7
    v_pk_fma_f32 v[24:25], v[64:65], v[20:21], v[24:25] op_sel:[0,0,0] op_sel_hi:[1,0,1]
    v_pk_fma_f32 v[26:27], v[66:67], v[20:21], v[26:27] op_sel:[0,0,0] op_sel_hi:[1,0,1]
    v_add_f32 v8, v8, v7
    v_pk_fma_f32 v[24:25], v[68:69], v[20:21], v[24:25] op_sel:[0,1,0] op_sel_hi:[1,1,1]
    v_pk_fma_f32 v[26:27], v[70:71], v[20:21], v[26:27] op_sel:[0,1,0] op_sel_hi:[1,1,1]
    v_rcp_f32 v31, v8
    v_pk_fma_f32 v[24:25], v[72:73], v[22:23], v[24:25] op_sel:[0,0,0] op_sel_hi:[1,0,1]
    v_pk_fma_f32 v[26:27], v[74:75], v[22:23], v[26:27] op_sel:[0,0,0] op_sel_hi:[1,0,1]
    v_fma_f32 v8, -v8, v31, 1.0
    v_pk_fma_f32 v[24:25], v[76:77], v[22:23], v[24:25] op_sel:[0,1,0] op_sel_hi:[1,1,1]
    v_pk_fma_f32 v[26:27], v[78:79], v[22:23], v[26:27] op_sel:[0,1,0] op_sel_hi:[1,1,1]
    v_fma_f32 v31, v8, v31, v31
    s_nop 0
    v_permlane32_swap_b32 v24, v26
    v_permlane32_swap_b32 v25, v27
    v_add_f32 v24, v24, v26
    v_add_f32 v25, v25, v27
    s_nop 1
    v_permlane16_swap_b32 v24, v25
    v_add_f32 v24, v24, v25
    v_mul_f32 v6, v24, v31
    v_mul_f32 v7, v24, v31
    v_cmp_u_f32 vcc, v6, v6
    s_nop 0
    v_permlane16_swap_b32 v6, v7
    s_cbranch_vccnz L_pr_166
L_pd_167:
    v_cvt_pk_bf16_f32 v6, v6, v7
    v_mov_b32 v7, v6
    s_nop 1
    v_permlane32_swap_b32 v6, v7
    v_dot2_f32_bf16 v16, v11, v6, 0
    v_dot2_f32_bf16 v17, v84, v6, 0
    v_dot2_f32_bf16 v18, v80, v6, 0
    v_dot2_f32_bf16 v19, v85, v6, 0
    v_dot2_f32_bf16 v20, v81, v6, 0
    v_dot2_f32_bf16 v21, v86, v6, 0
    v_dot2_f32_bf16 v22, v82, v6, 0
    v_dot2_f32_bf16 v23, v87, v6, 0
    v_dot2c_f32_bf16 v16, v83, v7
    v_dot2c_f32_bf16 v17, v92, v7
    v_dot2c_f32_bf16 v18, v88, v7
    v_dot2c_f32_bf16 v19, v93, v7
    v_dot2c_f32_bf16 v20, v89, v7
    v_dot2c_f32_bf16 v21, v94, v7
    v_dot2c_f32_bf16 v22, v90, v7
    v_dot2c_f32_bf16 v23, v95, v7
    v_add_f32_dpp v16, v16, v16 row_ror:8 row_mask:0xf bank_mask:0x3
    v_add_f32_dpp v17, v17, v17 row_ror:8 row_mask:0xf bank_mask:0x3
    v_add_f32_dpp v18, v18, v18 row_ror:8 row_mask:0xf bank_mask:0x3
    v_add_f32_dpp v19, v19, v19 row_ror:8 row_mask:0xf bank_mask:0x3
    v_add_f32_dpp v16, v20, v20 row_ror:8 row_mask:0xf bank_mask:0xc
    v_add_f32_dpp v17, v21, v21 row_ror:8 row_mask:0xf bank_mask:0xc
    v_add_f32_dpp v18, v22, v22 row_ror:8 row_mask:0xf bank_mask:0xc
    v_add_f32_dpp v19, v23, v23 row_ror:8 row_mask:0xf bank_mask:0xc
    v_add_f32_dpp v16, v16, v16 row_half_mirror row_mask:0xf bank_mask:0x5
    v_add_f32_dpp v17, v17, v17 row_half_mirror row_mask:0xf bank_mask:0x5
    s_nop 0
    v_add_f32_dpp v16, v18, v18 row_half_mirror row_mask:0xf bank_mask:0xa
    v_add_f32_dpp v17, v19, v19 row_half_mirror row_mask:0xf bank_mask:0xa
    s_nop 0
    v_add_f32_dpp v16, v16, v16 quad_perm:[1,0,3,2] row_mask:0xf bank_mask:0xf
    v_add_f32_dpp v17, v17, v17 quad_perm:[1,0,3,2] row_mask:0xf bank_mask:0xf
    s_nop 0
    v_add_f32_dpp v16, v16, v16 quad_perm:[2,3,0,1] row_mask:0xf bank_mask:0xf
    v_add_f32_dpp v17, v17, v17 quad_perm:[2,3,0,1] row_mask:0xf bank_mask:0xf
    s_mov_b32 exec_lo, 0x11111111
    s_mov_b32 exec_hi, 0x11111111
    ds_write_b64 v28, v[16:17] offset:8320
    s_mov_b64 exec, -1
    s_waitcnt lgkmcnt(0)
    s_barrier
    s_cmp_lg_u32 s52, 0
    s_cbranch_scc1 L_nopub_169
    ds_read_b128 v[32:35], v29 offset:8320
    ds_read_b128 v[36:39], v29 offset:8448
    ds_read_b128 v[40:43], v29 offset:8576
    ds_read_b128 v[44:47], v29 offset:8704
    s_waitcnt lgkmcnt(2)
    v_pk_add_f32 v[32:33], v[32:33], v[36:37]
    v_pk_add_f32 v[34:35], v[34:35], v[38:39]
    s_waitcnt lgkmcnt(0)
    v_pk_add_f32 v[40:41], v[40:41], v[44:45]
    v_pk_add_f32 v[42:43], v[42:43], v[46:47]
    v_pk_add_f32 v[32:33], v[32:33], v[40:41]
    v_pk_add_f32 v[34:35], v[34:35], v[42:43]
    buffer_store_dwordx4 v[32:35], v30, s[16:19], s55 offen sc1
    s_mov_b64 exec, -1
L_nopub_169:
    s_lshl_b32 s66, s52, 9
    v_and_b32 v4, 31, v1
    v_lshlrev_b32 v4, 4, v4
    v_add_u32 v4, s66, v4
    v_lshrrev_b32 v6, 5, v1
    v_mul_u32_u24 v7, 0x4000, v6
    s_lshr_b32 s66, s3, 5
    s_mul_i32 s66, s66, 0x8100
    s_add_u32 s66, s66, 0x400000
    v_add3_u32 v5, s66, v4, v7
    buffer_load_dwordx4 v[48:51], v5, s[16:19], s55 offen offset:0 sc1
    buffer_load_dwordx4 v[52:55], v5, s[16:19], s55 offen offset:2048 sc1
    s_add_u32 s53, s55, 0x1000
    buffer_load_dwordx4 v[56:59], v5, s[16:19], s53 offen offset:0 sc1
    buffer_load_dwordx4 v[60:63], v5, s[16:19], s53 offen offset:2048 sc1
    s_add_u32 s53, s55, 0x2000
    buffer_load_dwordx4 v[64:67], v5, s[16:19], s53 offen offset:0 sc1
    buffer_load_dwordx4 v[68:71], v5, s[16:19], s53 offen offset:2048 sc1
    s_add_u32 s53, s55, 0x3000
    buffer_load_dwordx4 v[72:75], v5, s[16:19], s53 offen offset:0 sc1
    buffer_load_dwordx4 v[76:79], v5, s[16:19], s53 offen offset:2048 sc1
    v_lshl_add_u32 v4, v6, 3, v4
    ds_read_b64 v[12:13], v4 offset:10496
    s_movk_i32 s5, 64
    s_and_b32 s66, s3, 3
    s_lshl_b32 s66, s66, 7
    v_lshlrev_b32 v28, 2, v1
    v_lshrrev_b32 v29, 2, v1
    v_add_u32 v29, s66, v29
    v_lshlrev_b32 v29, 2, v29
    v_add_u32 v29, 0x2900, v29
    s_lshl_b32 s68, s3, 8
    s_lshl_b32 s69, s52, 7
    s_add_u32 s68, s68, s69
    s_mov_b32 s69, 0xc0000
    s_cmp_lt_u32 s52, 2
    s_cselect_b32 s69, s69, 0xaff00
    s_add_u32 s68, s68, s69
    v_and_b32 v30, 3, v1
    v_lshlrev_b32 v30, 3, v30
    v_lshrrev_b32 v6, 4, v1
    v_lshl_add_u32 v30, v6, 5, v30
    v_add_u32 v30, s68, v30
    s_branch L_pchk_171
L_poll_170:
    buffer_load_dwordx4 v[48:51], v5, s[16:19], s55 offen offset:0 sc1
    buffer_load_dwordx4 v[52:55], v5, s[16:19], s55 offen offset:2048 sc1
    s_add_u32 s53, s55, 0x1000
    buffer_load_dwordx4 v[56:59], v5, s[16:19], s53 offen offset:0 sc1
    buffer_load_dwordx4 v[60:63], v5, s[16:19], s53 offen offset:2048 sc1
    s_add_u32 s53, s55, 0x2000
    buffer_load_dwordx4 v[64:67], v5, s[16:19], s53 offen offset:0 sc1
    buffer_load_dwordx4 v[68:71], v5, s[16:19], s53 offen offset:2048 sc1
    s_add_u32 s53, s55, 0x3000
    buffer_load_dwordx4 v[72:75], v5, s[16:19], s53 offen offset:0 sc1
    buffer_load_dwordx4 v[76:79], v5, s[16:19], s53 offen offset:2048 sc1
L_pchk_171:
    s_waitcnt vmcnt(0) lgkmcnt(0)
    v_pk_add_f32 v[48:49], v[48:49], v[52:53]
    v_pk_add_f32 v[50:51], v[50:51], v[54:55]
    v_pk_add_f32 v[56:57], v[56:57], v[60:61]
    v_pk_add_f32 v[58:59], v[58:59], v[62:63]
    v_pk_add_f32 v[64:65], v[64:65], v[68:69]
    v_pk_add_f32 v[66:67], v[66:67], v[70:71]
    v_pk_add_f32 v[72:73], v[72:73], v[76:77]
    v_pk_add_f32 v[74:75], v[74:75], v[78:79]
    v_pk_add_f32 v[48:49], v[48:49], v[56:57]
    v_pk_add_f32 v[50:51], v[50:51], v[58:59]
    v_pk_add_f32 v[64:65], v[64:65], v[72:73]
    v_pk_add_f32 v[66:67], v[66:67], v[74:75]
    v_pk_add_f32 v[48:49], v[48:49], v[64:65]
    v_pk_add_f32 v[50:51], v[50:51], v[66:67]
    s_nop 1
    v_permlane32_swap_b32 v48, v50
    v_permlane32_swap_b32 v49, v51
    v_add_f32 v48, v48, v50
    v_add_f32 v49, v49, v51
    v_cmp_u_f32 vcc, v48, v49
    v_cvt_pk_bf16_f32 v6, v48, v49
    s_cbranch_vccz L_pdone_172
    s_sub_u32 s5, s5, 1
    s_cmp_lg_u32 s5, 0
    s_cbranch_scc1 L_nofl_173
    buffer_wbl2 sc1
    s_movk_i32 s5, 64
L_nofl_173:
    s_or_b32 exec_lo, vcc_lo, vcc_hi
    s_mov_b32 exec_hi, exec_lo
    s_sub_u32 s56, s56, 1
    s_cmp_eq_u32 s56, 0
    s_cbranch_scc0 L_poll_170
    s_mov_b32 s56, 1
L_pdone_172:
    s_mov_b64 exec, -1
    v_lshlrev_b32 v48, 16, v6
    v_and_b32 v49, s59, v6
    v_pk_add_f32 v[12:13], v[12:13], v[48:49]
    v_cvt_pk_bf16_f32 v6, v12, v13
    v_lshlrev_b32 v12, 16, v6
    v_and_b32 v13, s59, v6
    ds_write_b64 v4, v[12:13] offset:10496
    s_waitcnt lgkmcnt(0)
    s_cmp_lt_u32 s52, 2
    s_barrier
    s_cbranch_scc1 L_e2a
    s_cmp_lg_u32 s54, 0
    s_cbranch_scc1 L_nok_174
    s_cmp_lt_u32 s6, 128
    s_cbranch_scc1 L_nok_174
    s_add_u32 s53, s99, 0x0
    s_and_b32 s53, s53, 0x1fffff
    buffer_load_dwordx4 v[80:83], v2, s[8:11], s53 offen offset:0 nt
    buffer_load_dwordx4 v[84:87], v2, s[8:11], s53 offen offset:1024 nt
    buffer_load_dwordx4 v[88:91], v2, s[8:11], s53 offen offset:2048 nt
    buffer_load_dwordx4 v[92:95], v2, s[8:11], s53 offen offset:3072 nt
    s_add_u32 s53, s53, 0x1000
    buffer_load_dwordx4 v[96:99], v2, s[8:11], s53 offen offset:0 nt
    buffer_load_dwordx4 v[100:103], v2, s[8:11], s53 offen offset:1024 nt
    buffer_load_dwordx4 v[104:107], v2, s[8:11], s53 offen offset:2048 nt
    buffer_load_dwordx4 v[108:111], v2, s[8:11], s53 offen offset:3072 nt
L_nok_174:
    s_branch L_gudone
L_e2a:
    s_cmp_ge_u32 s4, 28
    s_cbranch_scc1 L_gudone
    ds_read2st64_b32 v[32:33], v28 offset0:41 offset1:42
    ds_read2st64_b32 v[34:35], v28 offset0:43 offset1:44
    ds_read2st64_b32 v[36:37], v28 offset0:45 offset1:46
    ds_read2st64_b32 v[38:39], v28 offset0:47 offset1:48
    ds_read2_b32 v[40:41], v29 offset0:0 offset1:16
    ds_read2_b32 v[42:43], v29 offset0:32 offset1:48
    ds_read2_b32 v[44:45], v29 offset0:64 offset1:80
    ds_read2_b32 v[46:47], v29 offset0:96 offset1:112
    s_waitcnt lgkmcnt(4)
    v_readfirstlane_b32 s0, v32
    s_nop 1
    v_pk_add_f32 v[32:33], v[32:33], s[0:1] op_sel_hi:[1,0] neg_lo:[0,1] neg_hi:[0,1]
    v_pk_add_f32 v[34:35], v[34:35], s[0:1] op_sel_hi:[1,0] neg_lo:[0,1] neg_hi:[0,1]
    v_pk_add_f32 v[36:37], v[36:37], s[0:1] op_sel_hi:[1,0] neg_lo:[0,1] neg_hi:[0,1]
    v_pk_add_f32 v[38:39], v[38:39], s[0:1] op_sel_hi:[1,0] neg_lo:[0,1] neg_hi:[0,1]
    v_pk_mul_f32 v[48:49], v[32:33], v[32:33]
    v_pk_add_f32 v[50:51], v[32:33], v[34:35]
    v_pk_fma_f32 v[48:49], v[34:35], v[34:35], v[48:49]
    v_pk_add_f32 v[32:33], v[36:37], v[38:39]
    v_pk_fma_f32 v[48:49], v[36:37], v[36:37], v[48:49]
    v_pk_add_f32 v[50:51], v[50:51], v[32:33]
    v_pk_fma_f32 v[48:49], v[38:39], v[38:39], v[48:49]
    v_add_f32 v4, v50, v51
    v_add_f32 v5, v48, v49
    s_nop 0
    v_add_f32_dpp v4, v4, v4 quad_perm:[1,0,3,2] row_mask:0xf bank_mask:0xf
    v_add_f32_dpp v5, v5, v5 quad_perm:[1,0,3,2] row_mask:0xf bank_mask:0xf
    s_nop 0
    v_add_f32_dpp v4, v4, v4 quad_perm:[2,3,0,1] row_mask:0xf bank_mask:0xf
    v_add_f32_dpp v5, v5, v5 quad_perm:[2,3,0,1] row_mask:0xf bank_mask:0xf
    s_nop 0
    v_add_f32_dpp v4, v4, v4 row_ror:4 row_mask:0xf bank_mask:0xf
    v_add_f32_dpp v5, v5, v5 row_ror:4 row_mask:0xf bank_mask:0xf
    s_nop 0
    v_add_f32_dpp v4, v4, v4 row_ror:8 row_mask:0xf bank_mask:0xf
    v_add_f32_dpp v5, v5, v5 row_ror:8 row_mask:0xf bank_mask:0xf
    s_nop 0
    v_add_f32_dpp v4, v4, v4 row_bcast:15 row_mask:0xa bank_mask:0xf
    v_add_f32_dpp v5, v5, v5 row_bcast:15 row_mask:0xa bank_mask:0xf
    s_nop 0
    v_add_f32_dpp v4, v4, v4 row_bcast:31 row_mask:0xc bank_mask:0xf
    v_add_f32_dpp v5, v5, v5 row_bcast:31 row_mask:0xc bank_mask:0xf
    v_mul_f32 v4, 0x3b000000, v4
    v_mul_f32 v5, 0x3b000000, v5
    v_fma_f32 v5, -v4, v4, v5
    v_add_f32 v4, s0, v4
    v_max_f32 v5, 0, v5
    v_cvt_pk_bf16_f32 v6, v4, v5
    v_lshlrev_b32 v4, 16, v6
    v_and_b32 v5, s59, v6
    v_add_f32 v5, 0x3727c5ac, v5
    v_readlane_b32 s62, v4, 63
    v_cvt_pk_bf16_f32 v5, v5, v5
    v_lshlrev_b32 v5, 16, v5
    v_sqrt_f32 v5, v5
    s_waitcnt lgkmcnt(0)
    v_pk_add_f32 v[40:41], v[40:41], s[62:63] op_sel_hi:[1,0] neg_lo:[0,1] neg_hi:[0,1]
    v_pk_add_f32 v[42:43], v[42:43], s[62:63] op_sel_hi:[1,0] neg_lo:[0,1] neg_hi:[0,1]
    v_pk_add_f32 v[44:45], v[44:45], s[62:63] op_sel_hi:[1,0] neg_lo:[0,1] neg_hi:[0,1]
    v_pk_add_f32 v[46:47], v[46:47], s[62:63] op_sel_hi:[1,0] neg_lo:[0,1] neg_hi:[0,1]
    v_cvt_pk_bf16_f32 v5, v5, v5
    v_lshlrev_b32 v5, 16, v5
    v_rcp_f32 v6, v5
    v_cvt_pk_bf16_f32 v24, v40, v41
    v_cvt_pk_bf16_f32 v25, v42, v43
    v_cvt_pk_bf16_f32 v26, v44, v45
    v_cvt_pk_bf16_f32 v27, v46, v47
    v_readlane_b32 s64, v5, 63
    v_readlane_b32 s0, v6, 63
    v_lshlrev_b32 v40, 16, v24
    v_and_b32 v41, s59, v24
    v_lshlrev_b32 v42, 16, v25
    v_and_b32 v43, s59, v25
    v_lshlrev_b32 v44, 16, v26
    v_and_b32 v45, s59, v26
    v_lshlrev_b32 v46, 16, v27
    v_and_b32 v47, s59, v27
    v_pk_mul_f32 v[32:33], v[40:41], s[0:1] op_sel_hi:[1,0]
    v_pk_mul_f32 v[34:35], v[42:43], s[0:1] op_sel_hi:[1,0]
    v_pk_mul_f32 v[36:37], v[44:45], s[0:1] op_sel_hi:[1,0]
    v_pk_mul_f32 v[38:39], v[46:47], s[0:1] op_sel_hi:[1,0]
    v_pk_fma_f32 v[40:41], v[32:33], s[64:65], v[40:41] op_sel_hi:[1,0,1] neg_lo:[1,0,0] neg_hi:[1,0,0]
    v_pk_fma_f32 v[42:43], v[34:35], s[64:65], v[42:43] op_sel_hi:[1,0,1] neg_lo:[1,0,0] neg_hi:[1,0,0]
    v_pk_fma_f32 v[44:45], v[36:37], s[64:65], v[44:45] op_sel_hi:[1,0,1] neg_lo:[1,0,0] neg_hi:[1,0,0]
    v_pk_fma_f32 v[46:47], v[38:39], s[64:65], v[46:47] op_sel_hi:[1,0,1] neg_lo:[1,0,0] neg_hi:[1,0,0]
    v_pk_fma_f32 v[32:33], v[40:41], s[0:1], v[32:33] op_sel_hi:[1,0,1]
    v_pk_fma_f32 v[34:35], v[42:43], s[0:1], v[34:35] op_sel_hi:[1,0,1]
    v_pk_fma_f32 v[36:37], v[44:45], s[0:1], v[36:37] op_sel_hi:[1,0,1]
    v_pk_fma_f32 v[38:39], v[46:47], s[0:1], v[38:39] op_sel_hi:[1,0,1]
    v_cvt_pk_bf16_f32 v24, v32, v33
    v_cvt_pk_bf16_f32 v25, v34, v35
    v_cvt_pk_bf16_f32 v26, v36, v37
    v_cvt_pk_bf16_f32 v27, v38, v39
    v_dot2_f32_bf16 v16, v10, v24, 0
    v_dot2_f32_bf16 v17, v116, v24, 0
    v_dot2_f32_bf16 v18, v112, v24, 0
    v_dot2_f32_bf16 v19, v117, v24, 0
    v_dot2_f32_bf16 v20, v113, v24, 0
    v_dot2_f32_bf16 v21, v118, v24, 0
    v_dot2_f32_bf16 v22, v114, v24, 0
    v_dot2_f32_bf16 v23, v119, v24, 0
    v_dot2c_f32_bf16 v16, v115, v25
    v_dot2c_f32_bf16 v17, v124, v25
    v_dot2c_f32_bf16 v18, v120, v25
    v_dot2c_f32_bf16 v19, v125, v25
    v_dot2c_f32_bf16 v20, v121, v25
    v_dot2c_f32_bf16 v21, v126, v25
    v_dot2c_f32_bf16 v22, v122, v25
    v_dot2c_f32_bf16 v23, v127, v25
    v_dot2c_f32_bf16 v16, v123, v26
    v_dot2c_f32_bf16 v17, v132, v26
    v_dot2c_f32_bf16 v18, v128, v26
    v_dot2c_f32_bf16 v19, v133, v26
    v_dot2c_f32_bf16 v20, v129, v26
    v_dot2c_f32_bf16 v21, v134, v26
    v_dot2c_f32_bf16 v22, v130, v26
    v_dot2c_f32_bf16 v23, v135, v26
    v_dot2c_f32_bf16 v16, v131, v27
    v_dot2c_f32_bf16 v17, v140, v27
    v_dot2c_f32_bf16 v18, v136, v27
    v_dot2c_f32_bf16 v19, v141, v27
    v_dot2c_f32_bf16 v20, v137, v27
    v_dot2c_f32_bf16 v21, v142, v27
    v_dot2c_f32_bf16 v22, v138, v27
    v_dot2c_f32_bf16 v23, v143, v27
    v_permlane32_swap_b32 v16, v20
    v_permlane32_swap_b32 v17, v21
    v_permlane32_swap_b32 v18, v22
    v_permlane32_swap_b32 v19, v23
    v_add_f32 v16, v16, v20
    v_add_f32 v17, v17, v21
    v_add_f32 v18, v18, v22
    v_add_f32 v19, v19, v23
    s_nop 0
    v_permlane16_swap_b32 v16, v18
    v_permlane16_swap_b32 v17, v19
    v_add_f32 v16, v16, v18
    v_add_f32 v17, v17, v19
    s_nop 0
    v_add_f32_dpp v16, v16, v16 row_ror:4 row_mask:0xf bank_mask:0xf
    v_add_f32_dpp v17, v17, v17 row_ror:4 row_mask:0xf bank_mask:0xf
    s_nop 0
    v_add_f32_dpp v16, v16, v16 row_ror:8 row_mask:0xf bank_mask:0xf
    v_add_f32_dpp v17, v17, v17 row_ror:8 row_mask:0xf bank_mask:0xf
    s_nop 0
    v_mov_b32_dpp v18, v16 quad_perm:[1,1,3,3] row_mask:0xf bank_mask:0xf
    v_mov_b32_dpp v19, v17 quad_perm:[1,1,3,3] row_mask:0xf bank_mask:0xf
    s_mov_b32 exec_lo, 0x50005
    s_mov_b32 exec_hi, 0x50005
    s_cmp_lg_u32 s88, 0
    s_cbranch_scc0 L_far_175
    buffer_store_dwordx4 v[16:19], v30, s[16:19], s55 offen
L_near_176:
    s_mov_b64 exec, -1
    s_cmp_lg_u32 s54, 0
    s_cbranch_scc1 L_nok_177
    s_cmp_lt_u32 s6, 128
    s_cbranch_scc1 L_nok_177
    s_add_u32 s53, s99, 0x0
    s_and_b32 s53, s53, 0x1fffff
    buffer_load_dwordx4 v[80:83], v2, s[8:11], s53 offen offset:0 nt
    buffer_load_dwordx4 v[84:87], v2, s[8:11], s53 offen offset:1024 nt
    buffer_load_dwordx4 v[88:91], v2, s[8:11], s53 offen offset:2048 nt
    buffer_load_dwordx4 v[92:95], v2, s[8:11], s53 offen offset:3072 nt
    s_add_u32 s53, s53, 0x1000
    buffer_load_dwordx4 v[96:99], v2, s[8:11], s53 offen offset:0 nt
    buffer_load_dwordx4 v[100:103], v2, s[8:11], s53 offen offset:1024 nt
    buffer_load_dwordx4 v[104:107], v2, s[8:11], s53 offen offset:2048 nt
    buffer_load_dwordx4 v[108:111], v2, s[8:11], s53 offen offset:3072 nt
    s_add_u32 s53, s99, 0x20000
    s_and_b32 s53, s53, 0x1fffff
    buffer_load_dwordx4 v[112:115], v2, s[8:11], s53 offen offset:0 nt
    buffer_load_dwordx4 v[116:119], v2, s[8:11], s53 offen offset:1024 nt
    buffer_load_dwordx4 v[120:123], v2, s[8:11], s53 offen offset:2048 nt
    buffer_load_dwordx4 v[124:127], v2, s[8:11], s53 offen offset:3072 nt
    s_add_u32 s53, s53, 0x1000
    buffer_load_dwordx4 v[128:131], v2, s[8:11], s53 offen offset:0 nt
    buffer_load_dwordx4 v[132:135], v2, s[8:11], s53 offen offset:1024 nt
    buffer_load_dwordx4 v[136:139], v2, s[8:11], s53 offen offset:2048 nt
    buffer_load_dwordx4 v[140:143], v2, s[8:11], s53 offen offset:3072 nt
L_nok_177:
L_gudone:
    s_cmp_ge_u32 s6, 128
    s_cbranch_scc1 L_noe3
    s_mul_i32 s67, s52, 14
    v_and_b32 v5, 15, v1
    v_min_u32 v4, 13, v5
    v_add_u32 v4, s67, v4
    s_lshr_b32 s66, s3, 5
    s_lshl_b32 s66, s66, 13
    s_add_u32 s66, s66, 0xc0000
    v_lshrrev_b32 v5, 3, v4
    v_lshlrev_b32 v5, 10, v5
    v_and_b32 v4, 7, v4
    v_lshl_add_u32 v4, v4, 4, v5
    v_lshrrev_b32 v5, 4, v1
    v_lshlrev_b32 v5, 8, v5
    v_add3_u32 v4, v4, v5, s66
    buffer_load_dwordx4 v[32:35], v4, s[16:19], s55 offen offset:0 sc1
    buffer_load_dwordx4 v[36:39], v4, s[16:19], s55 offen offset:128 sc1
    s_lshl_b32 s66, s52, 7
    v_lshlrev_b32 v12, 1, v1
    v_add_u32 v12, s66, v12
    s_lshl_b32 s66, s6, 7
    s_add_u32 s66, s66, 0x600000
    v_and_b32 v13, 7, v1
    v_lshlrev_b32 v13, 4, v13
    v_lshrrev_b32 v14, 3, v1
    v_mul_u32_u24 v14, 0x4100, v14
    v_add3_u32 v14, s66, v14, v13
    s_movk_i32 s5, 64
    s_branch L_pchk_179
L_poll_178:
    buffer_load_dwordx4 v[32:35], v4, s[16:19], s55 offen offset:0 sc1
    buffer_load_dwordx4 v[36:39], v4, s[16:19], s55 offen offset:128 sc1
L_pchk_179:
    s_waitcnt vmcnt(0)
    v_permlane32_swap_b32 v32, v34
    v_permlane32_swap_b32 v33, v35
    v_permlane32_swap_b32 v36, v38
    v_permlane32_swap_b32 v37, v39
    v_add_f32 v32, v32, v34
    v_add_f32 v33, v33, v35
    v_add_f32 v36, v36, v38
    v_add_f32 v37, v37, v39
    v_permlane16_swap_b32 v32, v33
    s_nop 0
    v_permlane16_swap_b32 v36, v37
    v_add_f32 v32, v32, v33
    v_add_f32 v36, v36, v37
    v_cmp_u_f32 vcc, v32, v36
    v_cvt_pk_bf16_f32 v5, v32, v36
    s_cbranch_vccz L_pdone_180
    s_sub_u32 s5, s5, 1
    s_cmp_lg_u32 s5, 0
    s_cbranch_scc1 L_nofl_181
    buffer_wbl2 sc1
    s_movk_i32 s5, 64
L_nofl_181:
    s_sub_u32 s56, s56, 1
    s_cmp_eq_u32 s56, 0
    s_cbranch_scc0 L_poll_178
    s_mov_b32 s56, 1
L_pdone_180:
    v_lshlrev_b32 v6, 16, v5
    v_and_b32 v7, s59, v5
    v_max_f32 v6, 0, v6
    v_mul_f32 v6, v6, v7
    v_mul_f32 v7, v6, 1.0
    s_nop 1
    v_permlane16_swap_b32 v6, v7
    v_cvt_pk_bf16_f32 v6, v6, v7
    v_mov_b32 v7, v6
    s_nop 1
    v_permlane32_swap_b32 v6, v7
    v_dot2_f32_bf16 v48, v3, v6, 0
    v_dot2_f32_bf16 v49, v100, v6, 0
    v_dot2_f32_bf16 v50, v96, v6, 0
    v_dot2_f32_bf16 v51, v101, v6, 0
    v_dot2_f32_bf16 v52, v97, v6, 0
    v_dot2_f32_bf16 v53, v102, v6, 0
    v_dot2_f32_bf16 v54, v98, v6, 0
    v_dot2_f32_bf16 v55, v103, v6, 0
    v_dot2c_f32_bf16 v48, v99, v7
    v_dot2c_f32_bf16 v49, v108, v7
    v_dot2c_f32_bf16 v50, v104, v7
    v_dot2c_f32_bf16 v51, v109, v7
    v_dot2c_f32_bf16 v52, v105, v7
    v_dot2c_f32_bf16 v53, v110, v7
    v_dot2c_f32_bf16 v54, v106, v7
    v_dot2c_f32_bf16 v55, v111, v7
    v_add_f32_dpp v48, v48, v48 row_ror:8 row_mask:0xf bank_mask:0x3
    v_add_f32_dpp v49, v49, v49 row_ror:8 row_mask:0xf bank_mask:0x3
    v_add_f32_dpp v50, v50, v50 row_ror:8 row_mask:0xf bank_mask:0x3
    v_add_f32_dpp v51, v51, v51 row_ror:8 row_mask:0xf bank_mask:0x3
    v_add_f32_dpp v48, v52, v52 row_ror:8 row_mask:0xf bank_mask:0xc
    v_add_f32_dpp v49, v53, v53 row_ror:8 row_mask:0xf bank_mask:0xc
    v_add_f32_dpp v50, v54, v54 row_ror:8 row_mask:0xf bank_mask:0xc
    v_add_f32_dpp v51, v55, v55 row_ror:8 row_mask:0xf bank_mask:0xc
    v_add_f32_dpp v48, v48, v48 row_half_mirror row_mask:0xf bank_mask:0x5
    v_add_f32_dpp v49, v49, v49 row_half_mirror row_mask:0xf bank_mask:0x5
    s_nop 0
    v_add_f32_dpp v48, v50, v50 row_half_mirror row_mask:0xf bank_mask:0xa
    v_add_f32_dpp v49, v51, v51 row_half_mirror row_mask:0xf bank_mask:0xa
    s_nop 0
    v_add_f32_dpp v48, v48, v48 quad_perm:[1,0,3,2] row_mask:0xf bank_mask:0xf
    v_add_f32_dpp v49, v49, v49 quad_perm:[1,0,3,2] row_mask:0xf bank_mask:0xf
    s_nop 0
    v_add_f32_dpp v48, v48, v48 quad_perm:[2,3,0,1] row_mask:0xf bank_mask:0xf
    v_add_f32_dpp v49, v49, v49 quad_perm:[2,3,0,1] row_mask:0xf bank_mask:0xf
    s_mov_b32 exec_lo, 0x11111111
    s_mov_b32 exec_hi, 0x11111111
    ds_write_b64 v12, v[48:49] offset:8832
    s_mov_b64 exec, -1
    s_waitcnt lgkmcnt(0)
    s_barrier
    s_cmp_lg_u32 s52, 0
    s_cbranch_scc1 L_nopub_182
    ds_read_b128 v[32:35], v13 offset:8832
    ds_read_b128 v[36:39], v13 offset:8960
    ds_read_b128 v[40:43], v13 offset:9088
    ds_read_b128 v[44:47], v13 offset:9216
    s_waitcnt lgkmcnt(2)
    v_pk_add_f32 v[32:33], v[32:33], v[36:37]
    v_pk_add_f32 v[34:35], v[34:35], v[38:39]
    s_waitcnt lgkmcnt(0)
    v_pk_add_f32 v[40:41], v[40:41], v[44:45]
    v_pk_add_f32 v[42:43], v[42:43], v[46:47]
    v_pk_add_f32 v[32:33], v[32:33], v[40:41]
    v_pk_add_f32 v[34:35], v[34:35], v[42:43]
    buffer_store_dwordx4 v[32:35], v14, s[16:19], s55 offen sc1
    s_mov_b64 exec, -1
L_nopub_182:
    s_cmp_ge_u32 s52, 2
    s_cbranch_scc1 L_e3w23
    s_cmp_lg_u32 s54, 0
    s_cbranch_scc1 L_nok_183
    s_add_u32 s53, s99, 0x0
    s_and_b32 s53, s53, 0x1fffff
    buffer_load_dwordx4 v[80:83], v2, s[8:11], s53 offen offset:0 nt
    buffer_load_dwordx4 v[84:87], v2, s[8:11], s53 offen offset:1024 nt
    buffer_load_dwordx4 v[88:91], v2, s[8:11], s53 offen offset:2048 nt
    buffer_load_dwordx4 v[92:95], v2, s[8:11], s53 offen offset:3072 nt
    s_add_u32 s53, s53, 0x1000
    buffer_load_dwordx4 v[96:99], v2, s[8:11], s53 offen offset:0 nt
    buffer_load_dwordx4 v[100:103], v2, s[8:11], s53 offen offset:1024 nt
    buffer_load_dwordx4 v[104:107], v2, s[8:11], s53 offen offset:2048 nt
    buffer_load_dwordx4 v[108:111], v2, s[8:11], s53 offen offset:3072 nt
    s_add_u32 s53, s99, 0x20000
    s_and_b32 s53, s53, 0x1fffff
    buffer_load_dwordx4 v[112:115], v2, s[8:11], s53 offen offset:0 nt
    buffer_load_dwordx4 v[116:119], v2, s[8:11], s53 offen offset:1024 nt
    buffer_load_dwordx4 v[120:123], v2, s[8:11], s53 offen offset:2048 nt
    buffer_load_dwordx4 v[124:127], v2, s[8:11], s53 offen offset:3072 nt
    s_add_u32 s53, s53, 0x1000
    buffer_load_dwordx4 v[128:131], v2, s[8:11], s53 offen offset:0 nt
    buffer_load_dwordx4 v[132:135], v2, s[8:11], s53 offen offset:1024 nt
    buffer_load_dwordx4 v[136:139], v2, s[8:11], s53 offen offset:2048 nt
    buffer_load_dwordx4 v[140:143], v2, s[8:11], s53 offen offset:3072 nt
L_nok_183:
    s_branch L_noe3
L_e3w23:
    s_cmp_lg_u32 s54, 0
    s_cbranch_scc1 L_nok_184
L_nok_184:
L_noe3:
    s_cmp_lg_u32 s54, 0
    s_cbranch_scc1 L_final
    s_cmp_lt_u32 s52, 2
    s_cbranch_scc1 L_e4a
    s_lshl_b32 s66, s52, 10
    s_sub_u32 s66, s66, 2048
    v_lshlrev_b32 v4, 4, v1
    v_add_u32 v4, s66, v4
    s_lshr_b32 s66, s3, 5
    s_mul_i32 s66, s66, 0x4100
    s_add_u32 s66, s66, 0x600000
    v_add_u32 v5, s66, v4
    buffer_load_dwordx4 v[48:51], v5, s[16:19], s55 offen offset:0 sc1
    buffer_load_dwordx4 v[52:55], v5, s[16:19], s55 offen offset:2048 sc1
    s_add_u32 s53, s55, 0x1000
    buffer_load_dwordx4 v[56:59], v5, s[16:19], s53 offen offset:0 sc1
    buffer_load_dwordx4 v[60:63], v5, s[16:19], s53 offen offset:2048 sc1
    s_add_u32 s53, s55, 0x2000
    buffer_load_dwordx4 v[64:67], v5, s[16:19], s53 offen offset:0 sc1
    buffer_load_dwordx4 v[68:71], v5, s[16:19], s53 offen offset:2048 sc1
    s_add_u32 s53, s55, 0x3000
    buffer_load_dwordx4 v[72:75], v5, s[16:19], s53 offen offset:0 sc1
    buffer_load_dwordx4 v[76:79], v5, s[16:19], s53 offen offset:2048 sc1
    ds_read_b128 v[12:15], v4 offset:10496
    s_movk_i32 s5, 64
    s_branch L_pchk_186
L_poll_185:
    buffer_load_dwordx4 v[48:51], v5, s[16:19], s55 offen offset:0 sc1
    buffer_load_dwordx4 v[52:55], v5, s[16:19], s55 offen offset:2048 sc1
    s_add_u32 s53, s55, 0x1000
    buffer_load_dwordx4 v[56:59], v5, s[16:19], s53 offen offset:0 sc1
    buffer_load_dwordx4 v[60:63], v5, s[16:19], s53 offen offset:2048 sc1
    s_add_u32 s53, s55, 0x2000
    buffer_load_dwordx4 v[64:67], v5, s[16:19], s53 offen offset:0 sc1
    buffer_load_dwordx4 v[68:71], v5, s[16:19], s53 offen offset:2048 sc1
    s_add_u32 s53, s55, 0x3000
    buffer_load_dwordx4 v[72:75], v5, s[16:19], s53 offen offset:0 sc1
    buffer_load_dwordx4 v[76:79], v5, s[16:19], s53 offen offset:2048 sc1
L_pchk_186:
    s_waitcnt vmcnt(0) lgkmcnt(0)
    v_pk_add_f32 v[48:49], v[48:49], v[52:53]
    v_pk_add_f32 v[50:51], v[50:51], v[54:55]
    v_pk_add_f32 v[56:57], v[56:57], v[60:61]
    v_pk_add_f32 v[58:59], v[58:59], v[62:63]
    v_pk_add_f32 v[64:65], v[64:65], v[68:69]
    v_pk_add_f32 v[66:67], v[66:67], v[70:71]
    v_pk_add_f32 v[72:73], v[72:73], v[76:77]
    v_pk_add_f32 v[74:75], v[74:75], v[78:79]
    v_pk_add_f32 v[48:49], v[48:49], v[56:57]
    v_pk_add_f32 v[50:51], v[50:51], v[58:59]
    v_pk_add_f32 v[64:65], v[64:65], v[72:73]
    v_pk_add_f32 v[66:67], v[66:67], v[74:75]
    v_pk_add_f32 v[48:49], v[48:49], v[64:65]
    v_pk_add_f32 v[50:51], v[50:51], v[66:67]
    v_cmp_u_f32 vcc, v48, v49
    v_cmp_u_f32 s[0:1], v50, v51
    v_cvt_pk_bf16_f32 v6, v48, v49
    v_cvt_pk_bf16_f32 v7, v50, v51
    s_or_b64 vcc, vcc, s[0:1]
    s_cbranch_scc0 L_pdone_187
    s_sub_u32 s5, s5, 1
    s_cmp_lg_u32 s5, 0
    s_cbranch_scc1 L_nofl_188
    buffer_wbl2 sc1
    s_movk_i32 s5, 64
L_nofl_188:
    s_mov_b64 exec, vcc
    s_sub_u32 s56, s56, 1
    s_cmp_eq_u32 s56, 0
    s_cbranch_scc0 L_poll_185
    s_mov_b32 s56, 1
L_pdone_187:
    s_mov_b64 exec, -1
    v_lshlrev_b32 v48, 16, v6
    v_and_b32 v49, s59, v6
    v_lshlrev_b32 v50, 16, v7
    v_and_b32 v51, s59, v7
    v_pk_add_f32 v[12:13], v[12:13], v[48:49]
    v_pk_add_f32 v[14:15], v[14:15], v[50:51]
    v_cvt_pk_bf16_f32 v6, v12, v13
    v_cvt_pk_bf16_f32 v7, v14, v15
    v_lshlrev_b32 v12, 16, v6
    v_and_b32 v13, s59, v6
    v_lshlrev_b32 v14, 16, v7
    v_and_b32 v15, s59, v7
    ds_write_b128 v4, v[12:15] offset:10496
    s_waitcnt lgkmcnt(0)
    s_barrier
    ds_read2st64_b32 v[32:33], v28 offset0:41 offset1:42
    ds_read2st64_b32 v[34:35], v28 offset0:43 offset1:44
    ds_read2st64_b32 v[36:37], v28 offset0:45 offset1:46
    ds_read2st64_b32 v[38:39], v28 offset0:47 offset1:48
    ds_read2_b32 v[40:41], v29 offset0:0 offset1:16
    ds_read2_b32 v[42:43], v29 offset0:32 offset1:48
    ds_read2_b32 v[44:45], v29 offset0:64 offset1:80
    ds_read2_b32 v[46:47], v29 offset0:96 offset1:112
    s_waitcnt lgkmcnt(4)
    v_readfirstlane_b32 s0, v32
    s_nop 1
    v_pk_add_f32 v[32:33], v[32:33], s[0:1] op_sel_hi:[1,0] neg_lo:[0,1] neg_hi:[0,1]
    v_pk_add_f32 v[34:35], v[34:35], s[0:1] op_sel_hi:[1,0] neg_lo:[0,1] neg_hi:[0,1]
    v_pk_add_f32 v[36:37], v[36:37], s[0:1] op_sel_hi:[1,0] neg_lo:[0,1] neg_hi:[0,1]
    v_pk_add_f32 v[38:39], v[38:39], s[0:1] op_sel_hi:[1,0] neg_lo:[0,1] neg_hi:[0,1]
    v_pk_mul_f32 v[48:49], v[32:33], v[32:33]
    v_pk_add_f32 v[50:51], v[32:33], v[34:35]
    v_pk_fma_f32 v[48:49], v[34:35], v[34:35], v[48:49]
    v_pk_add_f32 v[32:33], v[36:37], v[38:39]
    v_pk_fma_f32 v[48:49], v[36:37], v[36:37], v[48:49]
    v_pk_add_f32 v[50:51], v[50:51], v[32:33]
    v_pk_fma_f32 v[48:49], v[38:39], v[38:39], v[48:49]
    v_add_f32 v4, v50, v51
    v_add_f32 v5, v48, v49
    s_nop 0
    v_add_f32_dpp v4, v4, v4 quad_perm:[1,0,3,2] row_mask:0xf bank_mask:0xf
    v_add_f32_dpp v5, v5, v5 quad_perm:[1,0,3,2] row_mask:0xf bank_mask:0xf
    s_nop 0
    v_add_f32_dpp v4, v4, v4 quad_perm:[2,3,0,1] row_mask:0xf bank_mask:0xf
    v_add_f32_dpp v5, v5, v5 quad_perm:[2,3,0,1] row_mask:0xf bank_mask:0xf
    s_nop 0
    v_add_f32_dpp v4, v4, v4 row_ror:4 row_mask:0xf bank_mask:0xf
    v_add_f32_dpp v5, v5, v5 row_ror:4 row_mask:0xf bank_mask:0xf
    s_nop 0
    v_add_f32_dpp v4, v4, v4 row_ror:8 row_mask:0xf bank_mask:0xf
    v_add_f32_dpp v5, v5, v5 row_ror:8 row_mask:0xf bank_mask:0xf
    s_nop 0
    v_add_f32_dpp v4, v4, v4 row_bcast:15 row_mask:0xa bank_mask:0xf
    v_add_f32_dpp v5, v5, v5 row_bcast:15 row_mask:0xa bank_mask:0xf
    s_nop 0
    v_add_f32_dpp v4, v4, v4 row_bcast:31 row_mask:0xc bank_mask:0xf
    v_add_f32_dpp v5, v5, v5 row_bcast:31 row_mask:0xc bank_mask:0xf
    v_mul_f32 v4, 0x3b000000, v4
    v_mul_f32 v5, 0x3b000000, v5
    v_fma_f32 v5, -v4, v4, v5
    v_add_f32 v4, s0, v4
    v_max_f32 v5, 0, v5
    v_cvt_pk_bf16_f32 v6, v4, v5
    v_lshlrev_b32 v4, 16, v6
    v_and_b32 v5, s59, v6
    v_add_f32 v5, 0x3727c5ac, v5
    v_readlane_b32 s62, v4, 63
    v_cvt_pk_bf16_f32 v5, v5, v5
    v_lshlrev_b32 v5, 16, v5
    v_sqrt_f32 v5, v5
    s_waitcnt lgkmcnt(0)
    v_pk_add_f32 v[40:41], v[40:41], s[62:63] op_sel_hi:[1,0] neg_lo:[0,1] neg_hi:[0,1]
    v_pk_add_f32 v[42:43], v[42:43], s[62:63] op_sel_hi:[1,0] neg_lo:[0,1] neg_hi:[0,1]
    v_pk_add_f32 v[44:45], v[44:45], s[62:63] op_sel_hi:[1,0] neg_lo:[0,1] neg_hi:[0,1]
    v_pk_add_f32 v[46:47], v[46:47], s[62:63] op_sel_hi:[1,0] neg_lo:[0,1] neg_hi:[0,1]
    v_cvt_pk_bf16_f32 v5, v5, v5
    v_lshlrev_b32 v5, 16, v5
    v_rcp_f32 v6, v5
    v_cvt_pk_bf16_f32 v24, v40, v41
    v_cvt_pk_bf16_f32 v25, v42, v43
    v_cvt_pk_bf16_f32 v26, v44, v45
    v_cvt_pk_bf16_f32 v27, v46, v47
    v_readlane_b32 s64, v5, 63
    v_readlane_b32 s0, v6, 63
    v_lshlrev_b32 v40, 16, v24
    v_and_b32 v41, s59, v24
    v_lshlrev_b32 v42, 16, v25
    v_and_b32 v43, s59, v25
    v_lshlrev_b32 v44, 16, v26
    v_and_b32 v45, s59, v26
    v_lshlrev_b32 v46, 16, v27
    v_and_b32 v47, s59, v27
    v_pk_mul_f32 v[32:33], v[40:41], s[0:1] op_sel_hi:[1,0]
    v_pk_mul_f32 v[34:35], v[42:43], s[0:1] op_sel_hi:[1,0]
    v_pk_mul_f32 v[36:37], v[44:45], s[0:1] op_sel_hi:[1,0]
    v_pk_mul_f32 v[38:39], v[46:47], s[0:1] op_sel_hi:[1,0]
    v_pk_fma_f32 v[40:41], v[32:33], s[64:65], v[40:41] op_sel_hi:[1,0,1] neg_lo:[1,0,0] neg_hi:[1,0,0]
    v_pk_fma_f32 v[42:43], v[34:35], s[64:65], v[42:43] op_sel_hi:[1,0,1] neg_lo:[1,0,0] neg_hi:[1,0,0]
    v_pk_fma_f32 v[44:45], v[36:37], s[64:65], v[44:45] op_sel_hi:[1,0,1] neg_lo:[1,0,0] neg_hi:[1,0,0]
    v_pk_fma_f32 v[46:47], v[38:39], s[64:65], v[46:47] op_sel_hi:[1,0,1] neg_lo:[1,0,0] neg_hi:[1,0,0]
    v_pk_fma_f32 v[32:33], v[40:41], s[0:1], v[32:33] op_sel_hi:[1,0,1]
    v_pk_fma_f32 v[34:35], v[42:43], s[0:1], v[34:35] op_sel_hi:[1,0,1]
    v_pk_fma_f32 v[36:37], v[44:45], s[0:1], v[36:37] op_sel_hi:[1,0,1]
    v_pk_fma_f32 v[38:39], v[46:47], s[0:1], v[38:39] op_sel_hi:[1,0,1]
    v_cvt_pk_bf16_f32 v24, v32, v33
    v_cvt_pk_bf16_f32 v25, v34, v35
    v_cvt_pk_bf16_f32 v26, v36, v37
    v_cvt_pk_bf16_f32 v27, v38, v39
    v_dot2_f32_bf16 v16, v10, v24, 0
    v_dot2_f32_bf16 v17, v116, v24, 0
    v_dot2_f32_bf16 v18, v112, v24, 0
    v_dot2_f32_bf16 v19, v117, v24, 0
    v_dot2_f32_bf16 v20, v113, v24, 0
    v_dot2_f32_bf16 v21, v118, v24, 0
    v_dot2_f32_bf16 v22, v114, v24, 0
    v_dot2_f32_bf16 v23, v119, v24, 0
    v_dot2c_f32_bf16 v16, v115, v25
    v_dot2c_f32_bf16 v17, v124, v25
    v_dot2c_f32_bf16 v18, v120, v25
    v_dot2c_f32_bf16 v19, v125, v25
    v_dot2c_f32_bf16 v20, v121, v25
    v_dot2c_f32_bf16 v21, v126, v25
    v_dot2c_f32_bf16 v22, v122, v25
    v_dot2c_f32_bf16 v23, v127, v25
    v_dot2c_f32_bf16 v16, v123, v26
    v_dot2c_f32_bf16 v17, v132, v26
    v_dot2c_f32_bf16 v18, v128, v26
    v_dot2c_f32_bf16 v19, v133, v26
    v_dot2c_f32_bf16 v20, v129, v26
    v_dot2c_f32_bf16 v21, v134, v26
    v_dot2c_f32_bf16 v22, v130, v26
    v_dot2c_f32_bf16 v23, v135, v26
    v_dot2c_f32_bf16 v16, v131, v27
    v_dot2c_f32_bf16 v17, v140, v27
    v_dot2c_f32_bf16 v18, v136, v27
    v_dot2c_f32_bf16 v19, v141, v27
    v_dot2c_f32_bf16 v20, v137, v27
    v_dot2c_f32_bf16 v21, v142, v27
    v_dot2c_f32_bf16 v22, v138, v27
    v_dot2c_f32_bf16 v23, v143, v27
    v_permlane32_swap_b32 v16, v20
    v_permlane32_swap_b32 v17, v21
    v_permlane32_swap_b32 v18, v22
    v_permlane32_swap_b32 v19, v23
    v_add_f32 v16, v16, v20
    v_add_f32 v17, v17, v21
    v_add_f32 v18, v18, v22
    v_add_f32 v19, v19, v23
    s_nop 0
    v_permlane16_swap_b32 v16, v18
    v_permlane16_swap_b32 v17, v19
    v_add_f32 v16, v16, v18
    v_add_f32 v17, v17, v19
    s_nop 0
    v_add_f32_dpp v16, v16, v16 row_ror:4 row_mask:0xf bank_mask:0xf
    v_add_f32_dpp v17, v17, v17 row_ror:4 row_mask:0xf bank_mask:0xf
    s_nop 0
    v_add_f32_dpp v16, v16, v16 row_ror:8 row_mask:0xf bank_mask:0xf
    v_add_f32_dpp v17, v17, v17 row_ror:8 row_mask:0xf bank_mask:0xf
    s_nop 0
    v_mov_b32_dpp v18, v16 quad_perm:[1,1,3,3] row_mask:0xf bank_mask:0xf
    v_mov_b32_dpp v19, v17 quad_perm:[1,1,3,3] row_mask:0xf bank_mask:0xf
    s_mov_b32 exec_lo, 0x50005
    s_mov_b32 exec_hi, 0x50005
    s_cmp_lg_u32 s88, 0
    s_cbranch_scc0 L_far_189
    buffer_store_dwordx4 v[16:19], v30, s[16:19], s61 offen
L_near_190:
    s_mov_b64 exec, -1
    s_mov_b32 s42, 0
    s_cmp_lg_u32 s54, 0
    s_cbranch_scc1 L_nok_191
    s_cmp_ge_u32 s6, 128
    s_cbranch_scc1 L_nok_191
    s_add_u32 s53, s99, 0x0
    s_and_b32 s53, s53, 0x1fffff
    buffer_load_dwordx4 v[80:83], v2, s[8:11], s53 offen offset:0 nt
    buffer_load_dwordx4 v[84:87], v2, s[8:11], s53 offen offset:1024 nt
    buffer_load_dwordx4 v[88:91], v2, s[8:11], s53 offen offset:2048 nt
    buffer_load_dwordx4 v[92:95], v2, s[8:11], s53 offen offset:3072 nt
    s_add_u32 s53, s53, 0x1000
    buffer_load_dwordx4 v[96:99], v2, s[8:11], s53 offen offset:0 nt
    buffer_load_dwordx4 v[100:103], v2, s[8:11], s53 offen offset:1024 nt
    buffer_load_dwordx4 v[104:107], v2, s[8:11], s53 offen offset:2048 nt
    buffer_load_dwordx4 v[108:111], v2, s[8:11], s53 offen offset:3072 nt
L_nok_191:
    s_add_u32 s53, s99, 0x20000
    s_and_b32 s53, s53, 0x1fffff
    buffer_load_dwordx4 v[112:115], v2, s[8:11], s53 offen offset:0 nt
    buffer_load_dwordx4 v[116:119], v2, s[8:11], s53 offen offset:1024 nt
    buffer_load_dwordx4 v[120:123], v2, s[8:11], s53 offen offset:2048 nt
    buffer_load_dwordx4 v[124:127], v2, s[8:11], s53 offen offset:3072 nt
    s_add_u32 s53, s53, 0x1000
    buffer_load_dwordx4 v[128:131], v2, s[8:11], s53 offen offset:0 nt
    buffer_load_dwordx4 v[132:135], v2, s[8:11], s53 offen offset:1024 nt
    buffer_load_dwordx4 v[136:139], v2, s[8:11], s53 offen offset:2048 nt
    buffer_load_dwordx4 v[140:143], v2, s[8:11], s53 offen offset:3072 nt
    s_branch L_e5done
L_e4a:
    s_lshr_b32 s66, s3, 5
    s_lshl_b32 s66, s66, 13
    s_lshl_b32 s67, s52, 12
    s_add_u32 s66, s66, s67
    s_add_u32 s66, s66, 0xb0000
    v_lshlrev_b32 v4, 4, v1
    v_add_u32 v4, s66, v4
    v_bfe_u32 v6, v1, 1, 2
    v_lshlrev_b32 v6, 2, v6
    v_lshrrev_b32 v7, 5, v1
    v_lshl_add_u32 v6, v7, 7, v6
    v_bfe_u32 v7, v1, 4, 1
    v_lshl_add_u32 v6, v7, 4, v6
    v_bfe_u32 v7, v1, 3, 1
    v_lshl_add_u32 v6, v7, 6, v6
    v_and_b32 v7, 1, v1
    v_lshl_add_u32 v6, v7, 5, v6
    s_lshl_b32 s66, s52, 9
    v_add_u32 v6, s66, v6
    s_movk_i32 s5, 64
    s_barrier
L_poll_192:
    buffer_load_dwordx4 v[32:35], v4, s[16:19], s61 offen offset:0 sc1
    buffer_load_dwordx4 v[36:39], v4, s[16:19], s61 offen offset:1024 sc1
    buffer_load_dwordx4 v[40:43], v4, s[16:19], s61 offen offset:2048 sc1
    buffer_load_dwordx4 v[44:47], v4, s[16:19], s61 offen offset:3072 sc1
    s_waitcnt vmcnt(0)
    v_permlane32_swap_b32 v32, v36
    v_permlane32_swap_b32 v33, v37
    v_permlane32_swap_b32 v34, v38
    v_permlane32_swap_b32 v35, v39
    v_permlane32_swap_b32 v40, v44
    v_permlane32_swap_b32 v41, v45
    v_permlane32_swap_b32 v42, v46
    v_permlane32_swap_b32 v43, v47
    v_add_f32 v32, v32, v36
    v_add_f32 v33, v33, v37
    v_add_f32 v34, v34, v38
    v_add_f32 v35, v35, v39
    v_add_f32 v40, v40, v44
    v_add_f32 v41, v41, v45
    v_add_f32 v42, v42, v46
    v_add_f32 v43, v43, v47
    v_permlane16_swap_b32 v32, v34
    v_permlane16_swap_b32 v33, v35
    v_permlane16_swap_b32 v40, v42
    v_permlane16_swap_b32 v41, v43
    v_add_f32 v32, v32, v34
    v_add_f32 v33, v33, v35
    v_add_f32 v40, v40, v42
    v_add_f32 v41, v41, v43
    v_cmp_u_f32 vcc, v32, v33
    v_cmp_u_f32 s[0:1], v40, v41
    v_cvt_pk_bf16_f32 v5, v32, v33
    v_cvt_pk_bf16_f32 v7, v40, v41
    s_or_b64 vcc, vcc, s[0:1]
    s_cbranch_scc0 L_pdone_193
    s_sub_u32 s5, s5, 1
    s_cmp_lg_u32 s5, 0
    s_cbranch_scc1 L_nofl_194
    buffer_wbl2 sc1
    s_movk_i32 s5, 64
L_nofl_194:
    s_sub_u32 s56, s56, 1
    s_cmp_eq_u32 s56, 0
    s_cbranch_scc0 L_poll_192
    s_mov_b32 s56, 1
L_pdone_193:
    ds_write2st64_b32 v6, v5, v7 offset0:37 offset1:38
L_e5done:
    v_and_b32 v7, 3, v1
    v_lshlrev_b32 v7, 8, v7
    v_and_b32 v8, 0x3c, v1
    v_lshl_add_u32 v7, v8, 2, v7
    s_waitcnt lgkmcnt(0)
    s_barrier
    ds_read_b128 v[12:15], v7 offset:9472
    s_waitcnt lgkmcnt(0)
    s_mov_b32 s54, 1
    s_mov_b32 s55, 0x100000
    s_branch L_pass
L_final:
    s_cmp_lg_u32 s2, 0
    s_cbranch_scc1 L_confirm
    s_lshl_b32 s66, s52, 9
    v_and_b32 v4, 31, v1
    v_lshlrev_b32 v4, 4, v4
    v_add_u32 v4, s66, v4
    v_lshrrev_b32 v6, 5, v1
    v_mul_u32_u24 v7, 0x2000, v6
    s_lshr_b32 s66, s3, 5
    s_mul_i32 s66, s66, 0x4100
    s_add_u32 s66, s66, 0x600000
    v_add3_u32 v5, s66, v4, v7
    buffer_load_dwordx4 v[48:51], v5, s[16:19], s55 offen offset:0 sc1
    buffer_load_dwordx4 v[52:55], v5, s[16:19], s55 offen offset:2048 sc1
    s_add_u32 s53, s55, 0x1000
    buffer_load_dwordx4 v[56:59], v5, s[16:19], s53 offen offset:0 sc1
    buffer_load_dwordx4 v[60:63], v5, s[16:19], s53 offen offset:2048 sc1
    v_lshl_add_u32 v4, v6, 3, v4
    ds_read_b64 v[12:13], v4 offset:10496
    s_movk_i32 s5, 64
    s_branch L_pchk_196
L_poll_195:
    buffer_load_dwordx4 v[48:51], v5, s[16:19], s55 offen offset:0 sc1
    buffer_load_dwordx4 v[52:55], v5, s[16:19], s55 offen offset:2048 sc1
    s_add_u32 s53, s55, 0x1000
    buffer_load_dwordx4 v[56:59], v5, s[16:19], s53 offen offset:0 sc1
    buffer_load_dwordx4 v[60:63], v5, s[16:19], s53 offen offset:2048 sc1
L_pchk_196:
    s_waitcnt vmcnt(0) lgkmcnt(0)
    v_pk_add_f32 v[48:49], v[48:49], v[52:53]
    v_pk_add_f32 v[50:51], v[50:51], v[54:55]
    v_pk_add_f32 v[56:57], v[56:57], v[60:61]
    v_pk_add_f32 v[58:59], v[58:59], v[62:63]
    v_pk_add_f32 v[48:49], v[48:49], v[56:57]
    v_pk_add_f32 v[50:51], v[50:51], v[58:59]
    s_nop 1
    v_permlane32_swap_b32 v48, v50
    v_permlane32_swap_b32 v49, v51
    v_add_f32 v48, v48, v50
    v_add_f32 v49, v49, v51
    v_cmp_u_f32 vcc, v48, v49
    v_cvt_pk_bf16_f32 v6, v48, v49
    s_cbranch_vccz L_pdone_197
    s_sub_u32 s5, s5, 1
    s_cmp_lg_u32 s5, 0
    s_cbranch_scc1 L_nofl_198
    buffer_wbl2 sc1
    s_movk_i32 s5, 64
L_nofl_198:
    s_or_b32 exec_lo, vcc_lo, vcc_hi
    s_mov_b32 exec_hi, exec_lo
    s_sub_u32 s56, s56, 1
    s_cmp_eq_u32 s56, 0
    s_cbranch_scc0 L_poll_195
    s_mov_b32 s56, 1
L_pdone_197:
    s_mov_b64 exec, -1
    v_lshlrev_b32 v48, 16, v6
    v_and_b32 v49, s59, v6
    v_pk_add_f32 v[12:13], v[12:13], v[48:49]
    v_cvt_pk_bf16_f32 v6, v12, v13
    v_lshrrev_b32 v4, 1, v4
    buffer_store_dword v6, v4, s[44:47], 0 offen
    s_waitcnt vmcnt(0)
    s_branch L_dump
L_confirm:
    s_branch L_dump
    s_cmp_lg_u32 s52, 1
    s_cbranch_scc1 L_dump
    s_lshr_b32 s66, s3, 5
    s_lshl_b32 s66, s66, 11
    s_add_u32 s66, s66, 0x600000
    v_and_b32 v4, 15, v1
    v_lshlrev_b32 v4, 7, v4
    v_add_u32 v4, s66, v4
    s_movk_i32 s5, 64
L_poll_199:
    buffer_load_dword v5, v4, s[16:19], s55 offen sc1
    s_waitcnt vmcnt(0)
    v_cmp_eq_u32 vcc, -1, v5
    s_cbranch_vccz L_pdone_200
    s_sub_u32 s5, s5, 1
    s_cmp_lg_u32 s5, 0
    s_cbranch_scc1 L_nofl_201
    buffer_wbl2 sc1
    s_movk_i32 s5, 64
L_nofl_201:
    s_sub_u32 s56, s56, 1
    s_cmp_eq_u32 s56, 0
    s_cbranch_scc0 L_poll_199
    s_mov_b32 s56, 1
L_pdone_200:
L_dump:
L_exit:
    s_endpgm
    M_CSUBS_
L_xc_1:
    M_CALL 0, L_sub_ev80
    s_cbranch_scc1 L_xo_3
    s_branch L_xcb_2
L_xc_4:
    M_CALL 512, L_sub_ev112
    s_cbranch_scc1 L_xo_6
    s_branch L_xcb_5
L_xc_7:
    M_CALL 1024, L_sub_ev80
    s_cbranch_scc1 L_xo_9
    s_branch L_xcb_8
L_xc_10:
    M_CALL 1536, L_sub_ev112
    s_cbranch_scc1 L_xo_12
    s_branch L_xcb_11
L_xc_13:
    M_CALL 2048, L_sub_ev80
    s_cbranch_scc1 L_xo_15
    s_branch L_xcb_14
L_xc_16:
    M_CALL 2560, L_sub_ev112
    s_cbranch_scc1 L_xo_18
    s_branch L_xcb_17
L_xc_19:
    M_CALL 3072, L_sub_ev80
    s_cbranch_scc1 L_xo_21
    s_branch L_xcb_20
L_xc_22:
    M_CALL 3584, L_sub_ev112
    s_cbranch_scc1 L_xo_24
    s_branch L_xcb_23
L_xc_25:
    M_CALL 4096, L_sub_ev80
    s_cbranch_scc1 L_xo_27
    s_branch L_xcb_26
L_xc_32:
    M_CALL 8192, L_sub_ek112
    s_cbranch_scc1 L_xo_34
    s_branch L_xcb_33
L_xp_35:
    M_CALL 8192, L_sub_pk
    s_branch L_xpb_36
L_xp_37:
    M_CALL 8256, L_sub_pk
    s_branch L_xpb_38
L_xp_39:
    M_CALL 8320, L_sub_pk
    s_branch L_xpb_40
L_xp_41:
    M_CALL 8384, L_sub_pk
    s_branch L_xpb_42
L_xp_43:
    M_CALL 8448, L_sub_pk
    s_branch L_xpb_44
L_xp_45:
    M_CALL 8512, L_sub_pk
    s_branch L_xpb_46
L_xp_47:
    M_CALL 8576, L_sub_pk
    s_branch L_xpb_48
L_xp_49:
    M_CALL 8640, L_sub_pk
    s_branch L_xpb_50
L_xp_51:
    M_CALL 0, L_sub_pv
    s_branch L_xpb_52
L_xp_53:
    M_CALL 64, L_sub_pv
    s_branch L_xpb_54
L_xp_55:
    M_CALL 128, L_sub_pv
    s_branch L_xpb_56
L_xp_57:
    M_CALL 192, L_sub_pv
    s_branch L_xpb_58
L_xp_59:
    M_CALL 512, L_sub_pv
    s_branch L_xpb_60
L_xp_61:
    M_CALL 576, L_sub_pv
    s_branch L_xpb_62
L_xp_63:
    M_CALL 640, L_sub_pv
    s_branch L_xpb_64
L_xp_65:
    M_CALL 704, L_sub_pv
    s_branch L_xpb_66
L_xp_67:
    M_CALL 1024, L_sub_pv
    s_branch L_xpb_68
L_xp_69:
    M_CALL 1088, L_sub_pv
    s_branch L_xpb_70
L_xp_71:
    M_CALL 1152, L_sub_pv
    s_branch L_xpb_72
L_xp_73:
    M_CALL 1216, L_sub_pv
    s_branch L_xpb_74
L_xc_75:
    M_CALL 8704, L_sub_ek112
    s_cbranch_scc1 L_xo_77
    s_branch L_xcb_76
L_xp_78:
    M_CALL 8704, L_sub_pk
    s_branch L_xpb_79
L_xp_80:
    M_CALL 8768, L_sub_pk
    s_branch L_xpb_81
L_xp_82:
    M_CALL 8832, L_sub_pk
    s_branch L_xpb_83
L_xp_84:
    M_CALL 8896, L_sub_pk
    s_branch L_xpb_85
L_xp_86:
    M_CALL 8960, L_sub_pk
    s_branch L_xpb_87
L_xp_88:
    M_CALL 9024, L_sub_pk
    s_branch L_xpb_89
L_xp_90:
    M_CALL 9088, L_sub_pk
    s_branch L_xpb_91
L_xp_92:
    M_CALL 9152, L_sub_pk
    s_branch L_xpb_93
L_xp_94:
    M_CALL 1536, L_sub_pv
    s_branch L_xpb_95
L_xp_96:
    M_CALL 1600, L_sub_pv
    s_branch L_xpb_97
L_xp_98:
    M_CALL 1664, L_sub_pv
    s_branch L_xpb_99
L_xp_100:
    M_CALL 1728, L_sub_pv
    s_branch L_xpb_101
L_xp_102:
    M_CALL 2048, L_sub_pv
    s_branch L_xpb_103
L_xp_104:
    M_CALL 2112, L_sub_pv
    s_branch L_xpb_105
L_xp_106:
    M_CALL 2176, L_sub_pv
    s_branch L_xpb_107
L_xp_108:
    M_CALL 2240, L_sub_pv
    s_branch L_xpb_109
L_xp_110:
    M_CALL 2560, L_sub_pv
    s_branch L_xpb_111
L_xp_112:
    M_CALL 2624, L_sub_pv
    s_branch L_xpb_113
L_xp_114:
    M_CALL 2688, L_sub_pv
    s_branch L_xpb_115
L_xp_116:
    M_CALL 2752, L_sub_pv
    s_branch L_xpb_117
L_xp_118:
    M_CALL 3072, L_sub_pv
    s_branch L_xpb_119
L_xp_120:
    M_CALL 3136, L_sub_pv
    s_branch L_xpb_121
L_xp_122:
    M_CALL 3200, L_sub_pv
    s_branch L_xpb_123
L_xp_124:
    M_CALL 3264, L_sub_pv
    s_branch L_xpb_125
L_xc_126:
    M_CALL 9216, L_sub_ek112
    s_cbranch_scc1 L_xo_128
    s_branch L_xcb_127
L_xp_129:
    M_CALL 9216, L_sub_pk
    s_branch L_xpb_130
L_xp_131:
    M_CALL 9280, L_sub_pk
    s_branch L_xpb_132
L_xp_133:
    M_CALL 9344, L_sub_pk
    s_branch L_xpb_134
L_xp_135:
    M_CALL 9408, L_sub_pk
    s_branch L_xpb_136
L_xp_137:
    M_CALL 9472, L_sub_pk
    s_branch L_xpb_138
L_xp_139:
    M_CALL 9536, L_sub_pk
    s_branch L_xpb_140
L_xp_141:
    M_CALL 9600, L_sub_pk
    s_branch L_xpb_142
L_xp_143:
    M_CALL 9664, L_sub_pk
    s_branch L_xpb_144
L_xp_145:
    M_CALL 3584, L_sub_pv
    s_branch L_xpb_146
L_xp_147:
    M_CALL 3648, L_sub_pv
    s_branch L_xpb_148
L_xp_149:
    M_CALL 3712, L_sub_pv
    s_branch L_xpb_150
L_xp_151:
    M_CALL 3776, L_sub_pv
    s_branch L_xpb_152
L_xp_153:
    M_CALL 4096, L_sub_pv
    s_branch L_xpb_154
L_xp_155:
    M_CALL 4160, L_sub_pv
    s_branch L_xpb_156
L_xp_157:
    M_CALL 4224, L_sub_pv
    s_branch L_xpb_158
L_xp_159:
    M_CALL 4288, L_sub_pv
    s_branch L_xpb_160
    M_CSUBE_
L_xo_3:
    s_bitset1_b32 s77, 0
    s_bitset1_b64 s[90:91], 0
    s_bitset1_b64 s[90:91], 1
    s_bitset1_b64 s[90:91], 2
    s_bitset1_b64 s[90:91], 3
    s_nop 7
    M_SPV 80, 84, 88, 92, 96, 100, 104, 108, 0
    s_nop 7
    M_SPV 81, 85, 89, 93, 97, 101, 105, 109, 2048
    s_nop 7
    M_SPV 82, 86, 90, 94, 98, 102, 106, 110, 4096
    s_nop 7
    M_SPV 83, 87, 91, 95, 99, 103, 107, 111, 6144
    s_waitcnt vmcnt(0)
    s_branch L_xcb_2
L_xo_6:
    s_bitset1_b32 s77, 1
    s_bitset1_b64 s[90:91], 4
    s_bitset1_b64 s[90:91], 5
    s_bitset1_b64 s[90:91], 6
    s_bitset1_b64 s[90:91], 7
    s_nop 7
    M_SPV 112, 116, 120, 124, 128, 132, 136, 140, 8192
    s_nop 7
    M_SPV 113, 117, 121, 125, 129, 133, 137, 141, 10240
    s_nop 7
    M_SPV 114, 118, 122, 126, 130, 134, 138, 142, 12288
    s_nop 7
    M_SPV 115, 119, 123, 127, 131, 135, 139, 143, 14336
    s_waitcnt vmcnt(0)
    s_branch L_xcb_5
L_xo_9:
    s_bitset1_b32 s77, 2
    s_bitset1_b64 s[90:91], 8
    s_bitset1_b64 s[90:91], 9
    s_bitset1_b64 s[90:91], 10
    s_bitset1_b64 s[90:91], 11
    s_nop 7
    M_SPV 80, 84, 88, 92, 96, 100, 104, 108, 16384
    s_nop 7
    M_SPV 81, 85, 89, 93, 97, 101, 105, 109, 18432
    s_nop 7
    M_SPV 82, 86, 90, 94, 98, 102, 106, 110, 20480
    s_nop 7
    M_SPV 83, 87, 91, 95, 99, 103, 107, 111, 22528
    s_waitcnt vmcnt(0)
    s_branch L_xcb_8
L_xo_12:
    s_bitset1_b32 s77, 3
    s_bitset1_b64 s[90:91], 12
    s_bitset1_b64 s[90:91], 13
    s_bitset1_b64 s[90:91], 14
    s_bitset1_b64 s[90:91], 15
    s_nop 7
    M_SPV 112, 116, 120, 124, 128, 132, 136, 140, 24576
    s_nop 7
    M_SPV 113, 117, 121, 125, 129, 133, 137, 141, 26624
    s_nop 7
    M_SPV 114, 118, 122, 126, 130, 134, 138, 142, 28672
    s_nop 7
    M_SPV 115, 119, 123, 127, 131, 135, 139, 143, 30720
    s_waitcnt vmcnt(0)
    s_branch L_xcb_11
L_xo_15:
    s_bitset1_b32 s77, 4
    s_bitset1_b64 s[90:91], 16
    s_bitset1_b64 s[90:91], 17
    s_bitset1_b64 s[90:91], 18
    s_bitset1_b64 s[90:91], 19
    s_nop 7
    M_SPV 80, 84, 88, 92, 96, 100, 104, 108, 32768
    s_nop 7
    M_SPV 81, 85, 89, 93, 97, 101, 105, 109, 34816
    s_nop 7
    M_SPV 82, 86, 90, 94, 98, 102, 106, 110, 36864
    s_nop 7
    M_SPV 83, 87, 91, 95, 99, 103, 107, 111, 38912
    s_waitcnt vmcnt(0)
    s_branch L_xcb_14
L_xo_18:
    s_bitset1_b32 s77, 5
    s_bitset1_b64 s[90:91], 20
    s_bitset1_b64 s[90:91], 21
    s_bitset1_b64 s[90:91], 22
    s_bitset1_b64 s[90:91], 23
    s_nop 7
    M_SPV 112, 116, 120, 124, 128, 132, 136, 140, 40960
    s_nop 7
    M_SPV 113, 117, 121, 125, 129, 133, 137, 141, 43008
    s_nop 7
    M_SPV 114, 118, 122, 126, 130, 134, 138, 142, 45056
    s_nop 7
    M_SPV 115, 119, 123, 127, 131, 135, 139, 143, 47104
    s_waitcnt vmcnt(0)
    s_branch L_xcb_17
L_xo_21:
    s_bitset1_b32 s77, 6
    s_bitset1_b64 s[90:91], 24
    s_bitset1_b64 s[90:91], 25
    s_bitset1_b64 s[90:91], 26
    s_bitset1_b64 s[90:91], 27
    s_nop 7
    M_SPV 80, 84, 88, 92, 96, 100, 104, 108, 49152
    s_nop 7
    M_SPV 81, 85, 89, 93, 97, 101, 105, 109, 51200
    s_nop 7
    M_SPV 82, 86, 90, 94, 98, 102, 106, 110, 53248
    s_nop 7
    M_SPV 83, 87, 91, 95, 99, 103, 107, 111, 55296
    s_waitcnt vmcnt(0)
    s_branch L_xcb_20
L_xo_24:
    s_bitset1_b32 s77, 7
    s_bitset1_b64 s[90:91], 28
    s_bitset1_b64 s[90:91], 29
    s_bitset1_b64 s[90:91], 30
    s_bitset1_b64 s[90:91], 31
    s_nop 7
    M_SPV 112, 116, 120, 124, 128, 132, 136, 140, 57344
    s_nop 7
    M_SPV 113, 117, 121, 125, 129, 133, 137, 141, 59392
    s_nop 7
    M_SPV 114, 118, 122, 126, 130, 134, 138, 142, 61440
    s_nop 7
    M_SPV 115, 119, 123, 127, 131, 135, 139, 143, 63488
    s_waitcnt vmcnt(0)
    s_branch L_xcb_23
L_xo_27:
    s_bitset1_b32 s77, 8
    s_bitset1_b64 s[90:91], 32
    s_bitset1_b64 s[90:91], 33
    s_bitset1_b64 s[90:91], 34
    s_bitset1_b64 s[90:91], 35
    s_nop 7
    M_SPV 80, 84, 88, 92, 96, 100, 104, 108, 65536
    s_nop 7
    M_SPV 81, 85, 89, 93, 97, 101, 105, 109, 67584
    s_nop 7
    M_SPV 82, 86, 90, 94, 98, 102, 106, 110, 69632
    s_nop 7
    M_SPV 83, 87, 91, 95, 99, 103, 107, 111, 71680
    s_waitcnt vmcnt(0)
    s_branch L_xcb_26
L_xo_34:
    s_bitset1_b32 s77, 16
    s_bitset1_b64 s[92:93], 0
    s_bitset1_b64 s[92:93], 1
    s_bitset1_b64 s[92:93], 2
    s_bitset1_b64 s[92:93], 3
    s_bitset1_b64 s[92:93], 4
    s_bitset1_b64 s[92:93], 5
    s_bitset1_b64 s[92:93], 6
    s_bitset1_b64 s[92:93], 7
    s_nop 7
    M_SPK 112, 131072
    s_nop 7
    M_SPK 116, 132096
    s_nop 7
    M_SPK 120, 133120
    s_nop 7
    M_SPK 124, 134144
    s_nop 7
    M_SPK 128, 135168
    s_nop 7
    M_SPK 132, 136192
    s_nop 7
    M_SPK 136, 137216
    s_nop 7
    M_SPK 140, 138240
    s_waitcnt vmcnt(0)
    s_branch L_xcb_33
L_xo_77:
    s_bitset1_b32 s77, 17
    s_bitset1_b64 s[92:93], 8
    s_bitset1_b64 s[92:93], 9
    s_bitset1_b64 s[92:93], 10
    s_bitset1_b64 s[92:93], 11
    s_bitset1_b64 s[92:93], 12
    s_bitset1_b64 s[92:93], 13
    s_bitset1_b64 s[92:93], 14
    s_bitset1_b64 s[92:93], 15
    s_nop 7
    M_SPK 112, 139264
    s_nop 7
    M_SPK 116, 140288
    s_nop 7
    M_SPK 120, 141312
    s_nop 7
    M_SPK 124, 142336
    s_nop 7
    M_SPK 128, 143360
    s_nop 7
    M_SPK 132, 144384
    s_nop 7
    M_SPK 136, 145408
    s_nop 7
    M_SPK 140, 146432
    s_waitcnt vmcnt(0)
    s_branch L_xcb_76
L_xo_128:
    s_bitset1_b32 s77, 18
    s_bitset1_b64 s[92:93], 16
    s_bitset1_b64 s[92:93], 17
    s_bitset1_b64 s[92:93], 18
    s_bitset1_b64 s[92:93], 19
    s_bitset1_b64 s[92:93], 20
    s_bitset1_b64 s[92:93], 21
    s_bitset1_b64 s[92:93], 22
    s_bitset1_b64 s[92:93], 23
    s_nop 7
    M_SPK 112, 147456
    s_nop 7
    M_SPK 116, 148480
    s_nop 7
    M_SPK 120, 149504
    s_nop 7
    M_SPK 124, 150528
    s_nop 7
    M_SPK 128, 151552
    s_nop 7
    M_SPK 132, 152576
    s_nop 7
    M_SPK 136, 153600
    s_nop 7
    M_SPK 140, 154624
    s_waitcnt vmcnt(0)
    s_branch L_xcb_127
L_far_161:
    buffer_store_dwordx4 v[44:47], v3, s[16:19], s55 offen sc1
    s_branch L_near_162
L_far_163:
    buffer_store_dwordx4 v[40:43], v3, s[16:19], s7 offen sc1
    s_branch L_near_164
L_pr_166:
    s_sub_u32 s5, s5, 1
    s_cmp_lg_u32 s5, 0
    s_cbranch_scc1 L_nofl_202
    buffer_wbl2 sc1
    s_movk_i32 s5, 64
L_nofl_202:
    v_max_u32 v6, v32, v33
    v_cmp_eq_u32 s[0:1], -1, v6
    s_nop 0
    s_mov_b64 exec, s[0:1]
    buffer_load_dwordx2 v[32:33], v5, s[16:19], s55 offen sc1
    s_mov_b64 exec, -1
    v_max3_u32 v6, v48, v49, v50
    v_max_u32 v6, v6, v51
    v_cmp_eq_u32 vcc, -1, v6
    s_nop 0
    s_or_b64 s[0:1], s[0:1], vcc
    s_mov_b64 exec, vcc
    s_add_u32 s53, s55, 0x0
    buffer_load_dwordx4 v[48:51], v4, s[16:19], s53 offen sc1
    s_mov_b64 exec, -1
    v_max3_u32 v6, v52, v53, v54
    v_max_u32 v6, v6, v55
    v_cmp_eq_u32 vcc, -1, v6
    s_nop 0
    s_or_b64 s[0:1], s[0:1], vcc
    s_mov_b64 exec, vcc
    s_add_u32 s53, s55, 0x2800
    buffer_load_dwordx4 v[52:55], v4, s[16:19], s53 offen sc1
    s_mov_b64 exec, -1
    v_max3_u32 v6, v56, v57, v58
    v_max_u32 v6, v6, v59
    v_cmp_eq_u32 vcc, -1, v6
    s_nop 0
    s_or_b64 s[0:1], s[0:1], vcc
    s_mov_b64 exec, vcc
    s_add_u32 s53, s55, 0x5000
    buffer_load_dwordx4 v[56:59], v4, s[16:19], s53 offen sc1
    s_mov_b64 exec, -1
    v_max3_u32 v6, v60, v61, v62
    v_max_u32 v6, v6, v63
    v_cmp_eq_u32 vcc, -1, v6
    s_nop 0
    s_or_b64 s[0:1], s[0:1], vcc
    s_mov_b64 exec, vcc
    s_add_u32 s53, s55, 0x7800
    buffer_load_dwordx4 v[60:63], v4, s[16:19], s53 offen sc1
    s_mov_b64 exec, -1
    v_max3_u32 v6, v64, v65, v66
    v_max_u32 v6, v6, v67
    v_cmp_eq_u32 vcc, -1, v6
    s_nop 0
    s_or_b64 s[0:1], s[0:1], vcc
    s_mov_b64 exec, vcc
    s_add_u32 s53, s55, 0xa000
    buffer_load_dwordx4 v[64:67], v4, s[16:19], s53 offen sc1
    s_mov_b64 exec, -1
    v_max3_u32 v6, v68, v69, v70
    v_max_u32 v6, v6, v71
    v_cmp_eq_u32 vcc, -1, v6
    s_nop 0
    s_or_b64 s[0:1], s[0:1], vcc
    s_mov_b64 exec, vcc
    s_add_u32 s53, s55, 0xc800
    buffer_load_dwordx4 v[68:71], v4, s[16:19], s53 offen sc1
    s_mov_b64 exec, -1
    v_max3_u32 v6, v72, v73, v74
    v_max_u32 v6, v6, v75
    v_cmp_eq_u32 vcc, -1, v6
    s_nop 0
    s_or_b64 s[0:1], s[0:1], vcc
    s_mov_b64 exec, vcc
    s_add_u32 s53, s55, 0xf000
    buffer_load_dwordx4 v[72:75], v4, s[16:19], s53 offen sc1
    s_mov_b64 exec, -1
    v_max3_u32 v6, v76, v77, v78
    v_max_u32 v6, v6, v79
    v_cmp_eq_u32 vcc, -1, v6
    s_nop 0
    s_or_b64 s[0:1], s[0:1], vcc
    s_mov_b64 exec, vcc
    s_add_u32 s53, s55, 0x11800
    buffer_load_dwordx4 v[76:79], v4, s[16:19], s53 offen sc1
    s_mov_b64 exec, -1
    s_cmp_eq_u64 s[0:1], 0
    s_cbranch_scc1 L_pf_168
    s_waitcnt vmcnt(0)
    s_sub_u32 s56, s56, 1
    s_cmp_eq_u32 s56, 0
    s_cbranch_scc0 L_pc_165
    s_mov_b32 s56, 1
L_pf_168:
    v_max_f32_dpp v6, v32, v32 quad_perm:[1,0,3,2] row_mask:0xf bank_mask:0xf
    s_nop 1
    v_max_f32_dpp v6, v6, v6 quad_perm:[2,3,0,1] row_mask:0xf bank_mask:0xf
    s_nop 1
    v_max_f32_dpp v6, v6, v6 row_half_mirror row_mask:0xf bank_mask:0xf
    v_mov_b32 v7, v6
    s_nop 1
    v_permlane16_swap_b32 v6, v7
    v_max_f32 v6, v6, v7
    v_mov_b32 v7, v6
    s_nop 1
    v_permlane32_swap_b32 v6, v7
    v_max_f32 v6, v6, v7
    v_mul_f32 v6, s60, v6
    v_fma_f32 v6, v32, s60, -v6
    v_exp_f32 v6, v6
    s_nop 0
    v_mul_f32 v8, v6, v33
    v_mov_b32_dpp v16, v6 row_newbcast:0 row_mask:0xf bank_mask:0xf
    v_mov_b32_dpp v17, v6 row_newbcast:1 row_mask:0xf bank_mask:0xf
    v_add_f32_dpp v8, v8, v8 quad_perm:[1,0,3,2] row_mask:0xf bank_mask:0xf
    v_mov_b32_dpp v18, v6 row_newbcast:2 row_mask:0xf bank_mask:0xf
    v_mov_b32_dpp v19, v6 row_newbcast:3 row_mask:0xf bank_mask:0xf
    v_add_f32_dpp v8, v8, v8 quad_perm:[2,3,0,1] row_mask:0xf bank_mask:0xf
    v_mov_b32_dpp v20, v6 row_newbcast:4 row_mask:0xf bank_mask:0xf
    v_mov_b32_dpp v21, v6 row_newbcast:5 row_mask:0xf bank_mask:0xf
    v_add_f32_dpp v8, v8, v8 row_half_mirror row_mask:0xf bank_mask:0xf
    v_mov_b32_dpp v22, v6 row_newbcast:6 row_mask:0xf bank_mask:0xf
    v_mov_b32_dpp v23, v6 row_newbcast:7 row_mask:0xf bank_mask:0xf
    v_mov_b32 v7, v8
    v_pk_mul_f32 v[24:25], v[48:49], v[16:17] op_sel:[0,0] op_sel_hi:[1,0]
    v_pk_mul_f32 v[26:27], v[50:51], v[16:17] op_sel:[0,0] op_sel_hi:[1,0]
    v_permlane16_swap_b32 v8, v7
    v_pk_fma_f32 v[24:25], v[52:53], v[16:17], v[24:25] op_sel:[0,1,0] op_sel_hi:[1,1,1]
    v_pk_fma_f32 v[26:27], v[54:55], v[16:17], v[26:27] op_sel:[0,1,0] op_sel_hi:[1,1,1]
    v_add_f32 v8, v8, v7
    v_pk_fma_f32 v[24:25], v[56:57], v[18:19], v[24:25] op_sel:[0,0,0] op_sel_hi:[1,0,1]
    v_pk_fma_f32 v[26:27], v[58:59], v[18:19], v[26:27] op_sel:[0,0,0] op_sel_hi:[1,0,1]
    v_mov_b32 v7, v8
    v_pk_fma_f32 v[24:25], v[60:61], v[18:19], v[24:25] op_sel:[0,1,0] op_sel_hi:[1,1,1]
    v_pk_fma_f32 v[26:27], v[62:63], v[18:19], v[26:27] op_sel:[0,1,0] op_sel_hi:[1,1,1]
    v_permlane32_swap_b32 v8, v7
    v_pk_fma_f32 v[24:25], v[64:65], v[20:21], v[24:25] op_sel:[0,0,0] op_sel_hi:[1,0,1]
    v_pk_fma_f32 v[26:27], v[66:67], v[20:21], v[26:27] op_sel:[0,0,0] op_sel_hi:[1,0,1]
    v_add_f32 v8, v8, v7
    v_pk_fma_f32 v[24:25], v[68:69], v[20:21], v[24:25] op_sel:[0,1,0] op_sel_hi:[1,1,1]
    v_pk_fma_f32 v[26:27], v[70:71], v[20:21], v[26:27] op_sel:[0,1,0] op_sel_hi:[1,1,1]
    v_rcp_f32 v31, v8
    v_pk_fma_f32 v[24:25], v[72:73], v[22:23], v[24:25] op_sel:[0,0,0] op_sel_hi:[1,0,1]
    v_pk_fma_f32 v[26:27], v[74:75], v[22:23], v[26:27] op_sel:[0,0,0] op_sel_hi:[1,0,1]
    v_fma_f32 v8, -v8, v31, 1.0
    v_pk_fma_f32 v[24:25], v[76:77], v[22:23], v[24:25] op_sel:[0,1,0] op_sel_hi:[1,1,1]
    v_pk_fma_f32 v[26:27], v[78:79], v[22:23], v[26:27] op_sel:[0,1,0] op_sel_hi:[1,1,1]
    v_fma_f32 v31, v8, v31, v31
    s_nop 0
    v_permlane32_swap_b32 v24, v26
    v_permlane32_swap_b32 v25, v27
    v_add_f32 v24, v24, v26
    v_add_f32 v25, v25, v27
    s_nop 1
    v_permlane16_swap_b32 v24, v25
    v_add_f32 v24, v24, v25
    v_mul_f32 v6, v24, v31
    v_mul_f32 v7, v24, v31
    s_nop 1
    v_permlane16_swap_b32 v6, v7
    s_branch L_pd_167
L_far_175:
    buffer_store_dwordx4 v[16:19], v30, s[16:19], s55 offen sc1
    s_branch L_near_176
L_far_189:
    buffer_store_dwordx4 v[16:19], v30, s[16:19], s61 offen sc1
    s_branch L_near_190
.section .rodata,"a"
.p2align 6
.amdhsa_kernel interleave_layers__gqa_block_cached__glu_gated_reglu__decode_kernel
  .amdhsa_next_free_vgpr 512
  .amdhsa_next_free_sgpr 102
  .amdhsa_accum_offset 256
  .amdhsa_group_segment_fixed_size 0
  .amdhsa_kernarg_size 96
  .amdhsa_user_sgpr_count 2
  .amdhsa_user_sgpr_kernarg_segment_ptr 1
  .amdhsa_system_sgpr_workgroup_id_x 1
  .amdhsa_float_denorm_mode_32 3
.end_amdhsa_kernel
```
